```python
import torch

def _softmax(x, axis=-1):
    return torch.softmax(x, dim=axis)
def _gelu(x):
    return torch.nn.functional.gelu(x, approximate="tanh")
def _silu(x):
    return torch.nn.functional.silu(x)
def _sigmoid(x):
    return torch.sigmoid(x)
def _layernorm(x, axis=-1, eps=1e-5):
    m = x.mean(dim=axis, keepdim=True)
    v = x.var(dim=axis, keepdim=True, unbiased=False)
    return (x - m) / torch.sqrt(v + eps)
def _scatter_add(tgt, idx, src, axis=0):
    return tgt.clone().index_add_(axis, idx, src)
def _segment_sum(src, seg, n):
    out = torch.zeros((n,) + src.shape[1:], dtype=src.dtype)
    return out.index_add_(0, seg, src)
def _pad(x, pw):
    flat = tuple(v for pair in reversed(pw) for v in pair)
    return torch.nn.functional.pad(x, flat)

kernel_name = 'gated_mix__linear_attn_block__geglu_ffn__prompt'

def setup_inputs():

    _w = (lambda a: (lambda t: t.to(torch.bfloat16) if t.is_floating_point() else t)(torch.as_tensor(a)))
    def _A_setup():
        B, S, D = 1, 2048, 512
        return {
            "x": _w((lambda *s: torch.randn(*s, dtype=torch.bfloat16) * 0.05)(B, S, D)),
            "wqkv": _w((lambda *s: torch.randn(*s, dtype=torch.bfloat16) * 0.8)(D, 3 * D)),
            "wo": _w((lambda *s: torch.randn(*s, dtype=torch.bfloat16) * 0.05)(D, D)),
        }
    _A_in = _A_setup()

    def _B_setup():
        B, S, D, F = 1, 2048, 512, 1792
        return {
            "x": _w((lambda *s: torch.randn(*s, dtype=torch.bfloat16) * 0.05)(B, S, D)),
            "w_gate": _w((lambda *s: torch.randn(*s, dtype=torch.bfloat16) * 0.05)(D, F)),
            "w_up": _w((lambda *s: torch.randn(*s, dtype=torch.bfloat16) * 0.05)(D, F)),
            "w_down": _w((lambda *s: torch.randn(*s, dtype=torch.bfloat16) * 0.05)(F, D)),
        }
    _B_in = _B_setup()

    return {
        "A_x": _A_in["x"],
        "A_wqkv": _A_in["wqkv"],
        "A_wo": _A_in["wo"],
        "B_x": _B_in["x"],
        "B_w_gate": _B_in["w_gate"],
        "B_w_up": _B_in["w_up"],
        "B_w_down": _B_in["w_down"],
        "gate_w": _w((lambda *s: torch.randn(*s, dtype=torch.bfloat16) * 0.05)(512) * 16.0),
    }

def reference(A_x, A_wqkv, A_wo, B_x, B_w_gate, B_w_up, B_w_down, gate_w):
    def _A_ref(x, wqkv, wo):
        B, S, D = x.shape
        H = 32; Dh = D // H
        qkv = (lambda x, *d: x.permute(*d))((x @ wqkv).reshape(B, S, 3, H, Dh), 2, 0, 3, 1, 4)
        q, k, v = qkv[0], qkv[1], qkv[2]
        phi = lambda t: torch.where(t > 0, t + 1, torch.exp(t)) + 1e-6
        pq, pk = phi(q), phi(k)
        kv = torch.einsum("bhsd,bhse->bhde", pk, v)
        z = torch.einsum("bhsd->bhd", pk)
        num = torch.einsum("bhqd,bhde->bhqe", pq, kv)
        den = torch.einsum("bhqd,bhd->bhq", pq, z)[..., None] + 1e-6
        o = num / den
        return (lambda x, *d: x.permute(*d))(o, 0, 2, 1, 3).reshape(B, S, D) @ wo

    def _B_ref(x, w_gate, w_up, w_down):
        return (_gelu(x @ w_gate) * (x @ w_up)) @ w_down

    x = A_x
    g = _sigmoid((x * gate_w).sum(-1, keepdims=True))
    a = _A_ref(x, A_wqkv, A_wo)
    b = _B_ref(x, B_w_gate, B_w_up, B_w_down)
    return g * a + (1 - g) * b
```

```asm
; @launch grid=(256,1,1) block=(256,1,1) lds=163840
.amdgcn_target "amdgcn-amd-amdhsa--gfx950"
.text
.globl gated_mix__linear_attn_block__geglu_ffn__prompt_kernel
.p2align 8
.type gated_mix__linear_attn_block__geglu_ffn__prompt_kernel,@function
gated_mix__linear_attn_block__geglu_ffn__prompt_kernel:
    s_cmp_ge_u32 s2, 256
    s_cbranch_scc1 L_exit
    s_load_dwordx16 s[84:99], s[0:1], 0
    s_load_dwordx4 s[80:83], s[0:1], 64
    s_load_dwordx2 s[100:101], s[0:1], 80
    v_lshrrev_b32 v96, 6, v0
    v_and_b32 v0, 63, v0
    v_readfirstlane_b32 s4, v96
    s_getpc_b64 s[32:33]
    s_and_b32 s32, s32, 0xffffff00
    s_lshr_b32 s3, s2, 3
    s_mul_i32 s3, s3, 12
    v_min_u32 v104, 11, v0
    v_add_u32 v104, s3, v104
    v_min_u32 v104, 365, v104
    v_lshlrev_b32 v104, 7, v104
    global_load_dword v105, v104, s[32:33]
    s_bfe_u32 s56, s2, 0x30003
    s_lshr_b32 s57, s2, 6
    s_and_b32 s44, s2, 1
    s_lshl_b32 s58, s44, 3
    s_add_u32 s58, s58, s56
    s_bfe_u32 s45, s2, 0x20001
    s_and_b32 s47, s57, 1
    s_lshl1_add_u32 s59, s45, s47
    s_lshr_b32 s60, s2, 7
    s_lshl_b32 s6, s58, 17
    s_lshl_b32 s7, s59, 7
    s_mul_i32 s46, s45, 640
    s_mul_i32 s48, s47, 384
    s_add_u32 s8, s46, s48
    s_add_u32 s10, s46, 256
    s_and_b32 s46, s56, 3
    s_lshl1_add_u32 s46, s47, s46
    s_add_u32 s44, s44, s45
    s_lshl1_add_u32 s45, s46, s44
    s_lshl_b32 s45, s45, 6
    s_and_b32 s16, s45, 511
    s_add_u32 s45, s45, 64
    s_and_b32 s17, s45, 511
    s_add_u32 s46, s7, 1024
    s_cmp_eq_u32 s60, 0
    s_cselect_b32 s48, s46, s8
    s_lshl_b32 s3, s60, 9
    s_add_u32 s3, s3, 3072
    s_lshl_b32 s49, 1024, s60
    s_lshl_b32 s50, s3, 9
    s_lshl_b32 s5, s4, 12
    s_lshl_b32 s46, s3, 3
    s_sub_u32 s46, s46, 1024
    s_sub_u32 s38, s50, s48
    s_add_u32 s42, s38, s49
    s_sub_u32 s30, 2097152, s6
    s_sub_u32 s34, 2082816, s6
    s_mov_b32 s31, 0x20000
    s_mov_b32 s35, 0x20000
    s_mov_b32 s39, 0x20000
    s_mov_b32 s43, 0x20000
    v_lshrrev_b32 v96, 3, v0
    v_and_b32 v98, 7, v0
    v_lshrrev_b32 v97, 4, v0
    v_xor_b32 v97, v97, v98
    v_lshlrev_b32 v97, 4, v97
    s_lshl_b32 s47, s4, 5
    v_add_u32 v99, s47, v96
    v_lshl_add_u32 v64, v99, 10, v97
    v_xor_b32 v65, 64, v64
    v_add_u32 v65, 7168, v65
    v_and_b32 v97, 2, v96
    v_xor_b32 v97, v97, v98
    v_lshlrev_b32 v97, 4, v97
    s_lshl_b32 s47, s4, 4
    v_add_u32 v99, s47, v96
    v_mad_u32_u24 v2, v99, s3, v97
    v_xor_b32 v3, 64, v2
    v_add_u32 v3, s46, v3
    s_waitcnt lgkmcnt(0)
    s_add_u32 s28, s84, s6
    s_addc_u32 s29, s85, 0
    s_add_u32 s32, s28, 14336
    s_addc_u32 s33, s29, 0
    s_add_u32 m0, s5, 0
    s_lshl_b32 s26, s16, 1
    buffer_load_dwordx4 v64, s[28:31], s26 offen lds
    buffer_load_dwordx4 v65, s[28:31], s26 offen offset:1024 lds
    buffer_load_dwordx4 v64, s[32:35], s26 offen offset:2048 lds
    buffer_load_dwordx4 v65, s[32:35], s26 offen offset:3072 lds
    s_cmp_eq_u32 s60, 0
    s_cselect_b64 s[36:37], s[86:87], s[92:93]
    s_cselect_b64 s[40:41], s[86:87], s[94:95]
    s_add_u32 s36, s36, s48
    s_addc_u32 s37, s37, 0
    s_add_u32 s40, s40, s48
    s_addc_u32 s41, s41, 0
    s_sub_u32 s40, s40, s49
    s_subb_u32 s41, s41, 0
    s_add_u32 m0, s5, 16384
    s_mul_i32 s26, s16, s3
    buffer_load_dwordx4 v2, s[36:39], s26 offen lds
    buffer_load_dwordx4 v3, s[36:39], s26 offen offset:1024 lds
    buffer_load_dwordx4 v2, s[40:43], s26 offen offset:2048 lds
    buffer_load_dwordx4 v3, s[40:43], s26 offen offset:3072 lds
    s_add_u32 m0, s5, 32768
    s_lshl_b32 s26, s17, 1
    buffer_load_dwordx4 v64, s[28:31], s26 offen lds
    buffer_load_dwordx4 v65, s[28:31], s26 offen offset:1024 lds
    buffer_load_dwordx4 v64, s[32:35], s26 offen offset:2048 lds
    buffer_load_dwordx4 v65, s[32:35], s26 offen offset:3072 lds
    s_mov_b32 s52, s100
    s_mov_b32 s53, s101
    s_mov_b32 s54, 268435456
    s_mov_b32 s55, 0x20000
    s_cmp_lg_u32 s60, 0
    s_cbranch_scc1 L_typeB
    s_add_u32 s45, s45, 64
    s_and_b32 s18, s45, 511
    s_add_u32 s45, s45, 64
    s_and_b32 s19, s45, 511
    s_add_u32 s45, s45, 64
    s_and_b32 s20, s45, 511
    s_add_u32 s45, s45, 64
    s_and_b32 s21, s45, 511
    s_add_u32 s45, s45, 64
    s_and_b32 s22, s45, 511
    s_add_u32 s45, s45, 64
    s_and_b32 s23, s45, 511
    v_lshlrev_b32 v1, 4, v0
    v_and_b32 v100, 6, v96
    v_xor_b32 v100, v100, v98
    v_lshlrev_b32 v100, 4, v100
    v_lshl_add_u32 v6, v96, 10, v100
    v_add_u32 v7, 7168, v6
    v_mul_u32_u24 v100, 3584, v99
    v_add_u32 v4, v100, v97
    v_xor_b32 v5, 64, v4
    v_add_u32 v5, 27648, v5
    s_add_u32 s9, s7, 2560
    s_and_b32 s48, s2, 127
    s_lshl_b32 s46, s48, 14
    s_lshl_b32 s47, s4, 10
    s_add_u32 s46, s46, s47
    s_add_u32 s46, s46, 11534336
    v_add_u32 v90, s46, v1
    s_lshl_b32 s47, s48, 2
    s_add_u32 s47, s47, 128
    s_lshl_b32 s46, s4, 8
    s_or_b32 s46, s46, s48
    s_cmp_lt_u32 s46, 32
    s_cselect_b32 s47, s47, 0x7fff0000
    v_cmp_eq_u32 vcc, 0, v0
    v_mov_b32 v91, 0x7fff0000
    v_mov_b32 v100, s47
    v_cndmask_b32 v91, v91, v100, vcc
    v_mov_b32 v92, 0
    v_mov_b32 v93, 0
    v_mov_b32 v94, 0
    v_mov_b32 v95, 0
    s_lshr_b32 s61, s4, 1
    s_and_b32 s62, s4, 1
    s_lshl1_add_u32 s63, s58, s61
    s_bfe_u32 s64, s2, 0x20001
    s_lshl3_add_u32 s64, s64, s56
    s_and_b32 s65, s2, 1
    s_lshl2_add_u32 s65, s65, s57
    s_lshl3_add_u32 s66, s60, s59
    s_lshl1_add_u32 s66, s66, s62
    s_cmp_ge_u32 s2, 32
    s_cbranch_scc1 L_noinit
    s_movk_i32 s3, 0x1000
    s_movk_i32 s27, 0x2000
    buffer_store_dwordx4 v[92:95], v90, s[52:55], s3 offen sc1
    buffer_store_dwordx4 v[92:95], v90, s[52:55], s27 offen sc1
    buffer_store_dwordx4 v[92:95], v90, s[52:55], 0 offen sc1
L_noinit:
    s_add_u32 m0, s5, 49152
    s_mul_i32 s26, s17, 3072
    buffer_load_dwordx4 v2, s[36:39], s26 offen lds
    buffer_load_dwordx4 v3, s[36:39], s26 offen offset:1024 lds
    buffer_load_dwordx4 v2, s[40:43], s26 offen offset:2048 lds
    buffer_load_dwordx4 v3, s[40:43], s26 offen offset:3072 lds
    v_bfe_u32 v96, v0, 2, 2
    v_and_b32 v98, 3, v0
    v_lshlrev_b32 v96, 7, v96
    v_lshl_add_u32 v96, v98, 3, v96
    v_bfe_u32 v97, v0, 3, 2
    v_lshlrev_b32 v97, 5, v97
    v_lshrrev_b32 v99, 4, v0
    v_and_b32 v98, 1, v99
    v_lshl_add_u32 v100, v98, 10, v96
    v_lshrrev_b32 v98, 1, v99
    v_lshl_add_u32 v100, v98, 12, v100
    v_add_u32 v100, v100, v97
    s_lshl_b32 s3, s62, 6
    v_xor_b32 v8, s3, v100
    v_add_u32 v9, 0x10000, v8
    v_add_u32 v10, 0x20000, v8
    v_xor_b32 v11, 32, v8
    v_xor_b32 v12, 32, v9
    v_xor_b32 v13, 32, v10
    v_and_b32 v100, 15, v0
    v_lshrrev_b32 v98, 1, v100
    s_lshl_b32 s3, s4, 5
    v_add_u32 v100, s3, v100
    v_xor_b32 v98, v98, v99
    v_lshlrev_b32 v98, 4, v98
    v_lshl_add_u32 v66, v100, 7, v98
    v_xor_b32 v67, 4096, v66
    v_xor_b32 v68, 64, v66
    v_xor_b32 v69, 64, v67
    s_add_u32 m0, s5, 65536
    s_lshl_b32 s26, s18, 1
    buffer_load_dwordx4 v64, s[28:31], s26 offen lds
    buffer_load_dwordx4 v65, s[28:31], s26 offen offset:1024 lds
    buffer_load_dwordx4 v64, s[32:35], s26 offen offset:2048 lds
    buffer_load_dwordx4 v65, s[32:35], s26 offen offset:3072 lds
    s_waitcnt vmcnt(12)
    s_barrier
    ds_read_b128 a[0:3], v66 offset:0
    ds_read_b128 a[4:7], v66 offset:2048
    ds_read_b128 a[128:131], v67 offset:0
    ds_read_b128 a[132:135], v67 offset:2048
    ds_read_b64_tr_b16 v[40:41], v8 offset:16384
    ds_read_b64_tr_b16 v[42:43], v8 offset:16896
    ds_read_b64_tr_b16 v[44:45], v11 offset:16384
    ds_read_b64_tr_b16 v[46:47], v11 offset:16896
    ds_read_b64_tr_b16 v[48:49], v8 offset:18432
    ds_read_b64_tr_b16 v[50:51], v8 offset:18944
    ds_read_b64_tr_b16 v[52:53], v11 offset:18432
    ds_read_b64_tr_b16 v[54:55], v11 offset:18944
    s_waitcnt lgkmcnt(6)
    v_mfma_f32_16x16x32_bf16 v[128:131], a[0:3], v[40:43], 0
    ds_read_b128 a[8:11], v68 offset:0
    s_add_u32 m0, s5, 81920
    s_mul_i32 s26, s18, 3072
    buffer_load_dwordx4 v2, s[36:39], s26 offen lds
    v_mfma_f32_16x16x32_bf16 v[132:135], a[4:7], v[40:43], 0
    ds_read_b128 a[12:15], v68 offset:2048
    s_mov_b32 s76, s82
    s_mov_b32 s77, s83
    s_mov_b32 s78, 256
    s_mov_b32 s79, 0x20000
    v_mfma_f32_16x16x32_bf16 v[136:139], a[128:131], v[40:43], 0
    ds_read_b128 a[136:139], v69 offset:0
    v_lshl_add_u32 v100, v99, 9, v96
    v_add3_u32 v20, v100, v97, s5
    v_add_u32 v21, 0x10000, v20
    v_mfma_f32_16x16x32_bf16 v[140:143], a[132:135], v[40:43], 0
    ds_read_b128 a[140:143], v69 offset:2048
    v_add_u32 v22, 0x20000, v20
    v_xor_b32 v23, 32, v20
    s_waitcnt lgkmcnt(8)
    v_mfma_f32_16x16x32_bf16 v[144:147], a[0:3], v[44:47], 0
    ds_read_b64_tr_b16 v[56:57], v8 offset:24576
    buffer_load_dwordx4 v3, s[36:39], s26 offen offset:1024 lds
    v_xor_b32 v24, 32, v21
    v_xor_b32 v25, 32, v22
    v_mfma_f32_16x16x32_bf16 v[148:151], a[4:7], v[44:47], 0
    ds_read_b64_tr_b16 v[58:59], v8 offset:25088
    v_xor_b32 v26, 64, v20
    v_xor_b32 v27, 64, v21
    v_xor_b32 v28, 64, v22
    v_mfma_f32_16x16x32_bf16 v[152:155], a[128:131], v[44:47], 0
    ds_read_b64_tr_b16 v[60:61], v11 offset:24576
    v_xor_b32 v29, 96, v20
    v_xor_b32 v30, 96, v21
    v_xor_b32 v31, 96, v22
    v_mfma_f32_16x16x32_bf16 v[156:159], a[132:135], v[44:47], 0
    ds_read_b64_tr_b16 v[62:63], v11 offset:25088
    s_mul_i32 s3, s63, 294912
    s_add_u32 s3, s3, 1048576
    s_waitcnt lgkmcnt(10)
    v_mfma_f32_16x16x32_bf16 v[160:163], a[0:3], v[48:51], 0
    ds_read_b64_tr_b16 v[40:41], v8 offset:26624
    buffer_load_dwordx4 v2, s[40:43], s26 offen offset:2048 lds
    s_lshl_b32 s72, s62, 12
    s_add_u32 s3, s3, s72
    v_mfma_f32_16x16x32_bf16 v[164:167], a[4:7], v[48:51], 0
    ds_read_b64_tr_b16 v[42:43], v8 offset:27136
    s_lshl_b32 s72, s62, 11
    s_add_u32 s11, s3, s72
    s_xor_b32 s72, s72, 2048
    v_mfma_f32_16x16x32_bf16 v[168:171], a[128:131], v[48:51], 0
    ds_read_b64_tr_b16 v[44:45], v11 offset:26624
    s_add_u32 s12, s3, s72
    s_lshl_b32 s13, s63, 7
    s_add_u32 s13, s13, s66
    v_mfma_f32_16x16x32_bf16 v[172:175], a[132:135], v[48:51], 0
    ds_read_b64_tr_b16 v[46:47], v11 offset:27136
    s_lshl_b32 s13, s13, 7
    s_add_u32 s13, s13, 11534336
    s_waitcnt lgkmcnt(12)
    v_mfma_f32_16x16x32_bf16 v[176:179], a[0:3], v[52:55], 0
    buffer_load_dwordx4 v3, s[40:43], s26 offen offset:3072 lds
    s_add_u32 m0, s5, 98304
    s_lshl_b32 s26, s19, 1
    s_lshl_b32 s14, s64, 14
    v_mfma_f32_16x16x32_bf16 v[180:183], a[4:7], v[52:55], 0
    s_add_u32 s14, s14, 11534336
    s_mul_i32 s15, s64, 294912
    s_add_u32 s15, s15, 1048576
    s_mov_b32 s24, 0xffff
    v_mfma_f32_16x16x32_bf16 v[184:187], a[128:131], v[52:55], 0
    s_mov_b32 s25, 0xffff
    v_mov_b32 v32, 0xbdd2d3e8
    v_mov_b32 v100, 0x7fff0000
    v_and_b32 v96, 15, v0
    v_mfma_f32_16x16x32_bf16 v[188:191], a[132:135], v[52:55], 0
    v_lshlrev_b32 v96, 2, v96
    v_lshlrev_b32 v98, 2, v0
    s_waitcnt lgkmcnt(4)
    v_mfma_f32_16x16x32_bf16 v[128:131], a[8:11], v[56:59], v[128:131]
    s_waitcnt vmcnt(8) lgkmcnt(0)
    s_barrier
    ds_read_b128 a[16:19], v66 offset:32768
    buffer_load_dwordx4 v64, s[28:31], s26 offen lds
    v_mfma_f32_16x16x32_bf16 v[132:135], a[12:15], v[56:59], v[132:135]
    ds_read_b128 a[20:23], v66 offset:34816
    v_cmp_gt_u32 vcc, 32, v0
    v_add_u32 v34, 159744, v96
    v_and_b32 v97, 4, v0
    v_cndmask_b32 v37, v100, v98, vcc
    v_mfma_f32_16x16x32_bf16 v[136:139], a[136:139], v[56:59], v[136:139]
    ds_read_b128 a[144:147], v67 offset:32768
    v_and_b32 v98, 3, v0
    v_lshl_add_u32 v97, v97, 2, v98
    s_lshl_b32 s3, s4, 2
    v_mfma_f32_16x16x32_bf16 v[140:143], a[140:143], v[56:59], v[140:143]
    ds_read_b128 a[148:151], v67 offset:34816
    v_cmp_gt_u32 vcc, 8, v0
    v_add_lshl_u32 v97, v97, s3, 7
    s_lshl_b32 s3, s61, 14
    v_cndmask_b32 v33, v100, v97, vcc
    v_mfma_f32_16x16x32_bf16 v[144:147], a[8:11], v[60:63], v[144:147]
    ds_read_b64_tr_b16 v[48:49], v8 offset:49152
    buffer_load_dwordx4 v65, s[28:31], s26 offen offset:1024 lds
    s_lshl_b32 s72, s66, 7
    s_add_u32 s3, s3, s72
    v_mfma_f32_16x16x32_bf16 v[148:151], a[12:15], v[60:63], v[148:151]
    ds_read_b64_tr_b16 v[50:51], v8 offset:49664
    v_cmp_gt_u32 vcc, 16, v0
    s_add_u32 s3, s3, 11534336
    v_lshl_add_u32 v97, v0, 15, s3
    v_cndmask_b32 v36, v100, v97, vcc
    v_mfma_f32_16x16x32_bf16 v[152:155], a[136:139], v[60:63], v[152:155]
    ds_read_b64_tr_b16 v[52:53], v11 offset:49152
    s_add_u32 s44, s92, s9
    s_addc_u32 s45, s93, 0
    s_sub_u32 s46, 1835008, s9
    s_mov_b32 s47, 0x20000
    v_mfma_f32_16x16x32_bf16 v[156:159], a[140:143], v[60:63], v[156:159]
    ds_read_b64_tr_b16 v[54:55], v11 offset:49664
    s_sub_u32 s48, s94, 2048
    s_subb_u32 s49, s95, 0
    s_add_u32 s48, s48, s9
    s_addc_u32 s49, s49, 0
    s_sub_u32 s50, 1837056, s9
    s_mov_b32 s51, 0x20000
    v_mfma_f32_16x16x32_bf16 v[160:163], a[8:11], v[40:43], v[160:163]
    ds_read_b64_tr_b16 v[56:57], v8 offset:51200
    buffer_load_dwordx4 v64, s[32:35], s26 offen offset:2048 lds
    s_lshl_b32 s93, s65, 7
    v_mfma_f32_16x16x32_bf16 v[164:167], a[12:15], v[40:43], v[164:167]
    ds_read_b64_tr_b16 v[58:59], v8 offset:51712
    s_add_u32 s68, s88, 14336
    s_addc_u32 s69, s89, 0
    s_add_u32 s68, s68, s93
    s_addc_u32 s69, s69, 0
    s_sub_u32 s70, 509952, s93
    s_mov_b32 s71, 0x20000
    v_mfma_f32_16x16x32_bf16 v[168:171], a[136:139], v[40:43], v[168:171]
    ds_read_b64_tr_b16 v[60:61], v11 offset:51200
    s_lshl_b32 s3, s59, 2
    s_lshl1_add_u32 s3, s62, s3
    s_add_u32 s3, s3, s61
    v_mfma_f32_16x16x32_bf16 v[172:175], a[140:143], v[40:43], v[172:175]
    ds_read_b64_tr_b16 v[62:63], v11 offset:51712
    s_lshl4_add_u32 s3, s3, s58
    s_lshl_b32 s90, s3, 7
    s_add_u32 s90, s90, 16384
    v_mfma_f32_16x16x32_bf16 v[176:179], a[8:11], v[44:47], v[176:179]
    buffer_load_dwordx4 v65, s[32:35], s26 offen offset:3072 lds
    s_add_u32 m0, s5, 114688
    s_mul_i32 s26, s19, 3072
    s_lshl_b32 s95, s3, 10
    v_mfma_f32_16x16x32_bf16 v[180:183], a[12:15], v[44:47], v[180:183]
    s_lshl2_add_u32 s3, s64, s4
    s_lshl_b32 s3, s3, 14
    s_add_u32 s92, s3, s93
    s_add_u32 s3, s64, s65
    v_mfma_f32_16x16x32_bf16 v[184:187], a[136:139], v[44:47], v[184:187]
    s_mul_i32 s72, s4, 10
    s_lshl_b32 s73, s4, 2
    v_add_u32 v96, s3, v0
    v_and_b32 v96, 3, v96
    v_mfma_f32_16x16x32_bf16 v[188:191], a[140:143], v[44:47], v[188:191]
    v_add_lshl_u32 v98, v96, s73, 15
    v_and_b32 v97, 2, v96
    v_lshl_add_u32 v96, v97, 1, v96
    s_waitcnt lgkmcnt(4)
    v_mfma_f32_16x16x32_bf16 v[128:131], a[16:19], v[48:51], v[128:131]
    ds_read_b128 a[24:27], v68 offset:32768
    buffer_load_dwordx4 v2, s[36:39], s26 offen lds
    v_add_lshl_u32 v97, v96, s72, 15
    s_add_u32 s6, s72, 4
    v_mfma_f32_16x16x32_bf16 v[132:135], a[20:23], v[48:51], v[132:135]
    ds_read_b128 a[28:31], v68 offset:34816
    s_and_b32 s56, s3, 1
    s_add_u32 s6, s6, s56
    s_lshl_b32 s6, s6, 15
    v_mfma_f32_16x16x32_bf16 v[136:139], a[144:147], v[48:51], v[136:139]
    ds_read_b128 a[152:155], v69 offset:32768
    s_lshl_b32 s3, s3, 0
    s_add_u32 s72, s72, 2
    s_add_u32 s73, s73, 36
    v_mfma_f32_16x16x32_bf16 v[140:143], a[148:151], v[48:51], v[140:143]
    ds_read_b128 a[156:159], v69 offset:34816
    v_add_u32 v99, s3, v0
    v_and_b32 v99, 3, v99
    v_and_b32 v96, 4, v0
    v_mfma_f32_16x16x32_bf16 v[144:147], a[16:19], v[52:55], v[144:147]
    ds_read_b64_tr_b16 v[40:41], v8 offset:57344
    buffer_load_dwordx4 v3, s[36:39], s26 offen offset:1024 lds
    v_or_b32 v99, v99, v96
    v_and_b32 v96, 2, v99
    v_mfma_f32_16x16x32_bf16 v[148:151], a[20:23], v[52:55], v[148:151]
    ds_read_b64_tr_b16 v[42:43], v8 offset:57856
    v_lshl_add_u32 v96, v96, 1, v99
    v_add_u32 v96, s72, v96
    v_mfma_f32_16x16x32_bf16 v[152:155], a[144:147], v[52:55], v[152:155]
    ds_read_b64_tr_b16 v[44:45], v11 offset:57344
    v_cmp_gt_u32 vcc, 4, v99
    v_add_u32 v99, s73, v99
    v_mov_b32 v0, 1
    v_cndmask_b32 v38, v99, v96, vcc
    v_mfma_f32_16x16x32_bf16 v[156:159], a[148:151], v[52:55], v[156:159]
    ds_read_b64_tr_b16 v[46:47], v11 offset:57856
    v_lshlrev_b32 v38, 15, v38
    s_waitcnt lgkmcnt(8)
    v_mfma_f32_16x16x32_bf16 v[160:163], a[16:19], v[56:59], v[160:163]
    ds_read_b64_tr_b16 v[48:49], v8 offset:59392
    buffer_load_dwordx4 v2, s[40:43], s26 offen offset:2048 lds
    v_mfma_f32_16x16x32_bf16 v[164:167], a[20:23], v[56:59], v[164:167]
    ds_read_b64_tr_b16 v[50:51], v8 offset:59904
    s_mov_b32 s72, s80
    s_mov_b32 s73, s81
    s_mov_b32 s74, 2097152
    s_mov_b32 s75, 0x20000
    v_mfma_f32_16x16x32_bf16 v[168:171], a[144:147], v[56:59], v[168:171]
    ds_read_b64_tr_b16 v[52:53], v11 offset:59392
    v_readlane_b32 s80, v97, 0
    v_readlane_b32 s81, v97, 1
    v_readlane_b32 s82, v97, 2
    v_mfma_f32_16x16x32_bf16 v[172:175], a[148:151], v[56:59], v[172:175]
    ds_read_b64_tr_b16 v[54:55], v11 offset:59904
    v_readlane_b32 s83, v97, 3
    v_readlane_b32 s84, v98, 0
    v_readlane_b32 s85, v98, 1
    v_mfma_f32_16x16x32_bf16 v[176:179], a[16:19], v[60:63], v[176:179]
    buffer_load_dwordx4 v3, s[40:43], s26 offen offset:3072 lds
    s_add_u32 m0, s5, 131072
    s_lshl_b32 s26, s20, 1
    v_readlane_b32 s86, v98, 2
    v_mfma_f32_16x16x32_bf16 v[180:183], a[20:23], v[60:63], v[180:183]
    v_readlane_b32 s87, v98, 3
    s_add_u32 s56, s96, s93
    s_addc_u32 s57, s97, 0
    s_sub_u32 s58, 1835008, s93
    s_mov_b32 s59, 0x20000
    v_mfma_f32_16x16x32_bf16 v[184:187], a[144:147], v[60:63], v[184:187]
    s_add_u32 s60, s96, 14336
    s_addc_u32 s61, s97, 0
    s_add_u32 s60, s60, s93
    s_addc_u32 s61, s61, 0
    s_sub_u32 s62, 1820672, s93
    s_mov_b32 s63, 0x20000
    v_mfma_f32_16x16x32_bf16 v[188:191], a[148:151], v[60:63], v[188:191]
    s_add_u32 s64, s88, s93
    s_addc_u32 s65, s89, 0
    s_sub_u32 s66, 524288, s93
    s_mov_b32 s67, 0x20000
    s_waitcnt lgkmcnt(4)
    v_mfma_f32_16x16x32_bf16 v[128:131], a[24:27], v[40:43], v[128:131]
    s_waitcnt vmcnt(8) lgkmcnt(0)
    s_barrier
    v_add_u32 v66, 0x10000, v66
    v_add_u32 v67, 0x10000, v67
    v_mfma_f32_16x16x32_bf16 v[132:135], a[28:31], v[40:43], v[132:135]
    v_add_u32 v68, 0x10000, v68
    v_add_u32 v69, 0x10000, v69
    buffer_load_dwordx4 v64, s[28:31], s26 offen lds
    s_mov_b32 s88, s93
    v_mfma_f32_16x16x32_bf16 v[136:139], a[152:155], v[40:43], v[136:139]
    ds_read_b128 a[32:35], v66 offset:0
    ds_read_b128 a[36:39], v66 offset:2048
    s_add_u32 s89, s95, 131072
    v_mfma_f32_16x16x32_bf16 v[140:143], a[156:159], v[40:43], v[140:143]
    ds_read_b128 a[160:163], v67 offset:0
    ds_read_b128 a[164:167], v67 offset:2048
    v_mfma_f32_16x16x32_bf16 v[144:147], a[24:27], v[44:47], v[144:147]
    ds_read_b64_tr_b16 v[56:57], v9 offset:16384
    v_mfma_f32_16x16x32_bf16 v[148:151], a[28:31], v[44:47], v[148:151]
    ds_read_b64_tr_b16 v[58:59], v9 offset:16896
    v_mov_b32 v35, 1
    buffer_store_dword v35, v91, s[76:79], 0 offen sc1
    v_mfma_f32_16x16x32_bf16 v[152:155], a[152:155], v[44:47], v[152:155]
    ds_read_b64_tr_b16 v[60:61], v12 offset:16384
    v_mfma_f32_16x16x32_bf16 v[156:159], a[156:159], v[44:47], v[156:159]
    ds_read_b64_tr_b16 v[62:63], v12 offset:16896
    v_mfma_f32_16x16x32_bf16 v[160:163], a[24:27], v[48:51], v[160:163]
    ds_read_b64_tr_b16 v[40:41], v9 offset:18432
    v_mfma_f32_16x16x32_bf16 v[164:167], a[28:31], v[48:51], v[164:167]
    ds_read_b64_tr_b16 v[42:43], v9 offset:18944
    buffer_load_dwordx4 v65, s[28:31], s26 offen offset:1024 lds
    v_mfma_f32_16x16x32_bf16 v[168:171], a[152:155], v[48:51], v[168:171]
    ds_read_b64_tr_b16 v[44:45], v12 offset:18432
    v_mfma_f32_16x16x32_bf16 v[172:175], a[156:159], v[48:51], v[172:175]
    ds_read_b64_tr_b16 v[46:47], v12 offset:18944
    v_mfma_f32_16x16x32_bf16 v[176:179], a[24:27], v[52:55], v[176:179]
    v_mfma_f32_16x16x32_bf16 v[180:183], a[28:31], v[52:55], v[180:183]
    buffer_load_dwordx4 v64, s[32:35], s26 offen offset:2048 lds
    v_mfma_f32_16x16x32_bf16 v[184:187], a[152:155], v[52:55], v[184:187]
    v_mfma_f32_16x16x32_bf16 v[188:191], a[156:159], v[52:55], v[188:191]
    s_waitcnt lgkmcnt(4)
    v_mfma_f32_16x16x32_bf16 v[128:131], a[32:35], v[56:59], v[128:131]
    ds_read_b128 a[40:43], v68 offset:0
    v_mfma_f32_16x16x32_bf16 v[132:135], a[36:39], v[56:59], v[132:135]
    ds_read_b128 a[44:47], v68 offset:2048
    buffer_load_dwordx4 v65, s[32:35], s26 offen offset:3072 lds
    s_add_u32 m0, s5, 0
    s_mul_i32 s26, s20, 3072
    v_mfma_f32_16x16x32_bf16 v[136:139], a[160:163], v[56:59], v[136:139]
    ds_read_b128 a[168:171], v69 offset:0
    v_mfma_f32_16x16x32_bf16 v[140:143], a[164:167], v[56:59], v[140:143]
    ds_read_b128 a[172:175], v69 offset:2048
    v_mfma_f32_16x16x32_bf16 v[144:147], a[32:35], v[60:63], v[144:147]
    ds_read_b64_tr_b16 v[48:49], v9 offset:24576
    v_mfma_f32_16x16x32_bf16 v[148:151], a[36:39], v[60:63], v[148:151]
    ds_read_b64_tr_b16 v[50:51], v9 offset:25088
    buffer_load_dwordx4 v2, s[36:39], s26 offen lds
    v_mfma_f32_16x16x32_bf16 v[152:155], a[160:163], v[60:63], v[152:155]
    ds_read_b64_tr_b16 v[52:53], v12 offset:24576
    v_mfma_f32_16x16x32_bf16 v[156:159], a[164:167], v[60:63], v[156:159]
    ds_read_b64_tr_b16 v[54:55], v12 offset:25088
    s_waitcnt lgkmcnt(8)
    v_mfma_f32_16x16x32_bf16 v[160:163], a[32:35], v[40:43], v[160:163]
    ds_read_b64_tr_b16 v[56:57], v9 offset:26624
    v_mfma_f32_16x16x32_bf16 v[164:167], a[36:39], v[40:43], v[164:167]
    ds_read_b64_tr_b16 v[58:59], v9 offset:27136
    buffer_load_dwordx4 v3, s[36:39], s26 offen offset:1024 lds
    v_mfma_f32_16x16x32_bf16 v[168:171], a[160:163], v[40:43], v[168:171]
    ds_read_b64_tr_b16 v[60:61], v12 offset:26624
    v_mfma_f32_16x16x32_bf16 v[172:175], a[164:167], v[40:43], v[172:175]
    ds_read_b64_tr_b16 v[62:63], v12 offset:27136
    v_mfma_f32_16x16x32_bf16 v[176:179], a[32:35], v[44:47], v[176:179]
    v_mfma_f32_16x16x32_bf16 v[180:183], a[36:39], v[44:47], v[180:183]
    buffer_load_dwordx4 v2, s[40:43], s26 offen offset:2048 lds
    v_mfma_f32_16x16x32_bf16 v[184:187], a[160:163], v[44:47], v[184:187]
    v_mfma_f32_16x16x32_bf16 v[188:191], a[164:167], v[44:47], v[188:191]
    s_waitcnt lgkmcnt(4)
    v_mfma_f32_16x16x32_bf16 v[128:131], a[40:43], v[48:51], v[128:131]
    s_waitcnt vmcnt(8) lgkmcnt(0)
    s_barrier
    ds_read_b128 a[48:51], v66 offset:32768
    v_mfma_f32_16x16x32_bf16 v[132:135], a[44:47], v[48:51], v[132:135]
    ds_read_b128 a[52:55], v66 offset:34816
    buffer_load_dwordx4 v3, s[40:43], s26 offen offset:3072 lds
    s_add_u32 m0, s5, 16384
    s_lshl_b32 s26, s21, 1
    v_mfma_f32_16x16x32_bf16 v[136:139], a[168:171], v[48:51], v[136:139]
    ds_read_b128 a[176:179], v67 offset:32768
    v_mfma_f32_16x16x32_bf16 v[140:143], a[172:175], v[48:51], v[140:143]
    ds_read_b128 a[180:183], v67 offset:34816
    v_mfma_f32_16x16x32_bf16 v[144:147], a[40:43], v[52:55], v[144:147]
    ds_read_b64_tr_b16 v[40:41], v9 offset:49152
    v_mfma_f32_16x16x32_bf16 v[148:151], a[44:47], v[52:55], v[148:151]
    ds_read_b64_tr_b16 v[42:43], v9 offset:49664
    buffer_load_dwordx4 v64, s[28:31], s26 offen lds
    v_mfma_f32_16x16x32_bf16 v[152:155], a[168:171], v[52:55], v[152:155]
    ds_read_b64_tr_b16 v[44:45], v12 offset:49152
    v_mfma_f32_16x16x32_bf16 v[156:159], a[172:175], v[52:55], v[156:159]
    ds_read_b64_tr_b16 v[46:47], v12 offset:49664
    v_mfma_f32_16x16x32_bf16 v[160:163], a[40:43], v[56:59], v[160:163]
    ds_read_b64_tr_b16 v[48:49], v9 offset:51200
    v_mfma_f32_16x16x32_bf16 v[164:167], a[44:47], v[56:59], v[164:167]
    ds_read_b64_tr_b16 v[50:51], v9 offset:51712
    buffer_load_dwordx4 v65, s[28:31], s26 offen offset:1024 lds
    v_mfma_f32_16x16x32_bf16 v[168:171], a[168:171], v[56:59], v[168:171]
    ds_read_b64_tr_b16 v[52:53], v12 offset:51200
    v_mfma_f32_16x16x32_bf16 v[172:175], a[172:175], v[56:59], v[172:175]
    ds_read_b64_tr_b16 v[54:55], v12 offset:51712
    v_mfma_f32_16x16x32_bf16 v[176:179], a[40:43], v[60:63], v[176:179]
    v_mfma_f32_16x16x32_bf16 v[180:183], a[44:47], v[60:63], v[180:183]
    buffer_load_dwordx4 v64, s[32:35], s26 offen offset:2048 lds
    v_mfma_f32_16x16x32_bf16 v[184:187], a[168:171], v[60:63], v[184:187]
    v_mfma_f32_16x16x32_bf16 v[188:191], a[172:175], v[60:63], v[188:191]
    s_waitcnt lgkmcnt(4)
    v_mfma_f32_16x16x32_bf16 v[128:131], a[48:51], v[40:43], v[128:131]
    ds_read_b128 a[56:59], v68 offset:32768
    v_mfma_f32_16x16x32_bf16 v[132:135], a[52:55], v[40:43], v[132:135]
    ds_read_b128 a[60:63], v68 offset:34816
    buffer_load_dwordx4 v65, s[32:35], s26 offen offset:3072 lds
    s_add_u32 m0, s5, 32768
    s_mul_i32 s26, s21, 3072
    v_mfma_f32_16x16x32_bf16 v[136:139], a[176:179], v[40:43], v[136:139]
    ds_read_b128 a[184:187], v69 offset:32768
    v_mfma_f32_16x16x32_bf16 v[140:143], a[180:183], v[40:43], v[140:143]
    ds_read_b128 a[188:191], v69 offset:34816
    v_mfma_f32_16x16x32_bf16 v[144:147], a[48:51], v[44:47], v[144:147]
    ds_read_b64_tr_b16 v[56:57], v9 offset:57344
    v_mfma_f32_16x16x32_bf16 v[148:151], a[52:55], v[44:47], v[148:151]
    ds_read_b64_tr_b16 v[58:59], v9 offset:57856
    buffer_load_dwordx4 v2, s[36:39], s26 offen lds
    v_mfma_f32_16x16x32_bf16 v[152:155], a[176:179], v[44:47], v[152:155]
    ds_read_b64_tr_b16 v[60:61], v12 offset:57344
    v_mfma_f32_16x16x32_bf16 v[156:159], a[180:183], v[44:47], v[156:159]
    ds_read_b64_tr_b16 v[62:63], v12 offset:57856
    s_waitcnt lgkmcnt(8)
    v_mfma_f32_16x16x32_bf16 v[160:163], a[48:51], v[48:51], v[160:163]
    ds_read_b64_tr_b16 v[40:41], v9 offset:59392
    v_mfma_f32_16x16x32_bf16 v[164:167], a[52:55], v[48:51], v[164:167]
    ds_read_b64_tr_b16 v[42:43], v9 offset:59904
    buffer_load_dwordx4 v3, s[36:39], s26 offen offset:1024 lds
    v_mfma_f32_16x16x32_bf16 v[168:171], a[176:179], v[48:51], v[168:171]
    ds_read_b64_tr_b16 v[44:45], v12 offset:59392
    v_mfma_f32_16x16x32_bf16 v[172:175], a[180:183], v[48:51], v[172:175]
    ds_read_b64_tr_b16 v[46:47], v12 offset:59904
    v_mfma_f32_16x16x32_bf16 v[176:179], a[48:51], v[52:55], v[176:179]
    v_mfma_f32_16x16x32_bf16 v[180:183], a[52:55], v[52:55], v[180:183]
    buffer_load_dwordx4 v2, s[40:43], s26 offen offset:2048 lds
    v_mfma_f32_16x16x32_bf16 v[184:187], a[176:179], v[52:55], v[184:187]
    v_mfma_f32_16x16x32_bf16 v[188:191], a[180:183], v[52:55], v[188:191]
    s_waitcnt lgkmcnt(4)
    v_mfma_f32_16x16x32_bf16 v[128:131], a[56:59], v[56:59], v[128:131]
    s_waitcnt vmcnt(7) lgkmcnt(0)
    s_barrier
    v_add_u32 v66, 0x10000, v66
    v_add_u32 v67, 0x10000, v67
    v_mfma_f32_16x16x32_bf16 v[132:135], a[60:63], v[56:59], v[132:135]
    v_add_u32 v68, 0x10000, v68
    v_add_u32 v69, 0x10000, v69
    buffer_load_dwordx4 v3, s[40:43], s26 offen offset:3072 lds
    v_mfma_f32_16x16x32_bf16 v[136:139], a[184:187], v[56:59], v[136:139]
    ds_read_b128 a[64:67], v66 offset:0
    ds_read_b128 a[68:71], v66 offset:2048
    s_add_u32 m0, s5, 49152
    s_lshl_b32 s26, s22, 1
    v_mfma_f32_16x16x32_bf16 v[140:143], a[188:191], v[56:59], v[140:143]
    ds_read_b128 a[192:195], v67 offset:0
    ds_read_b128 a[196:199], v67 offset:2048
    v_mfma_f32_16x16x32_bf16 v[144:147], a[56:59], v[60:63], v[144:147]
    ds_read_b64_tr_b16 v[48:49], v8 offset:0
    v_mfma_f32_16x16x32_bf16 v[148:151], a[60:63], v[60:63], v[148:151]
    ds_read_b64_tr_b16 v[50:51], v8 offset:512
    buffer_load_dwordx4 v64, s[28:31], s26 offen lds
    v_mfma_f32_16x16x32_bf16 v[152:155], a[184:187], v[60:63], v[152:155]
    ds_read_b64_tr_b16 v[52:53], v11 offset:0
    v_mfma_f32_16x16x32_bf16 v[156:159], a[188:191], v[60:63], v[156:159]
    ds_read_b64_tr_b16 v[54:55], v11 offset:512
    v_mfma_f32_16x16x32_bf16 v[160:163], a[56:59], v[40:43], v[160:163]
    ds_read_b64_tr_b16 v[56:57], v8 offset:2048
    v_mfma_f32_16x16x32_bf16 v[164:167], a[60:63], v[40:43], v[164:167]
    ds_read_b64_tr_b16 v[58:59], v8 offset:2560
    buffer_load_dwordx4 v65, s[28:31], s26 offen offset:1024 lds
    v_mfma_f32_16x16x32_bf16 v[168:171], a[184:187], v[40:43], v[168:171]
    ds_read_b64_tr_b16 v[60:61], v11 offset:2048
    v_mfma_f32_16x16x32_bf16 v[172:175], a[188:191], v[40:43], v[172:175]
    ds_read_b64_tr_b16 v[62:63], v11 offset:2560
    v_mfma_f32_16x16x32_bf16 v[176:179], a[56:59], v[44:47], v[176:179]
    v_mfma_f32_16x16x32_bf16 v[180:183], a[60:63], v[44:47], v[180:183]
    buffer_load_dwordx4 v64, s[32:35], s26 offen offset:2048 lds
    v_mfma_f32_16x16x32_bf16 v[184:187], a[184:187], v[44:47], v[184:187]
    v_mfma_f32_16x16x32_bf16 v[188:191], a[188:191], v[44:47], v[188:191]
    s_waitcnt lgkmcnt(4)
    v_mfma_f32_16x16x32_bf16 v[128:131], a[64:67], v[48:51], v[128:131]
    ds_read_b128 a[72:75], v68 offset:0
    v_mfma_f32_16x16x32_bf16 v[132:135], a[68:71], v[48:51], v[132:135]
    ds_read_b128 a[76:79], v68 offset:2048
    buffer_load_dwordx4 v65, s[32:35], s26 offen offset:3072 lds
    s_add_u32 m0, s5, 65536
    s_mul_i32 s26, s22, 3072
    v_mfma_f32_16x16x32_bf16 v[136:139], a[192:195], v[48:51], v[136:139]
    ds_read_b128 a[200:203], v69 offset:0
    v_mfma_f32_16x16x32_bf16 v[140:143], a[196:199], v[48:51], v[140:143]
    ds_read_b128 a[204:207], v69 offset:2048
    v_mfma_f32_16x16x32_bf16 v[144:147], a[64:67], v[52:55], v[144:147]
    ds_read_b64_tr_b16 v[40:41], v8 offset:8192
    v_mfma_f32_16x16x32_bf16 v[148:151], a[68:71], v[52:55], v[148:151]
    ds_read_b64_tr_b16 v[42:43], v8 offset:8704
    buffer_load_dwordx4 v2, s[36:39], s26 offen lds
    v_mfma_f32_16x16x32_bf16 v[152:155], a[192:195], v[52:55], v[152:155]
    ds_read_b64_tr_b16 v[44:45], v11 offset:8192
    v_mfma_f32_16x16x32_bf16 v[156:159], a[196:199], v[52:55], v[156:159]
    ds_read_b64_tr_b16 v[46:47], v11 offset:8704
    s_waitcnt lgkmcnt(8)
    v_mfma_f32_16x16x32_bf16 v[160:163], a[64:67], v[56:59], v[160:163]
    ds_read_b64_tr_b16 v[48:49], v8 offset:10240
    v_mfma_f32_16x16x32_bf16 v[164:167], a[68:71], v[56:59], v[164:167]
    ds_read_b64_tr_b16 v[50:51], v8 offset:10752
    buffer_load_dwordx4 v3, s[36:39], s26 offen offset:1024 lds
    v_mfma_f32_16x16x32_bf16 v[168:171], a[192:195], v[56:59], v[168:171]
    ds_read_b64_tr_b16 v[52:53], v11 offset:10240
    v_mfma_f32_16x16x32_bf16 v[172:175], a[196:199], v[56:59], v[172:175]
    ds_read_b64_tr_b16 v[54:55], v11 offset:10752
    v_mfma_f32_16x16x32_bf16 v[176:179], a[64:67], v[60:63], v[176:179]
    v_mfma_f32_16x16x32_bf16 v[180:183], a[68:71], v[60:63], v[180:183]
    buffer_load_dwordx4 v2, s[40:43], s26 offen offset:2048 lds
    v_mfma_f32_16x16x32_bf16 v[184:187], a[192:195], v[60:63], v[184:187]
    v_mfma_f32_16x16x32_bf16 v[188:191], a[196:199], v[60:63], v[188:191]
    s_waitcnt lgkmcnt(4)
    v_mfma_f32_16x16x32_bf16 v[128:131], a[72:75], v[40:43], v[128:131]
    s_waitcnt vmcnt(7) lgkmcnt(0)
    s_barrier
    v_subrev_u32 v66, 0x20000, v66
    v_subrev_u32 v67, 0x20000, v67
    v_mfma_f32_16x16x32_bf16 v[132:135], a[76:79], v[40:43], v[132:135]
    v_subrev_u32 v68, 0x20000, v68
    v_subrev_u32 v69, 0x20000, v69
    buffer_load_dwordx4 v3, s[40:43], s26 offen offset:3072 lds
    v_mfma_f32_16x16x32_bf16 v[136:139], a[200:203], v[40:43], v[136:139]
    ds_read_b128 a[80:83], v66 offset:16384
    ds_read_b128 a[84:87], v66 offset:18432
    s_add_u32 m0, s5, 81920
    s_lshl_b32 s26, s23, 1
    v_mfma_f32_16x16x32_bf16 v[140:143], a[204:207], v[40:43], v[140:143]
    ds_read_b128 a[208:211], v67 offset:16384
    ds_read_b128 a[212:215], v67 offset:18432
    v_mfma_f32_16x16x32_bf16 v[144:147], a[72:75], v[44:47], v[144:147]
    ds_read_b64_tr_b16 v[56:57], v8 offset:32768
    v_mfma_f32_16x16x32_bf16 v[148:151], a[76:79], v[44:47], v[148:151]
    ds_read_b64_tr_b16 v[58:59], v8 offset:33280
    buffer_load_dwordx4 v64, s[28:31], s26 offen lds
    v_mfma_f32_16x16x32_bf16 v[152:155], a[200:203], v[44:47], v[152:155]
    ds_read_b64_tr_b16 v[60:61], v11 offset:32768
    v_mfma_f32_16x16x32_bf16 v[156:159], a[204:207], v[44:47], v[156:159]
    ds_read_b64_tr_b16 v[62:63], v11 offset:33280
    v_mfma_f32_16x16x32_bf16 v[160:163], a[72:75], v[48:51], v[160:163]
    ds_read_b64_tr_b16 v[40:41], v8 offset:34816
    v_mfma_f32_16x16x32_bf16 v[164:167], a[76:79], v[48:51], v[164:167]
    ds_read_b64_tr_b16 v[42:43], v8 offset:35328
    buffer_load_dwordx4 v65, s[28:31], s26 offen offset:1024 lds
    v_mfma_f32_16x16x32_bf16 v[168:171], a[200:203], v[48:51], v[168:171]
    ds_read_b64_tr_b16 v[44:45], v11 offset:34816
    v_mfma_f32_16x16x32_bf16 v[172:175], a[204:207], v[48:51], v[172:175]
    ds_read_b64_tr_b16 v[46:47], v11 offset:35328
    v_mfma_f32_16x16x32_bf16 v[176:179], a[72:75], v[52:55], v[176:179]
    v_mfma_f32_16x16x32_bf16 v[180:183], a[76:79], v[52:55], v[180:183]
    buffer_load_dwordx4 v64, s[32:35], s26 offen offset:2048 lds
    v_mfma_f32_16x16x32_bf16 v[184:187], a[200:203], v[52:55], v[184:187]
    v_mfma_f32_16x16x32_bf16 v[188:191], a[204:207], v[52:55], v[188:191]
    s_waitcnt lgkmcnt(4)
    v_mfma_f32_16x16x32_bf16 v[128:131], a[80:83], v[56:59], v[128:131]
    ds_read_b128 a[88:91], v68 offset:16384
    v_mfma_f32_16x16x32_bf16 v[132:135], a[84:87], v[56:59], v[132:135]
    ds_read_b128 a[92:95], v68 offset:18432
    buffer_load_dwordx4 v65, s[32:35], s26 offen offset:3072 lds
    s_add_u32 m0, s5, 98304
    s_mul_i32 s26, s23, 3072
    v_mfma_f32_16x16x32_bf16 v[136:139], a[208:211], v[56:59], v[136:139]
    ds_read_b128 a[216:219], v69 offset:16384
    v_mfma_f32_16x16x32_bf16 v[140:143], a[212:215], v[56:59], v[140:143]
    ds_read_b128 a[220:223], v69 offset:18432
    v_mfma_f32_16x16x32_bf16 v[144:147], a[80:83], v[60:63], v[144:147]
    ds_read_b64_tr_b16 v[48:49], v8 offset:40960
    v_mfma_f32_16x16x32_bf16 v[148:151], a[84:87], v[60:63], v[148:151]
    ds_read_b64_tr_b16 v[50:51], v8 offset:41472
    buffer_load_dwordx4 v2, s[36:39], s26 offen lds
    v_mfma_f32_16x16x32_bf16 v[152:155], a[208:211], v[60:63], v[152:155]
    ds_read_b64_tr_b16 v[52:53], v11 offset:40960
    v_mfma_f32_16x16x32_bf16 v[156:159], a[212:215], v[60:63], v[156:159]
    ds_read_b64_tr_b16 v[54:55], v11 offset:41472
    s_waitcnt lgkmcnt(8)
    v_mfma_f32_16x16x32_bf16 v[160:163], a[80:83], v[40:43], v[160:163]
    ds_read_b64_tr_b16 v[56:57], v8 offset:43008
    v_mfma_f32_16x16x32_bf16 v[164:167], a[84:87], v[40:43], v[164:167]
    ds_read_b64_tr_b16 v[58:59], v8 offset:43520
    buffer_load_dwordx4 v3, s[36:39], s26 offen offset:1024 lds
    v_mfma_f32_16x16x32_bf16 v[168:171], a[208:211], v[40:43], v[168:171]
    ds_read_b64_tr_b16 v[60:61], v11 offset:43008
    v_mfma_f32_16x16x32_bf16 v[172:175], a[212:215], v[40:43], v[172:175]
    ds_read_b64_tr_b16 v[62:63], v11 offset:43520
    v_mfma_f32_16x16x32_bf16 v[176:179], a[80:83], v[44:47], v[176:179]
    v_mfma_f32_16x16x32_bf16 v[180:183], a[84:87], v[44:47], v[180:183]
    buffer_load_dwordx4 v2, s[40:43], s26 offen offset:2048 lds
    v_mfma_f32_16x16x32_bf16 v[184:187], a[208:211], v[44:47], v[184:187]
    v_mfma_f32_16x16x32_bf16 v[188:191], a[212:215], v[44:47], v[188:191]
    s_waitcnt lgkmcnt(4)
    v_mfma_f32_16x16x32_bf16 v[128:131], a[88:91], v[48:51], v[128:131]
    s_waitcnt vmcnt(7) lgkmcnt(0)
    s_barrier
    ds_read_b128 a[96:99], v66 offset:49152
    v_mfma_f32_16x16x32_bf16 v[132:135], a[92:95], v[48:51], v[132:135]
    ds_read_b128 a[100:103], v66 offset:51200
    buffer_load_dwordx4 v3, s[40:43], s26 offen offset:3072 lds
    v_mfma_f32_16x16x32_bf16 v[136:139], a[216:219], v[48:51], v[136:139]
    ds_read_b128 a[224:227], v67 offset:49152
    s_and_b32 s26, s2, 127
    s_lshl2_add_u32 s26, s26, s4
    s_mul_i32 s26, s26, 3072
    v_mfma_f32_16x16x32_bf16 v[140:143], a[220:223], v[48:51], v[140:143]
    ds_read_b128 a[228:231], v67 offset:51200
    v_lshrrev_b32 v104, 4, v1
    v_cmp_gt_u32 vcc, 8, v104
    v_mul_u32_u24 v104, 128, v104
    v_mov_b32 v105, 0x7fff0000
    v_cndmask_b32 v104, v105, v104, vcc
    v_mfma_f32_16x16x32_bf16 v[144:147], a[88:91], v[52:55], v[144:147]
    ds_read_b64_tr_b16 v[40:41], v9 offset:0
    s_sub_u32 s26, s26, s7
    v_mfma_f32_16x16x32_bf16 v[148:151], a[92:95], v[52:55], v[148:151]
    ds_read_b64_tr_b16 v[42:43], v9 offset:512
    buffer_load_dword v17, v104, s[40:43], s26 offen
    s_add_u32 m0, s5, 114688
    s_mul_i32 s26, s16, 3584
    v_mfma_f32_16x16x32_bf16 v[152:155], a[216:219], v[52:55], v[152:155]
    ds_read_b64_tr_b16 v[44:45], v12 offset:0
    v_mfma_f32_16x16x32_bf16 v[156:159], a[220:223], v[52:55], v[156:159]
    ds_read_b64_tr_b16 v[46:47], v12 offset:512
    v_mfma_f32_16x16x32_bf16 v[160:163], a[88:91], v[56:59], v[160:163]
    ds_read_b64_tr_b16 v[48:49], v9 offset:2048
    v_mfma_f32_16x16x32_bf16 v[164:167], a[92:95], v[56:59], v[164:167]
    ds_read_b64_tr_b16 v[50:51], v9 offset:2560
    buffer_load_dwordx4 v4, s[44:47], s26 offen lds
    v_mfma_f32_16x16x32_bf16 v[168:171], a[216:219], v[56:59], v[168:171]
    ds_read_b64_tr_b16 v[52:53], v12 offset:2048
    v_mfma_f32_16x16x32_bf16 v[172:175], a[220:223], v[56:59], v[172:175]
    ds_read_b64_tr_b16 v[54:55], v12 offset:2560
    v_mfma_f32_16x16x32_bf16 v[176:179], a[88:91], v[60:63], v[176:179]
    v_mfma_f32_16x16x32_bf16 v[180:183], a[92:95], v[60:63], v[180:183]
    buffer_load_dwordx4 v5, s[44:47], s26 offen offset:1024 lds
    v_mfma_f32_16x16x32_bf16 v[184:187], a[216:219], v[60:63], v[184:187]
    v_mfma_f32_16x16x32_bf16 v[188:191], a[220:223], v[60:63], v[188:191]
    s_waitcnt lgkmcnt(4)
    v_mfma_f32_16x16x32_bf16 v[128:131], a[96:99], v[40:43], v[128:131]
    ds_read_b128 a[104:107], v68 offset:49152
    v_mfma_f32_16x16x32_bf16 v[132:135], a[100:103], v[40:43], v[132:135]
    ds_read_b128 a[108:111], v68 offset:51200
    buffer_load_dwordx4 v4, s[48:51], s26 offen offset:2048 lds
    v_mfma_f32_16x16x32_bf16 v[136:139], a[224:227], v[40:43], v[136:139]
    ds_read_b128 a[232:235], v69 offset:49152
    v_mfma_f32_16x16x32_bf16 v[140:143], a[228:231], v[40:43], v[140:143]
    ds_read_b128 a[236:239], v69 offset:51200
    v_mfma_f32_16x16x32_bf16 v[144:147], a[96:99], v[44:47], v[144:147]
    ds_read_b64_tr_b16 v[56:57], v9 offset:8192
    v_mfma_f32_16x16x32_bf16 v[148:151], a[100:103], v[44:47], v[148:151]
    ds_read_b64_tr_b16 v[58:59], v9 offset:8704
    buffer_load_dwordx4 v5, s[48:51], s26 offen offset:3072 lds
    s_add_u32 m0, s5, 131072
    s_mul_i32 s26, s17, 3584
    v_mfma_f32_16x16x32_bf16 v[152:155], a[224:227], v[44:47], v[152:155]
    ds_read_b64_tr_b16 v[60:61], v12 offset:8192
    v_mfma_f32_16x16x32_bf16 v[156:159], a[228:231], v[44:47], v[156:159]
    ds_read_b64_tr_b16 v[62:63], v12 offset:8704
    s_waitcnt lgkmcnt(8)
    v_mfma_f32_16x16x32_bf16 v[160:163], a[96:99], v[48:51], v[160:163]
    ds_read_b64_tr_b16 v[40:41], v9 offset:10240
    v_mfma_f32_16x16x32_bf16 v[164:167], a[100:103], v[48:51], v[164:167]
    ds_read_b64_tr_b16 v[42:43], v9 offset:10752
    buffer_load_dwordx4 v4, s[44:47], s26 offen lds
    v_mfma_f32_16x16x32_bf16 v[168:171], a[224:227], v[48:51], v[168:171]
    ds_read_b64_tr_b16 v[44:45], v12 offset:10240
    v_mfma_f32_16x16x32_bf16 v[172:175], a[228:231], v[48:51], v[172:175]
    ds_read_b64_tr_b16 v[46:47], v12 offset:10752
    v_mfma_f32_16x16x32_bf16 v[176:179], a[96:99], v[52:55], v[176:179]
    v_mfma_f32_16x16x32_bf16 v[180:183], a[100:103], v[52:55], v[180:183]
    buffer_load_dwordx4 v5, s[44:47], s26 offen offset:1024 lds
    v_mfma_f32_16x16x32_bf16 v[184:187], a[224:227], v[52:55], v[184:187]
    v_mfma_f32_16x16x32_bf16 v[188:191], a[228:231], v[52:55], v[188:191]
    s_waitcnt lgkmcnt(4)
    v_mfma_f32_16x16x32_bf16 v[128:131], a[104:107], v[56:59], v[128:131]
    s_waitcnt vmcnt(7) lgkmcnt(0)
    s_barrier
    v_add_u32 v66, 0x10000, v66
    v_add_u32 v67, 0x10000, v67
    v_mfma_f32_16x16x32_bf16 v[132:135], a[108:111], v[56:59], v[132:135]
    v_add_u32 v68, 0x10000, v68
    v_add_u32 v69, 0x10000, v69
    buffer_load_dwordx4 v4, s[48:51], s26 offen offset:2048 lds
    v_mfma_f32_16x16x32_bf16 v[136:139], a[232:235], v[56:59], v[136:139]
    ds_read_b128 a[112:115], v66 offset:16384
    ds_read_b128 a[116:119], v66 offset:18432
    v_mfma_f32_16x16x32_bf16 v[140:143], a[236:239], v[56:59], v[140:143]
    ds_read_b128 a[240:243], v67 offset:16384
    ds_read_b128 a[244:247], v67 offset:18432
    v_mfma_f32_16x16x32_bf16 v[144:147], a[104:107], v[60:63], v[144:147]
    ds_read_b64_tr_b16 v[48:49], v9 offset:32768
    v_mfma_f32_16x16x32_bf16 v[148:151], a[108:111], v[60:63], v[148:151]
    ds_read_b64_tr_b16 v[50:51], v9 offset:33280
    buffer_load_dwordx4 v5, s[48:51], s26 offen offset:3072 lds
    s_add_u32 m0, s5, 0
    s_mul_i32 s26, s18, 3584
    v_mfma_f32_16x16x32_bf16 v[152:155], a[232:235], v[60:63], v[152:155]
    ds_read_b64_tr_b16 v[52:53], v12 offset:32768
    v_mfma_f32_16x16x32_bf16 v[156:159], a[236:239], v[60:63], v[156:159]
    ds_read_b64_tr_b16 v[54:55], v12 offset:33280
    v_mfma_f32_16x16x32_bf16 v[160:163], a[104:107], v[40:43], v[160:163]
    ds_read_b64_tr_b16 v[56:57], v9 offset:34816
    v_mfma_f32_16x16x32_bf16 v[164:167], a[108:111], v[40:43], v[164:167]
    ds_read_b64_tr_b16 v[58:59], v9 offset:35328
    buffer_load_dwordx4 v4, s[44:47], s26 offen lds
    v_mfma_f32_16x16x32_bf16 v[168:171], a[232:235], v[40:43], v[168:171]
    ds_read_b64_tr_b16 v[60:61], v12 offset:34816
    v_mfma_f32_16x16x32_bf16 v[172:175], a[236:239], v[40:43], v[172:175]
    ds_read_b64_tr_b16 v[62:63], v12 offset:35328
    v_mfma_f32_16x16x32_bf16 v[176:179], a[104:107], v[44:47], v[176:179]
    v_mfma_f32_16x16x32_bf16 v[180:183], a[108:111], v[44:47], v[180:183]
    buffer_load_dwordx4 v5, s[44:47], s26 offen offset:1024 lds
    v_mfma_f32_16x16x32_bf16 v[184:187], a[232:235], v[44:47], v[184:187]
    v_mfma_f32_16x16x32_bf16 v[188:191], a[236:239], v[44:47], v[188:191]
    s_waitcnt lgkmcnt(4)
    v_mfma_f32_16x16x32_bf16 v[128:131], a[112:115], v[48:51], v[128:131]
    ds_read_b128 a[120:123], v68 offset:16384
    v_mfma_f32_16x16x32_bf16 v[132:135], a[116:119], v[48:51], v[132:135]
    ds_read_b128 a[124:127], v68 offset:18432
    buffer_load_dwordx4 v4, s[48:51], s26 offen offset:2048 lds
    v_mfma_f32_16x16x32_bf16 v[136:139], a[240:243], v[48:51], v[136:139]
    ds_read_b128 a[248:251], v69 offset:16384
    v_mfma_f32_16x16x32_bf16 v[140:143], a[244:247], v[48:51], v[140:143]
    ds_read_b128 a[252:255], v69 offset:18432
    v_mfma_f32_16x16x32_bf16 v[144:147], a[112:115], v[52:55], v[144:147]
    ds_read_b64_tr_b16 v[40:41], v9 offset:40960
    v_mfma_f32_16x16x32_bf16 v[148:151], a[116:119], v[52:55], v[148:151]
    ds_read_b64_tr_b16 v[42:43], v9 offset:41472
    buffer_load_dwordx4 v5, s[48:51], s26 offen offset:3072 lds
    s_add_u32 m0, s5, 16384
    s_mul_i32 s26, s19, 3584
    v_mfma_f32_16x16x32_bf16 v[152:155], a[240:243], v[52:55], v[152:155]
    ds_read_b64_tr_b16 v[44:45], v12 offset:40960
    v_mfma_f32_16x16x32_bf16 v[156:159], a[244:247], v[52:55], v[156:159]
    ds_read_b64_tr_b16 v[46:47], v12 offset:41472
    s_waitcnt lgkmcnt(8)
    v_mfma_f32_16x16x32_bf16 v[160:163], a[112:115], v[56:59], v[160:163]
    ds_read_b64_tr_b16 v[48:49], v9 offset:43008
    v_mfma_f32_16x16x32_bf16 v[164:167], a[116:119], v[56:59], v[164:167]
    ds_read_b64_tr_b16 v[50:51], v9 offset:43520
    buffer_load_dwordx4 v4, s[44:47], s26 offen lds
    v_mfma_f32_16x16x32_bf16 v[168:171], a[240:243], v[56:59], v[168:171]
    ds_read_b64_tr_b16 v[52:53], v12 offset:43008
    v_mfma_f32_16x16x32_bf16 v[172:175], a[244:247], v[56:59], v[172:175]
    ds_read_b64_tr_b16 v[54:55], v12 offset:43520
    v_mfma_f32_16x16x32_bf16 v[176:179], a[112:115], v[60:63], v[176:179]
    v_mfma_f32_16x16x32_bf16 v[180:183], a[116:119], v[60:63], v[180:183]
    buffer_load_dwordx4 v5, s[44:47], s26 offen offset:1024 lds
    v_mfma_f32_16x16x32_bf16 v[184:187], a[240:243], v[60:63], v[184:187]
    v_mfma_f32_16x16x32_bf16 v[188:191], a[244:247], v[60:63], v[188:191]
    s_waitcnt lgkmcnt(4)
    v_mfma_f32_16x16x32_bf16 v[128:131], a[120:123], v[40:43], v[128:131]
    s_waitcnt vmcnt(10) lgkmcnt(0)
    s_barrier
    ds_read_b64_tr_b16 v[56:57], v9 offset:49152
    v_mfma_f32_16x16x32_bf16 v[132:135], a[124:127], v[40:43], v[132:135]
    ds_read_b64_tr_b16 v[58:59], v9 offset:49664
    buffer_load_dwordx4 v4, s[48:51], s26 offen offset:2048 lds
    v_mfma_f32_16x16x32_bf16 v[136:139], a[248:251], v[40:43], v[136:139]
    ds_read_b64_tr_b16 v[60:61], v12 offset:49152
    v_mfma_f32_16x16x32_bf16 v[140:143], a[252:255], v[40:43], v[140:143]
    ds_read_b64_tr_b16 v[62:63], v12 offset:49664
    v_mfma_f32_16x16x32_bf16 v[144:147], a[120:123], v[44:47], v[144:147]
    v_mfma_f32_16x16x32_bf16 v[148:151], a[124:127], v[44:47], v[148:151]
    buffer_load_dwordx4 v5, s[48:51], s26 offen offset:3072 lds
    s_add_u32 m0, s5, 32768
    s_mul_i32 s26, s20, 3584
    v_mfma_f32_16x16x32_bf16 v[152:155], a[248:251], v[44:47], v[152:155]
    v_mfma_f32_16x16x32_bf16 v[156:159], a[252:255], v[44:47], v[156:159]
    v_mfma_f32_16x16x32_bf16 v[160:163], a[120:123], v[48:51], v[160:163]
    ds_read_b64_tr_b16 v[40:41], v9 offset:51200
    v_mfma_f32_16x16x32_bf16 v[164:167], a[124:127], v[48:51], v[164:167]
    ds_read_b64_tr_b16 v[42:43], v9 offset:51712
    buffer_load_dword v35, v37, s[76:79], 0 offen offset:128 sc1
    v_mfma_f32_16x16x32_bf16 v[168:171], a[248:251], v[48:51], v[168:171]
    ds_read_b64_tr_b16 v[44:45], v12 offset:51200
    v_mfma_f32_16x16x32_bf16 v[172:175], a[252:255], v[48:51], v[172:175]
    ds_read_b64_tr_b16 v[46:47], v12 offset:51712
    v_mfma_f32_16x16x32_bf16 v[176:179], a[120:123], v[52:55], v[176:179]
    v_mfma_f32_16x16x32_bf16 v[180:183], a[124:127], v[52:55], v[180:183]
    buffer_load_dwordx4 v4, s[44:47], s26 offen lds
    v_mfma_f32_16x16x32_bf16 v[184:187], a[248:251], v[52:55], v[184:187]
    v_mfma_f32_16x16x32_bf16 v[188:191], a[252:255], v[52:55], v[188:191]
    s_waitcnt lgkmcnt(4)
    v_mfma_f32_16x16x32_bf16 v[192:195], v[56:59], a[0:3], 0
    ds_read_b64_tr_b16 v[48:49], v9 offset:57344
    v_mov_b32 v96, 0x3f803f80
    v_mov_b32 v97, 0x3f803f80
    v_mov_b32 v98, 0x3f803f80
    v_mov_b32 v99, 0x3f803f80
    v_mfma_f32_16x16x32_bf16 v[200:203], v[56:59], a[4:7], 0
    ds_read_b64_tr_b16 v[50:51], v9 offset:57856
    buffer_load_dwordx4 v5, s[44:47], s26 offen offset:1024 lds
    v_cvt_pk_bf16_f32 v160, v160, v161
    v_cvt_pk_bf16_f32 v161, v162, v163
    v_cvt_pk_bf16_f32 v162, v164, v165
    v_mfma_f32_16x16x32_bf16 v[208:211], v[56:59], a[128:131], 0
    ds_read_b64_tr_b16 v[52:53], v12 offset:57344
    v_cvt_pk_bf16_f32 v163, v166, v167
    v_cvt_pk_bf16_f32 v164, v168, v169
    v_cvt_pk_bf16_f32 v165, v170, v171
    v_cvt_pk_bf16_f32 v166, v172, v173
    v_mfma_f32_16x16x32_bf16 v[216:219], v[56:59], a[132:135], 0
    ds_read_b64_tr_b16 v[54:55], v12 offset:57856
    v_cvt_pk_bf16_f32 v167, v174, v175
    v_mul_f32 v120, 0x3fb8aa3b, v128
    v_mul_f32 v121, 0x3fb8aa3b, v129
    v_mul_f32 v122, 0x3fb8aa3b, v130
    v_mfma_f32_16x16x32_bf16 v[196:199], v[60:63], a[0:3], 0
    v_mul_f32 v123, 0x3fb8aa3b, v131
    v_exp_f32 v120, v120 clamp
    v_exp_f32 v121, v121 clamp
    v_mfma_f32_16x16x32_bf16 v[204:207], v[60:63], a[4:7], 0
    buffer_load_dwordx4 v4, s[48:51], s26 offen offset:2048 lds
    v_exp_f32 v122, v122 clamp
    v_exp_f32 v123, v123 clamp
    v_mfma_f32_16x16x32_bf16 v[212:215], v[60:63], a[128:131], 0
    v_max_f32 v128, 0x358637bd, v128
    v_max_f32 v129, 0x358637bd, v129
    v_max_f32 v130, 0x358637bd, v130
    v_max_f32 v131, 0x358637bd, v131
    v_add_f32 v128, v128, v120
    v_mfma_f32_16x16x32_bf16 v[220:223], v[60:63], a[132:135], 0
    v_add_f32 v129, v129, v121
    v_add_f32 v130, v130, v122
    v_add_f32 v131, v131, v123
    v_cvt_pk_bf16_f32 v128, v128, v129
    s_waitcnt lgkmcnt(4)
    v_mfma_f32_16x16x32_bf16 v[224:227], v[40:43], a[0:3], 0
    ds_read_b64_tr_b16 v[56:57], v9 offset:59392
    v_cvt_pk_bf16_f32 v129, v130, v131
    v_mul_f32 v124, 0x3fb8aa3b, v132
    v_mul_f32 v125, 0x3fb8aa3b, v133
    v_mul_f32 v126, 0x3fb8aa3b, v134
    v_mfma_f32_16x16x32_bf16 v[232:235], v[40:43], a[4:7], 0
    ds_read_b64_tr_b16 v[58:59], v9 offset:59904
    buffer_load_dwordx4 v5, s[48:51], s26 offen offset:3072 lds
    s_add_u32 m0, s5, 49152
    s_mul_i32 s26, s21, 3584
    v_mul_f32 v127, 0x3fb8aa3b, v135
    v_mfma_f32_16x16x32_bf16 v[240:243], v[40:43], a[128:131], 0
    ds_read_b64_tr_b16 v[60:61], v12 offset:59392
    v_exp_f32 v124, v124 clamp
    v_exp_f32 v125, v125 clamp
    v_mfma_f32_16x16x32_bf16 v[248:251], v[40:43], a[132:135], 0
    ds_read_b64_tr_b16 v[62:63], v12 offset:59904
    v_exp_f32 v126, v126 clamp
    v_exp_f32 v127, v127 clamp
    v_mfma_f32_16x16x32_bf16 v[228:231], v[44:47], a[0:3], 0
    v_max_f32 v132, 0x358637bd, v132
    v_max_f32 v133, 0x358637bd, v133
    v_max_f32 v134, 0x358637bd, v134
    v_max_f32 v135, 0x358637bd, v135
    v_add_f32 v132, v132, v124
    v_mfma_f32_16x16x32_bf16 v[236:239], v[44:47], a[4:7], 0
    buffer_load_dwordx4 v4, s[44:47], s26 offen lds
    v_add_f32 v133, v133, v125
    v_add_f32 v134, v134, v126
    v_add_f32 v135, v135, v127
    v_cvt_pk_bf16_f32 v130, v132, v133
    v_mfma_f32_16x16x32_bf16 v[244:247], v[44:47], a[128:131], 0
    v_cvt_pk_bf16_f32 v131, v134, v135
    v_mul_f32 v120, 0x3fb8aa3b, v136
    v_mul_f32 v121, 0x3fb8aa3b, v137
    v_mul_f32 v122, 0x3fb8aa3b, v138
    v_mul_f32 v123, 0x3fb8aa3b, v139
    v_mfma_f32_16x16x32_bf16 v[252:255], v[44:47], a[132:135], 0
    v_exp_f32 v120, v120 clamp
    v_exp_f32 v121, v121 clamp
    s_waitcnt lgkmcnt(4)
    v_mfma_f32_16x16x32_bf16 v[192:195], v[48:51], a[8:11], v[192:195]
    s_waitcnt vmcnt(14) lgkmcnt(0)
    s_barrier
    ds_read_b64_tr_b16 v[40:41], v10 offset:0
    v_exp_f32 v122, v122 clamp
    v_mfma_f32_16x16x32_bf16 v[200:203], v[48:51], a[12:15], v[200:203]
    ds_read_b64_tr_b16 v[42:43], v10 offset:512
    buffer_load_dwordx4 v5, s[44:47], s26 offen offset:1024 lds
    v_exp_f32 v123, v123 clamp
    v_max_f32 v136, 0x358637bd, v136
    v_mfma_f32_16x16x32_bf16 v[208:211], v[48:51], a[136:139], v[208:211]
    ds_read_b64_tr_b16 v[44:45], v13 offset:0
    v_max_f32 v137, 0x358637bd, v137
    v_max_f32 v138, 0x358637bd, v138
    v_max_f32 v139, 0x358637bd, v139
    v_add_f32 v136, v136, v120
    v_mfma_f32_16x16x32_bf16 v[216:219], v[48:51], a[140:143], v[216:219]
    ds_read_b64_tr_b16 v[46:47], v13 offset:512
    v_add_f32 v137, v137, v121
    v_add_f32 v138, v138, v122
    v_add_f32 v139, v139, v123
    v_cvt_pk_bf16_f32 v132, v136, v137
    v_mfma_f32_16x16x32_bf16 v[196:199], v[52:55], a[8:11], v[196:199]
    v_cvt_pk_bf16_f32 v133, v138, v139
    v_mul_f32 v124, 0x3fb8aa3b, v140
    v_mul_f32 v125, 0x3fb8aa3b, v141
    v_mul_f32 v126, 0x3fb8aa3b, v142
    v_mul_f32 v127, 0x3fb8aa3b, v143
    v_mfma_f32_16x16x32_bf16 v[204:207], v[52:55], a[12:15], v[204:207]
    buffer_load_dwordx4 v4, s[48:51], s26 offen offset:2048 lds
    v_exp_f32 v124, v124 clamp
    v_exp_f32 v125, v125 clamp
    v_mfma_f32_16x16x32_bf16 v[212:215], v[52:55], a[136:139], v[212:215]
    v_exp_f32 v126, v126 clamp
    v_exp_f32 v127, v127 clamp
    v_max_f32 v140, 0x358637bd, v140
    v_mfma_f32_16x16x32_bf16 v[220:223], v[52:55], a[140:143], v[220:223]
    v_max_f32 v141, 0x358637bd, v141
    v_max_f32 v142, 0x358637bd, v142
    v_max_f32 v143, 0x358637bd, v143
    v_add_f32 v140, v140, v124
    v_mfma_f32_16x16x32_bf16 v[224:227], v[56:59], a[8:11], v[224:227]
    ds_read_b64_tr_b16 v[48:49], v10 offset:2048
    v_add_f32 v141, v141, v125
    v_add_f32 v142, v142, v126
    v_add_f32 v143, v143, v127
    v_cvt_pk_bf16_f32 v134, v140, v141
    v_mfma_f32_16x16x32_bf16 v[232:235], v[56:59], a[12:15], v[232:235]
    ds_read_b64_tr_b16 v[50:51], v10 offset:2560
    buffer_load_dwordx4 v5, s[48:51], s26 offen offset:3072 lds
    s_add_u32 m0, s5, 65536
    s_mul_i32 s26, s22, 3584
    v_cvt_pk_bf16_f32 v135, v142, v143
    v_mfma_f32_16x16x32_bf16 v[240:243], v[56:59], a[136:139], v[240:243]
    ds_read_b64_tr_b16 v[52:53], v13 offset:2048
    v_mfma_f32_16x16x32_bf16 v[64:67], v[128:131], v[160:163], 0
    v_mfma_f32_16x16x32_bf16 v[248:251], v[56:59], a[140:143], v[248:251]
    ds_read_b64_tr_b16 v[54:55], v13 offset:2560
    s_waitcnt vmcnt(8)
    v_cmp_eq_u32 vcc, 0, v35
    s_nop 0
    s_and_b32 s91, vcc_lo, -1
    s_cbranch_scc1 LA_poll0_retry
LA_poll0_ok:
    v_mfma_f32_16x16x32_bf16 v[228:231], v[60:63], a[8:11], v[228:231]
    s_add_u32 s32, s52, s15
    s_addc_u32 s33, s53, 0
    s_mov_b32 s34, 294912
    v_mfma_f32_16x16x32_bf16 v[236:239], v[60:63], a[12:15], v[236:239]
    buffer_load_dwordx4 v4, s[44:47], s26 offen lds
    v_mfma_f32_16x16x32_bf16 v[80:83], v[96:99], v[128:131], 0
    v_mfma_f32_16x16x32_bf16 v[244:247], v[60:63], a[136:139], v[244:247]
    v_mfma_f32_16x16x32_bf16 v[64:67], v[132:135], v[164:167], v[64:67]
    v_mfma_f32_16x16x32_bf16 v[252:255], v[60:63], a[140:143], v[252:255]
    v_mfma_f32_16x16x32_bf16 v[80:83], v[96:99], v[132:135], v[80:83]
    s_waitcnt lgkmcnt(4)
    v_mfma_f32_16x16x32_bf16 v[192:195], v[40:43], a[16:19], v[192:195]
    ds_read_b64_tr_b16 v[56:57], v10 offset:8192
    v_cvt_pk_bf16_f32 v176, v176, v177
    v_cvt_pk_bf16_f32 v177, v178, v179
    v_cvt_pk_bf16_f32 v178, v180, v181
    v_cvt_pk_bf16_f32 v179, v182, v183
    v_mfma_f32_16x16x32_bf16 v[200:203], v[40:43], a[20:23], v[200:203]
    ds_read_b64_tr_b16 v[58:59], v10 offset:8704
    buffer_load_dwordx4 v5, s[44:47], s26 offen offset:1024 lds
    v_cvt_pk_bf16_f32 v180, v184, v185
    v_cvt_pk_bf16_f32 v181, v186, v187
    v_cvt_pk_bf16_f32 v182, v188, v189
    v_mfma_f32_16x16x32_bf16 v[208:211], v[40:43], a[144:147], v[208:211]
    ds_read_b64_tr_b16 v[60:61], v13 offset:8192
    v_cvt_pk_bf16_f32 v183, v190, v191
    v_mul_f32 v120, 0x3fb8aa3b, v144
    v_mul_f32 v121, 0x3fb8aa3b, v145
    v_mul_f32 v122, 0x3fb8aa3b, v146
    v_mfma_f32_16x16x32_bf16 v[216:219], v[40:43], a[148:151], v[216:219]
    ds_read_b64_tr_b16 v[62:63], v13 offset:8704
    v_mul_f32 v123, 0x3fb8aa3b, v147
    v_exp_f32 v120, v120 clamp
    v_mfma_f32_16x16x32_bf16 v[196:199], v[44:47], a[16:19], v[196:199]
    v_exp_f32 v121, v121 clamp
    v_exp_f32 v122, v122 clamp
    v_mfma_f32_16x16x32_bf16 v[204:207], v[44:47], a[20:23], v[204:207]
    buffer_load_dwordx4 v4, s[48:51], s26 offen offset:2048 lds
    v_exp_f32 v123, v123 clamp
    v_max_f32 v144, 0x358637bd, v144
    v_max_f32 v145, 0x358637bd, v145
    v_mfma_f32_16x16x32_bf16 v[212:215], v[44:47], a[144:147], v[212:215]
    v_max_f32 v146, 0x358637bd, v146
    v_max_f32 v147, 0x358637bd, v147
    v_add_f32 v144, v144, v120
    v_add_f32 v145, v145, v121
    v_add_f32 v146, v146, v122
    v_mfma_f32_16x16x32_bf16 v[220:223], v[44:47], a[148:151], v[220:223]
    v_add_f32 v147, v147, v123
    v_cvt_pk_bf16_f32 v144, v144, v145
    v_cvt_pk_bf16_f32 v145, v146, v147
    v_mul_f32 v124, 0x3fb8aa3b, v148
    s_waitcnt lgkmcnt(4)
    v_mfma_f32_16x16x32_bf16 v[224:227], v[48:51], a[16:19], v[224:227]
    ds_read_b64_tr_b16 v[40:41], v10 offset:10240
    v_mul_f32 v125, 0x3fb8aa3b, v149
    v_mul_f32 v126, 0x3fb8aa3b, v150
    v_mul_f32 v127, 0x3fb8aa3b, v151
    v_mfma_f32_16x16x32_bf16 v[232:235], v[48:51], a[20:23], v[232:235]
    ds_read_b64_tr_b16 v[42:43], v10 offset:10752
    buffer_load_dwordx4 v5, s[48:51], s26 offen offset:3072 lds
    s_add_u32 m0, s5, 81920
    s_mul_i32 s26, s23, 3584
    v_mfma_f32_16x16x32_bf16 v[240:243], v[48:51], a[144:147], v[240:243]
    ds_read_b64_tr_b16 v[44:45], v13 offset:10240
    v_exp_f32 v124, v124 clamp
    v_exp_f32 v125, v125 clamp
    v_mfma_f32_16x16x32_bf16 v[248:251], v[48:51], a[148:151], v[248:251]
    ds_read_b64_tr_b16 v[46:47], v13 offset:10752
    v_exp_f32 v126, v126 clamp
    v_exp_f32 v127, v127 clamp
    v_mfma_f32_16x16x32_bf16 v[228:231], v[52:55], a[16:19], v[228:231]
    v_max_f32 v148, 0x358637bd, v148
    v_max_f32 v149, 0x358637bd, v149
    v_max_f32 v150, 0x358637bd, v150
    v_max_f32 v151, 0x358637bd, v151
    v_add_f32 v148, v148, v124
    v_mfma_f32_16x16x32_bf16 v[236:239], v[52:55], a[20:23], v[236:239]
    buffer_load_dwordx4 v4, s[44:47], s26 offen lds
    v_add_f32 v149, v149, v125
    v_add_f32 v150, v150, v126
    v_add_f32 v151, v151, v127
    v_cvt_pk_bf16_f32 v146, v148, v149
    v_mfma_f32_16x16x32_bf16 v[244:247], v[52:55], a[144:147], v[244:247]
    v_cvt_pk_bf16_f32 v147, v150, v151
    v_mul_f32 v120, 0x3fb8aa3b, v152
    v_mul_f32 v121, 0x3fb8aa3b, v153
    v_mul_f32 v122, 0x3fb8aa3b, v154
    v_mul_f32 v123, 0x3fb8aa3b, v155
    v_mfma_f32_16x16x32_bf16 v[252:255], v[52:55], a[148:151], v[252:255]
    v_exp_f32 v120, v120 clamp
    v_exp_f32 v121, v121 clamp
    s_waitcnt lgkmcnt(4)
    v_mfma_f32_16x16x32_bf16 v[192:195], v[56:59], a[24:27], v[192:195]
    s_waitcnt lgkmcnt(0)
    s_barrier
    ds_read_b64_tr_b16 v[48:49], v8 offset:0
    v_exp_f32 v122, v122 clamp
    v_mfma_f32_16x16x32_bf16 v[200:203], v[56:59], a[28:31], v[200:203]
    ds_read_b64_tr_b16 v[50:51], v8 offset:512
    buffer_load_dwordx4 v5, s[44:47], s26 offen offset:1024 lds
    v_exp_f32 v123, v123 clamp
    v_max_f32 v152, 0x358637bd, v152
    v_mfma_f32_16x16x32_bf16 v[208:211], v[56:59], a[152:155], v[208:211]
    ds_read_b64_tr_b16 v[52:53], v11 offset:0
    v_max_f32 v153, 0x358637bd, v153
    v_max_f32 v154, 0x358637bd, v154
    v_max_f32 v155, 0x358637bd, v155
    v_add_f32 v152, v152, v120
    v_mfma_f32_16x16x32_bf16 v[216:219], v[56:59], a[156:159], v[216:219]
    ds_read_b64_tr_b16 v[54:55], v11 offset:512
    v_add_f32 v153, v153, v121
    v_add_f32 v154, v154, v122
    v_add_f32 v155, v155, v123
    v_cvt_pk_bf16_f32 v148, v152, v153
    v_mfma_f32_16x16x32_bf16 v[196:199], v[60:63], a[24:27], v[196:199]
    v_cvt_pk_bf16_f32 v149, v154, v155
    v_mul_f32 v124, 0x3fb8aa3b, v156
    v_mul_f32 v125, 0x3fb8aa3b, v157
    v_mul_f32 v126, 0x3fb8aa3b, v158
    v_mul_f32 v127, 0x3fb8aa3b, v159
    v_mfma_f32_16x16x32_bf16 v[204:207], v[60:63], a[28:31], v[204:207]
    buffer_load_dwordx4 v4, s[48:51], s26 offen offset:2048 lds
    v_exp_f32 v124, v124 clamp
    v_exp_f32 v125, v125 clamp
    v_mfma_f32_16x16x32_bf16 v[212:215], v[60:63], a[152:155], v[212:215]
    v_exp_f32 v126, v126 clamp
    v_exp_f32 v127, v127 clamp
    v_max_f32 v156, 0x358637bd, v156
    v_mfma_f32_16x16x32_bf16 v[220:223], v[60:63], a[156:159], v[220:223]
    v_max_f32 v157, 0x358637bd, v157
    v_max_f32 v158, 0x358637bd, v158
    v_max_f32 v159, 0x358637bd, v159
    v_add_f32 v156, v156, v124
    v_mfma_f32_16x16x32_bf16 v[224:227], v[40:43], a[24:27], v[224:227]
    ds_read_b64_tr_b16 v[56:57], v8 offset:2048
    v_add_f32 v157, v157, v125
    v_add_f32 v158, v158, v126
    v_add_f32 v159, v159, v127
    v_cvt_pk_bf16_f32 v150, v156, v157
    v_mfma_f32_16x16x32_bf16 v[232:235], v[40:43], a[28:31], v[232:235]
    ds_read_b64_tr_b16 v[58:59], v8 offset:2560
    buffer_load_dwordx4 v5, s[48:51], s26 offen offset:3072 lds
    s_sub_u32 s36, s36, 1024
    s_subb_u32 s37, s37, 0
    s_add_u32 s38, s38, 1024
    v_mfma_f32_16x16x32_bf16 v[240:243], v[40:43], a[152:155], v[240:243]
    ds_read_b64_tr_b16 v[60:61], v11 offset:2048
    s_sub_u32 s40, s40, 2048
    s_subb_u32 s41, s41, 0
    s_add_u32 s42, s42, 2048
    v_cvt_pk_bf16_f32 v151, v158, v159
    v_mfma_f32_16x16x32_bf16 v[248:251], v[40:43], a[156:159], v[248:251]
    ds_read_b64_tr_b16 v[62:63], v11 offset:2560
    s_add_u32 m0, s5, 98304
    s_mul_i32 s26, s16, 3072
    s_mul_i32 s27, s17, 3072
    v_mfma_f32_16x16x32_bf16 v[228:231], v[44:47], a[24:27], v[228:231]
    v_mfma_f32_16x16x32_bf16 v[68:71], v[144:147], v[176:179], 0
    v_mfma_f32_16x16x32_bf16 v[236:239], v[44:47], a[28:31], v[236:239]
    buffer_load_dwordx4 v2, s[36:39], s26 offen lds
    v_mfma_f32_16x16x32_bf16 v[84:87], v[96:99], v[144:147], 0
    v_mfma_f32_16x16x32_bf16 v[244:247], v[44:47], a[152:155], v[244:247]
    v_mfma_f32_16x16x32_bf16 v[68:71], v[148:151], v[180:183], v[68:71]
    v_mfma_f32_16x16x32_bf16 v[252:255], v[44:47], a[156:159], v[252:255]
    v_mfma_f32_16x16x32_bf16 v[84:87], v[96:99], v[148:151], v[84:87]
    s_waitcnt lgkmcnt(4)
    v_mfma_f32_16x16x32_bf16 v[192:195], v[48:51], a[32:35], v[192:195]
    ds_read_b64_tr_b16 v[40:41], v8 offset:8192
    s_lshl_b32 s96, s4, 11
    s_add_u32 s96, s96, 147456
    v_add_u32 v100, s96, v1
    s_and_b32 s96, s4, 1
    v_mfma_f32_16x16x32_bf16 v[200:203], v[48:51], a[36:39], v[200:203]
    ds_read_b64_tr_b16 v[42:43], v8 offset:8704
    buffer_load_dwordx4 v3, s[36:39], s26 offen offset:1024 lds
    s_lshl_b32 s96, s96, 11
    s_lshr_b32 s97, s4, 1
    s_lshl_b32 s97, s97, 10
    v_mfma_f32_16x16x32_bf16 v[208:211], v[48:51], a[160:163], v[208:211]
    ds_read_b64_tr_b16 v[44:45], v11 offset:8192
    s_add_u32 s96, s96, s97
    s_add_u32 s96, s96, 147456
    v_add_u32 v101, s96, v1
    v_cndmask_b32 v80, v84, v80, s[24:25]
    v_mfma_f32_16x16x32_bf16 v[216:219], v[48:51], a[164:167], v[216:219]
    ds_read_b64_tr_b16 v[46:47], v11 offset:8704
    ds_write_b128 v100, v[64:67]
    ds_write_b128 v100, v[68:71] offset:1024
    v_mfma_f32_16x16x32_bf16 v[196:199], v[52:55], a[32:35], v[196:199]
    v_mfma_f32_16x16x32_bf16 v[204:207], v[52:55], a[36:39], v[204:207]
    buffer_load_dwordx4 v2, s[40:43], s27 offen offset:2048 lds
    v_mfma_f32_16x16x32_bf16 v[212:215], v[52:55], a[160:163], v[212:215]
    v_mfma_f32_16x16x32_bf16 v[220:223], v[52:55], a[164:167], v[220:223]
    s_waitcnt lgkmcnt(6)
    v_mfma_f32_16x16x32_bf16 v[224:227], v[56:59], a[32:35], v[224:227]
    ds_read_b64_tr_b16 v[48:49], v8 offset:10240
    s_waitcnt lgkmcnt(1)
    s_barrier
    ds_read_b128 v[64:67], v101
    ds_read_b128 v[68:71], v101 offset:4096
    v_mfma_f32_16x16x32_bf16 v[232:235], v[56:59], a[36:39], v[232:235]
    ds_read_b64_tr_b16 v[50:51], v8 offset:10752
    buffer_store_dword v80, v37, s[52:55], s90 offen sc1
    v_mfma_f32_16x16x32_bf16 v[240:243], v[56:59], a[160:163], v[240:243]
    ds_read_b64_tr_b16 v[52:53], v11 offset:10240
    v_mfma_f32_16x16x32_bf16 v[248:251], v[56:59], a[164:167], v[248:251]
    ds_read_b64_tr_b16 v[54:55], v11 offset:10752
    v_mfma_f32_16x16x32_bf16 v[228:231], v[60:63], a[32:35], v[228:231]
    v_mfma_f32_16x16x32_bf16 v[236:239], v[60:63], a[36:39], v[236:239]
    buffer_load_dwordx4 v3, s[40:43], s27 offen offset:3072 lds
    s_add_u32 m0, s5, 114688
    s_mul_i32 s26, s18, 3072
    s_mul_i32 s27, s19, 3072
    v_mfma_f32_16x16x32_bf16 v[244:247], v[60:63], a[160:163], v[244:247]
    s_waitcnt lgkmcnt(3)
    v_add_f32 v64, v64, v68
    v_add_f32 v65, v65, v69
    v_add_f32 v66, v66, v70
    v_add_f32 v67, v67, v71
    v_mfma_f32_16x16x32_bf16 v[252:255], v[60:63], a[164:167], v[252:255]
    v_mfma_f32_16x16x32_bf16 v[192:195], v[40:43], a[40:43], v[192:195]
    s_waitcnt lgkmcnt(0)
    s_barrier
    ds_read_b64_tr_b16 v[56:57], v8 offset:16384
    v_mfma_f32_16x16x32_bf16 v[200:203], v[40:43], a[44:47], v[200:203]
    ds_read_b64_tr_b16 v[58:59], v8 offset:16896
    buffer_store_dwordx4 v[64:67], v1, s[52:55], s89 offen sc1
    v_mfma_f32_16x16x32_bf16 v[208:211], v[40:43], a[168:171], v[208:211]
    ds_read_b64_tr_b16 v[60:61], v11 offset:16384
    v_mfma_f32_16x16x32_bf16 v[216:219], v[40:43], a[172:175], v[216:219]
    ds_read_b64_tr_b16 v[62:63], v11 offset:16896
    v_mfma_f32_16x16x32_bf16 v[196:199], v[44:47], a[40:43], v[196:199]
    v_mfma_f32_16x16x32_bf16 v[204:207], v[44:47], a[44:47], v[204:207]
    buffer_load_dwordx4 v2, s[36:39], s26 offen lds
    v_mfma_f32_16x16x32_bf16 v[212:215], v[44:47], a[168:171], v[212:215]
    v_mfma_f32_16x16x32_bf16 v[220:223], v[44:47], a[172:175], v[220:223]
    v_mfma_f32_16x16x32_bf16 v[224:227], v[48:51], a[40:43], v[224:227]
    ds_read_b64_tr_b16 v[40:41], v8 offset:18432
    v_mfma_f32_16x16x32_bf16 v[232:235], v[48:51], a[44:47], v[232:235]
    ds_read_b64_tr_b16 v[42:43], v8 offset:18944
    buffer_load_dwordx4 v3, s[36:39], s26 offen offset:1024 lds
    v_mfma_f32_16x16x32_bf16 v[240:243], v[48:51], a[168:171], v[240:243]
    ds_read_b64_tr_b16 v[44:45], v11 offset:18432
    v_mfma_f32_16x16x32_bf16 v[248:251], v[48:51], a[172:175], v[248:251]
    ds_read_b64_tr_b16 v[46:47], v11 offset:18944
    v_mfma_f32_16x16x32_bf16 v[228:231], v[52:55], a[40:43], v[228:231]
    v_mfma_f32_16x16x32_bf16 v[236:239], v[52:55], a[44:47], v[236:239]
    buffer_load_dwordx4 v2, s[40:43], s27 offen offset:2048 lds
    v_mfma_f32_16x16x32_bf16 v[244:247], v[52:55], a[168:171], v[244:247]
    v_mfma_f32_16x16x32_bf16 v[252:255], v[52:55], a[172:175], v[252:255]
    s_waitcnt lgkmcnt(4)
    v_mfma_f32_16x16x32_bf16 v[192:195], v[56:59], a[48:51], v[192:195]
    ds_read_b64_tr_b16 v[48:49], v8 offset:24576
    v_mfma_f32_16x16x32_bf16 v[200:203], v[56:59], a[52:55], v[200:203]
    ds_read_b64_tr_b16 v[50:51], v8 offset:25088
    buffer_load_dwordx4 v3, s[40:43], s27 offen offset:3072 lds
    v_mfma_f32_16x16x32_bf16 v[208:211], v[56:59], a[176:179], v[208:211]
    ds_read_b64_tr_b16 v[52:53], v11 offset:24576
    s_add_u32 m0, s5, 131072
    s_mul_i32 s26, s20, 3072
    s_mul_i32 s27, s21, 3072
    v_mfma_f32_16x16x32_bf16 v[216:219], v[56:59], a[180:183], v[216:219]
    ds_read_b64_tr_b16 v[54:55], v11 offset:25088
    v_mfma_f32_16x16x32_bf16 v[196:199], v[60:63], a[48:51], v[196:199]
    v_mfma_f32_16x16x32_bf16 v[204:207], v[60:63], a[52:55], v[204:207]
    buffer_load_dwordx4 v2, s[36:39], s26 offen lds
    v_mfma_f32_16x16x32_bf16 v[212:215], v[60:63], a[176:179], v[212:215]
    v_mfma_f32_16x16x32_bf16 v[220:223], v[60:63], a[180:183], v[220:223]
    s_waitcnt lgkmcnt(4)
    v_mfma_f32_16x16x32_bf16 v[224:227], v[40:43], a[48:51], v[224:227]
    ds_read_b64_tr_b16 v[56:57], v8 offset:26624
    v_mfma_f32_16x16x32_bf16 v[232:235], v[40:43], a[52:55], v[232:235]
    ds_read_b64_tr_b16 v[58:59], v8 offset:27136
    buffer_load_dwordx4 v3, s[36:39], s26 offen offset:1024 lds
    v_mfma_f32_16x16x32_bf16 v[240:243], v[40:43], a[176:179], v[240:243]
    ds_read_b64_tr_b16 v[60:61], v11 offset:26624
    v_mfma_f32_16x16x32_bf16 v[248:251], v[40:43], a[180:183], v[248:251]
    ds_read_b64_tr_b16 v[62:63], v11 offset:27136
    v_mfma_f32_16x16x32_bf16 v[228:231], v[44:47], a[48:51], v[228:231]
    v_mfma_f32_16x16x32_bf16 v[236:239], v[44:47], a[52:55], v[236:239]
    buffer_load_dwordx4 v2, s[40:43], s27 offen offset:2048 lds
    v_mfma_f32_16x16x32_bf16 v[244:247], v[44:47], a[176:179], v[244:247]
    v_mfma_f32_16x16x32_bf16 v[252:255], v[44:47], a[180:183], v[252:255]
    s_waitcnt lgkmcnt(4)
    v_mfma_f32_16x16x32_bf16 v[192:195], v[48:51], a[56:59], v[192:195]
    s_waitcnt vmcnt(25) lgkmcnt(0)
    s_barrier
    ds_read_b64_tr_b16 v[40:41], v8 offset:32768
    v_mfma_f32_16x16x32_bf16 v[200:203], v[48:51], a[60:63], v[200:203]
    ds_read_b64_tr_b16 v[42:43], v8 offset:33280
    buffer_load_dwordx4 v3, s[40:43], s27 offen offset:3072 lds
    v_mfma_f32_16x16x32_bf16 v[208:211], v[48:51], a[184:187], v[208:211]
    ds_read_b64_tr_b16 v[44:45], v11 offset:32768
    s_add_u32 m0, s5, 0
    s_mul_i32 s26, s22, 3072
    s_mul_i32 s27, s23, 3072
    v_mfma_f32_16x16x32_bf16 v[216:219], v[48:51], a[188:191], v[216:219]
    ds_read_b64_tr_b16 v[46:47], v11 offset:33280
    v_mfma_f32_16x16x32_bf16 v[196:199], v[52:55], a[56:59], v[196:199]
    v_mfma_f32_16x16x32_bf16 v[204:207], v[52:55], a[60:63], v[204:207]
    buffer_load_dwordx4 v2, s[36:39], s26 offen lds
    v_mfma_f32_16x16x32_bf16 v[212:215], v[52:55], a[184:187], v[212:215]
    v_mfma_f32_16x16x32_bf16 v[220:223], v[52:55], a[188:191], v[220:223]
    v_mfma_f32_16x16x32_bf16 v[224:227], v[56:59], a[56:59], v[224:227]
    ds_read_b64_tr_b16 v[48:49], v8 offset:34816
    v_mfma_f32_16x16x32_bf16 v[232:235], v[56:59], a[60:63], v[232:235]
    ds_read_b64_tr_b16 v[50:51], v8 offset:35328
    buffer_load_dwordx4 v3, s[36:39], s26 offen offset:1024 lds
    v_mfma_f32_16x16x32_bf16 v[240:243], v[56:59], a[184:187], v[240:243]
    ds_read_b64_tr_b16 v[52:53], v11 offset:34816
    v_mfma_f32_16x16x32_bf16 v[248:251], v[56:59], a[188:191], v[248:251]
    ds_read_b64_tr_b16 v[54:55], v11 offset:35328
    v_mfma_f32_16x16x32_bf16 v[228:231], v[60:63], a[56:59], v[228:231]
    v_mfma_f32_16x16x32_bf16 v[236:239], v[60:63], a[60:63], v[236:239]
    buffer_load_dwordx4 v2, s[40:43], s27 offen offset:2048 lds
    v_mfma_f32_16x16x32_bf16 v[244:247], v[60:63], a[184:187], v[244:247]
    v_mfma_f32_16x16x32_bf16 v[252:255], v[60:63], a[188:191], v[252:255]
    s_waitcnt lgkmcnt(4)
    v_mfma_f32_16x16x32_bf16 v[192:195], v[40:43], a[64:67], v[192:195]
    ds_read_b64_tr_b16 v[56:57], v8 offset:40960
    v_mfma_f32_16x16x32_bf16 v[200:203], v[40:43], a[68:71], v[200:203]
    ds_read_b64_tr_b16 v[58:59], v8 offset:41472
    buffer_load_dwordx4 v3, s[40:43], s27 offen offset:3072 lds
    v_mfma_f32_16x16x32_bf16 v[208:211], v[40:43], a[192:195], v[208:211]
    ds_read_b64_tr_b16 v[60:61], v11 offset:40960
    v_readlane_b32 s16, v38, 0
    v_mfma_f32_16x16x32_bf16 v[216:219], v[40:43], a[196:199], v[216:219]
    ds_read_b64_tr_b16 v[62:63], v11 offset:41472
    v_readlane_b32 s17, v38, 1
    v_mfma_f32_16x16x32_bf16 v[196:199], v[44:47], a[64:67], v[196:199]
    v_readlane_b32 s18, v38, 2
    v_readlane_b32 s19, v38, 3
    v_mfma_f32_16x16x32_bf16 v[204:207], v[44:47], a[68:71], v[204:207]
    v_readlane_b32 s20, v38, 4
    v_readlane_b32 s21, v38, 5
    v_mfma_f32_16x16x32_bf16 v[212:215], v[44:47], a[192:195], v[212:215]
    v_readlane_b32 s22, v38, 6
    v_readlane_b32 s23, v38, 7
    v_mfma_f32_16x16x32_bf16 v[220:223], v[44:47], a[196:199], v[220:223]
    s_add_u32 s26, s4, 1
    s_and_b32 s26, s26, 3
    s_lshl_b32 s26, s26, 10
    v_add_u32 v2, s26, v1
    s_waitcnt lgkmcnt(4)
    v_mfma_f32_16x16x32_bf16 v[224:227], v[48:51], a[64:67], v[224:227]
    ds_read_b64_tr_b16 v[40:41], v8 offset:43008
    s_add_u32 s26, s4, 2
    s_and_b32 s26, s26, 3
    s_lshl_b32 s26, s26, 10
    v_add_u32 v3, s26, v1
    v_mfma_f32_16x16x32_bf16 v[232:235], v[48:51], a[68:71], v[232:235]
    ds_read_b64_tr_b16 v[42:43], v8 offset:43520
    s_add_u32 s26, s4, 3
    s_and_b32 s26, s26, 3
    s_lshl_b32 s26, s26, 10
    v_add_u32 v4, s26, v1
    v_mfma_f32_16x16x32_bf16 v[240:243], v[48:51], a[192:195], v[240:243]
    ds_read_b64_tr_b16 v[44:45], v11 offset:43008
    s_add_u32 s26, s4, 4
    s_and_b32 s26, s26, 3
    s_lshl_b32 s26, s26, 10
    v_add_u32 v5, s26, v1
    v_mfma_f32_16x16x32_bf16 v[248:251], v[48:51], a[196:199], v[248:251]
    ds_read_b64_tr_b16 v[46:47], v11 offset:43520
    s_add_u32 m0, s5, 16384
    v_mfma_f32_16x16x32_bf16 v[228:231], v[52:55], a[64:67], v[228:231]
    buffer_load_dwordx4 v6, s[56:59], s80 offen lds
    v_mfma_f32_16x16x32_bf16 v[236:239], v[52:55], a[68:71], v[236:239]
    v_mfma_f32_16x16x32_bf16 v[244:247], v[52:55], a[192:195], v[244:247]
    v_mfma_f32_16x16x32_bf16 v[252:255], v[52:55], a[196:199], v[252:255]
    s_waitcnt lgkmcnt(4)
    v_mfma_f32_16x16x32_bf16 v[192:195], v[56:59], a[72:75], v[192:195]
    s_waitcnt vmcnt(27) lgkmcnt(0)
    s_barrier
    ds_read_b64_tr_b16 v[48:49], v8 offset:49152
    v_mfma_f32_16x16x32_bf16 v[200:203], v[56:59], a[76:79], v[200:203]
    ds_read_b64_tr_b16 v[50:51], v8 offset:49664
    s_waitcnt vmcnt(13)
    buffer_store_dword v0, v37, s[52:55], s13 offen sc1
    s_add_u32 s13, s13, 4096
    v_mfma_f32_16x16x32_bf16 v[208:211], v[56:59], a[200:203], v[208:211]
    ds_read_b64_tr_b16 v[52:53], v11 offset:49152
    v_mfma_f32_16x16x32_bf16 v[216:219], v[56:59], a[204:207], v[216:219]
    ds_read_b64_tr_b16 v[54:55], v11 offset:49664
    v_mfma_f32_16x16x32_bf16 v[196:199], v[60:63], a[72:75], v[196:199]
    v_mfma_f32_16x16x32_bf16 v[204:207], v[60:63], a[76:79], v[204:207]
    buffer_load_dwordx4 v7, s[56:59], s80 offen offset:1024 lds
    v_mfma_f32_16x16x32_bf16 v[212:215], v[60:63], a[200:203], v[212:215]
    v_mfma_f32_16x16x32_bf16 v[220:223], v[60:63], a[204:207], v[220:223]
    v_mfma_f32_16x16x32_bf16 v[224:227], v[40:43], a[72:75], v[224:227]
    ds_read_b64_tr_b16 v[56:57], v8 offset:51200
    v_mfma_f32_16x16x32_bf16 v[232:235], v[40:43], a[76:79], v[232:235]
    ds_read_b64_tr_b16 v[58:59], v8 offset:51712
    buffer_load_dwordx4 v6, s[60:63], s80 offen offset:2048 lds
    v_mfma_f32_16x16x32_bf16 v[240:243], v[40:43], a[200:203], v[240:243]
    ds_read_b64_tr_b16 v[60:61], v11 offset:51200
    v_mfma_f32_16x16x32_bf16 v[248:251], v[40:43], a[204:207], v[248:251]
    ds_read_b64_tr_b16 v[62:63], v11 offset:51712
    v_mfma_f32_16x16x32_bf16 v[228:231], v[44:47], a[72:75], v[228:231]
    v_mfma_f32_16x16x32_bf16 v[236:239], v[44:47], a[76:79], v[236:239]
    buffer_load_dwordx4 v7, s[60:63], s80 offen offset:3072 lds
    s_add_u32 m0, s5, 32768
    v_mfma_f32_16x16x32_bf16 v[244:247], v[44:47], a[200:203], v[244:247]
    v_mfma_f32_16x16x32_bf16 v[252:255], v[44:47], a[204:207], v[252:255]
    s_waitcnt lgkmcnt(4)
    v_mfma_f32_16x16x32_bf16 v[192:195], v[48:51], a[80:83], v[192:195]
    ds_read_b64_tr_b16 v[40:41], v8 offset:57344
    v_mfma_f32_16x16x32_bf16 v[200:203], v[48:51], a[84:87], v[200:203]
    ds_read_b64_tr_b16 v[42:43], v8 offset:57856
    buffer_load_dwordx4 v6, s[56:59], s81 offen lds
    v_mfma_f32_16x16x32_bf16 v[208:211], v[48:51], a[208:211], v[208:211]
    ds_read_b64_tr_b16 v[44:45], v11 offset:57344
    v_mfma_f32_16x16x32_bf16 v[216:219], v[48:51], a[212:215], v[216:219]
    ds_read_b64_tr_b16 v[46:47], v11 offset:57856
    v_mfma_f32_16x16x32_bf16 v[196:199], v[52:55], a[80:83], v[196:199]
    v_mfma_f32_16x16x32_bf16 v[204:207], v[52:55], a[84:87], v[204:207]
    buffer_load_dwordx4 v7, s[56:59], s81 offen offset:1024 lds
    v_mfma_f32_16x16x32_bf16 v[212:215], v[52:55], a[208:211], v[212:215]
    v_mfma_f32_16x16x32_bf16 v[220:223], v[52:55], a[212:215], v[220:223]
    s_waitcnt lgkmcnt(4)
    v_mfma_f32_16x16x32_bf16 v[224:227], v[56:59], a[80:83], v[224:227]
    ds_read_b64_tr_b16 v[48:49], v8 offset:59392
    v_mfma_f32_16x16x32_bf16 v[232:235], v[56:59], a[84:87], v[232:235]
    ds_read_b64_tr_b16 v[50:51], v8 offset:59904
    buffer_load_dwordx4 v6, s[60:63], s81 offen offset:2048 lds
    v_mfma_f32_16x16x32_bf16 v[240:243], v[56:59], a[208:211], v[240:243]
    ds_read_b64_tr_b16 v[52:53], v11 offset:59392
    v_mfma_f32_16x16x32_bf16 v[248:251], v[56:59], a[212:215], v[248:251]
    ds_read_b64_tr_b16 v[54:55], v11 offset:59904
    v_mfma_f32_16x16x32_bf16 v[228:231], v[60:63], a[80:83], v[228:231]
    v_mfma_f32_16x16x32_bf16 v[236:239], v[60:63], a[84:87], v[236:239]
    buffer_load_dwordx4 v7, s[60:63], s81 offen offset:3072 lds
    v_mfma_f32_16x16x32_bf16 v[244:247], v[60:63], a[208:211], v[244:247]
    v_mfma_f32_16x16x32_bf16 v[252:255], v[60:63], a[212:215], v[252:255]
    s_waitcnt lgkmcnt(4)
    v_mfma_f32_16x16x32_bf16 v[192:195], v[40:43], a[88:91], v[192:195]
    s_waitcnt lgkmcnt(0)
    s_barrier
    ds_read_b64_tr_b16 v[56:57], v9 offset:0
    v_mfma_f32_16x16x32_bf16 v[200:203], v[40:43], a[92:95], v[200:203]
    ds_read_b64_tr_b16 v[58:59], v9 offset:512
    s_add_u32 m0, s5, 49152
    v_mfma_f32_16x16x32_bf16 v[208:211], v[40:43], a[216:219], v[208:211]
    ds_read_b64_tr_b16 v[60:61], v12 offset:0
    buffer_load_dwordx4 v6, s[56:59], s82 offen lds
    v_mfma_f32_16x16x32_bf16 v[216:219], v[40:43], a[220:223], v[216:219]
    ds_read_b64_tr_b16 v[62:63], v12 offset:512
    v_mfma_f32_16x16x32_bf16 v[196:199], v[44:47], a[88:91], v[196:199]
    v_mfma_f32_16x16x32_bf16 v[204:207], v[44:47], a[92:95], v[204:207]
    v_mfma_f32_16x16x32_bf16 v[212:215], v[44:47], a[216:219], v[212:215]
    buffer_load_dwordx4 v7, s[56:59], s82 offen offset:1024 lds
    v_mfma_f32_16x16x32_bf16 v[220:223], v[44:47], a[220:223], v[220:223]
    v_mfma_f32_16x16x32_bf16 v[224:227], v[48:51], a[88:91], v[224:227]
    ds_read_b64_tr_b16 v[40:41], v9 offset:2048
    v_mfma_f32_16x16x32_bf16 v[232:235], v[48:51], a[92:95], v[232:235]
    ds_read_b64_tr_b16 v[42:43], v9 offset:2560
    v_mfma_f32_16x16x32_bf16 v[240:243], v[48:51], a[216:219], v[240:243]
    ds_read_b64_tr_b16 v[44:45], v12 offset:2048
    buffer_load_dwordx4 v6, s[60:63], s82 offen offset:2048 lds
    v_mfma_f32_16x16x32_bf16 v[248:251], v[48:51], a[220:223], v[248:251]
    ds_read_b64_tr_b16 v[46:47], v12 offset:2560
    v_mfma_f32_16x16x32_bf16 v[228:231], v[52:55], a[88:91], v[228:231]
    v_mfma_f32_16x16x32_bf16 v[236:239], v[52:55], a[92:95], v[236:239]
    v_mfma_f32_16x16x32_bf16 v[244:247], v[52:55], a[216:219], v[244:247]
    buffer_load_dwordx4 v7, s[60:63], s82 offen offset:3072 lds
    v_mfma_f32_16x16x32_bf16 v[252:255], v[52:55], a[220:223], v[252:255]
    s_waitcnt lgkmcnt(4)
    v_mfma_f32_16x16x32_bf16 v[192:195], v[56:59], a[96:99], v[192:195]
    ds_read_b64_tr_b16 v[48:49], v9 offset:8192
    v_mfma_f32_16x16x32_bf16 v[200:203], v[56:59], a[100:103], v[200:203]
    ds_read_b64_tr_b16 v[50:51], v9 offset:8704
    v_mfma_f32_16x16x32_bf16 v[208:211], v[56:59], a[224:227], v[208:211]
    ds_read_b64_tr_b16 v[52:53], v12 offset:8192
    v_mfma_f32_16x16x32_bf16 v[216:219], v[56:59], a[228:231], v[216:219]
    ds_read_b64_tr_b16 v[54:55], v12 offset:8704
    v_mfma_f32_16x16x32_bf16 v[196:199], v[60:63], a[96:99], v[196:199]
    v_mfma_f32_16x16x32_bf16 v[204:207], v[60:63], a[100:103], v[204:207]
    v_mfma_f32_16x16x32_bf16 v[212:215], v[60:63], a[224:227], v[212:215]
    v_mfma_f32_16x16x32_bf16 v[220:223], v[60:63], a[228:231], v[220:223]
    s_waitcnt lgkmcnt(4)
    v_mfma_f32_16x16x32_bf16 v[224:227], v[40:43], a[96:99], v[224:227]
    ds_read_b64_tr_b16 v[56:57], v9 offset:10240
    v_mfma_f32_16x16x32_bf16 v[232:235], v[40:43], a[100:103], v[232:235]
    ds_read_b64_tr_b16 v[58:59], v9 offset:10752
    v_mfma_f32_16x16x32_bf16 v[240:243], v[40:43], a[224:227], v[240:243]
    ds_read_b64_tr_b16 v[60:61], v12 offset:10240
    v_mfma_f32_16x16x32_bf16 v[248:251], v[40:43], a[228:231], v[248:251]
    ds_read_b64_tr_b16 v[62:63], v12 offset:10752
    v_mfma_f32_16x16x32_bf16 v[228:231], v[44:47], a[96:99], v[228:231]
    v_mfma_f32_16x16x32_bf16 v[236:239], v[44:47], a[100:103], v[236:239]
    v_mfma_f32_16x16x32_bf16 v[244:247], v[44:47], a[224:227], v[244:247]
    v_mfma_f32_16x16x32_bf16 v[252:255], v[44:47], a[228:231], v[252:255]
    s_waitcnt lgkmcnt(4)
    v_mfma_f32_16x16x32_bf16 v[192:195], v[48:51], a[104:107], v[192:195]
    s_waitcnt lgkmcnt(0)
    s_barrier
    ds_read_b64_tr_b16 v[40:41], v9 offset:16384
    v_mfma_f32_16x16x32_bf16 v[200:203], v[48:51], a[108:111], v[200:203]
    ds_read_b64_tr_b16 v[42:43], v9 offset:16896
    s_add_u32 m0, s5, 65536
    v_mfma_f32_16x16x32_bf16 v[208:211], v[48:51], a[232:235], v[208:211]
    ds_read_b64_tr_b16 v[44:45], v12 offset:16384
    buffer_load_dwordx4 v6, s[56:59], s83 offen lds
    v_mfma_f32_16x16x32_bf16 v[216:219], v[48:51], a[236:239], v[216:219]
    ds_read_b64_tr_b16 v[46:47], v12 offset:16896
    v_mfma_f32_16x16x32_bf16 v[196:199], v[52:55], a[104:107], v[196:199]
    v_mfma_f32_16x16x32_bf16 v[204:207], v[52:55], a[108:111], v[204:207]
    v_mfma_f32_16x16x32_bf16 v[212:215], v[52:55], a[232:235], v[212:215]
    buffer_load_dwordx4 v7, s[56:59], s83 offen offset:1024 lds
    v_mfma_f32_16x16x32_bf16 v[220:223], v[52:55], a[236:239], v[220:223]
    v_mfma_f32_16x16x32_bf16 v[224:227], v[56:59], a[104:107], v[224:227]
    ds_read_b64_tr_b16 v[48:49], v9 offset:18432
    v_mfma_f32_16x16x32_bf16 v[232:235], v[56:59], a[108:111], v[232:235]
    ds_read_b64_tr_b16 v[50:51], v9 offset:18944
    v_mfma_f32_16x16x32_bf16 v[240:243], v[56:59], a[232:235], v[240:243]
    ds_read_b64_tr_b16 v[52:53], v12 offset:18432
    buffer_load_dwordx4 v6, s[60:63], s83 offen offset:2048 lds
    v_mfma_f32_16x16x32_bf16 v[248:251], v[56:59], a[236:239], v[248:251]
    ds_read_b64_tr_b16 v[54:55], v12 offset:18944
    v_mfma_f32_16x16x32_bf16 v[228:231], v[60:63], a[104:107], v[228:231]
    v_mfma_f32_16x16x32_bf16 v[236:239], v[60:63], a[108:111], v[236:239]
    v_mfma_f32_16x16x32_bf16 v[244:247], v[60:63], a[232:235], v[244:247]
    buffer_load_dwordx4 v7, s[60:63], s83 offen offset:3072 lds
    v_mfma_f32_16x16x32_bf16 v[252:255], v[60:63], a[236:239], v[252:255]
    s_waitcnt lgkmcnt(4)
    v_mfma_f32_16x16x32_bf16 v[192:195], v[40:43], a[112:115], v[192:195]
    ds_read_b64_tr_b16 v[56:57], v9 offset:24576
    v_mfma_f32_16x16x32_bf16 v[200:203], v[40:43], a[116:119], v[200:203]
    ds_read_b64_tr_b16 v[58:59], v9 offset:25088
    v_mfma_f32_16x16x32_bf16 v[208:211], v[40:43], a[240:243], v[208:211]
    ds_read_b64_tr_b16 v[60:61], v12 offset:24576
    v_mfma_f32_16x16x32_bf16 v[216:219], v[40:43], a[244:247], v[216:219]
    ds_read_b64_tr_b16 v[62:63], v12 offset:25088
    buffer_load_dword v35, v36, s[52:55], 0 offen sc1
    v_mfma_f32_16x16x32_bf16 v[196:199], v[44:47], a[112:115], v[196:199]
    v_mfma_f32_16x16x32_bf16 v[204:207], v[44:47], a[116:119], v[204:207]
    v_mfma_f32_16x16x32_bf16 v[212:215], v[44:47], a[240:243], v[212:215]
    v_mfma_f32_16x16x32_bf16 v[220:223], v[44:47], a[244:247], v[220:223]
    s_waitcnt lgkmcnt(4)
    v_mfma_f32_16x16x32_bf16 v[224:227], v[48:51], a[112:115], v[224:227]
    ds_read_b64_tr_b16 v[40:41], v9 offset:26624
    v_mfma_f32_16x16x32_bf16 v[232:235], v[48:51], a[116:119], v[232:235]
    ds_read_b64_tr_b16 v[42:43], v9 offset:27136
    v_mfma_f32_16x16x32_bf16 v[240:243], v[48:51], a[240:243], v[240:243]
    ds_read_b64_tr_b16 v[44:45], v12 offset:26624
    v_mfma_f32_16x16x32_bf16 v[248:251], v[48:51], a[244:247], v[248:251]
    ds_read_b64_tr_b16 v[46:47], v12 offset:27136
    v_mfma_f32_16x16x32_bf16 v[228:231], v[52:55], a[112:115], v[228:231]
    v_mfma_f32_16x16x32_bf16 v[236:239], v[52:55], a[116:119], v[236:239]
    v_mfma_f32_16x16x32_bf16 v[244:247], v[52:55], a[240:243], v[244:247]
    v_mfma_f32_16x16x32_bf16 v[252:255], v[52:55], a[244:247], v[252:255]
    s_waitcnt lgkmcnt(4)
    v_mfma_f32_16x16x32_bf16 v[192:195], v[56:59], a[120:123], v[192:195]
    s_waitcnt lgkmcnt(0)
    s_barrier
    ds_read_b64_tr_b16 v[48:49], v9 offset:32768
    v_mfma_f32_16x16x32_bf16 v[200:203], v[56:59], a[124:127], v[200:203]
    ds_read_b64_tr_b16 v[50:51], v9 offset:33280
    s_add_u32 m0, s5, 81920
    v_mfma_f32_16x16x32_bf16 v[208:211], v[56:59], a[248:251], v[208:211]
    ds_read_b64_tr_b16 v[52:53], v12 offset:32768
    buffer_load_dwordx4 v6, s[56:59], s16 offen lds
    v_mfma_f32_16x16x32_bf16 v[216:219], v[56:59], a[252:255], v[216:219]
    ds_read_b64_tr_b16 v[54:55], v12 offset:33280
    v_mfma_f32_16x16x32_bf16 v[196:199], v[60:63], a[120:123], v[196:199]
    v_mfma_f32_16x16x32_bf16 v[204:207], v[60:63], a[124:127], v[204:207]
    v_mfma_f32_16x16x32_bf16 v[212:215], v[60:63], a[248:251], v[212:215]
    buffer_load_dwordx4 v7, s[56:59], s16 offen offset:1024 lds
    v_mfma_f32_16x16x32_bf16 v[220:223], v[60:63], a[252:255], v[220:223]
    v_mfma_f32_16x16x32_bf16 v[224:227], v[40:43], a[120:123], v[224:227]
    ds_read_b64_tr_b16 v[56:57], v9 offset:40960
    v_mfma_f32_16x16x32_bf16 v[232:235], v[40:43], a[124:127], v[232:235]
    ds_read_b64_tr_b16 v[58:59], v9 offset:41472
    v_mfma_f32_16x16x32_bf16 v[240:243], v[40:43], a[248:251], v[240:243]
    ds_read_b64_tr_b16 v[60:61], v12 offset:40960
    buffer_load_dwordx4 v6, s[60:63], s16 offen offset:2048 lds
    v_mfma_f32_16x16x32_bf16 v[248:251], v[40:43], a[252:255], v[248:251]
    ds_read_b64_tr_b16 v[62:63], v12 offset:41472
    v_mfma_f32_16x16x32_bf16 v[228:231], v[44:47], a[120:123], v[228:231]
    v_mfma_f32_16x16x32_bf16 v[236:239], v[44:47], a[124:127], v[236:239]
    v_mfma_f32_16x16x32_bf16 v[244:247], v[44:47], a[248:251], v[244:247]
    buffer_load_dwordx4 v7, s[60:63], s16 offen offset:3072 lds
    v_mfma_f32_16x16x32_bf16 v[252:255], v[44:47], a[252:255], v[252:255]
    s_waitcnt lgkmcnt(4)
    v_mfma_f32_16x16x32_bf16 v[128:131], v[48:51], a[0:3], 0
    ds_read_b64_tr_b16 v[40:41], v9 offset:34816
    s_lshl_b32 s97, s9, 6
    s_add_u32 s96, s97, s11
    s_add_u32 s97, s97, s12
    v_mul_f32 v120, v192, v192
    v_mul_f32 v121, v193, v193
    v_mfma_f32_16x16x32_bf16 v[136:139], v[48:51], a[4:7], 0
    ds_read_b64_tr_b16 v[42:43], v9 offset:35328
    v_mul_f32 v122, v194, v194
    v_mul_f32 v123, v195, v195
    v_fmaak_f32 v120, v32, v120, 0xc0135761
    v_fmaak_f32 v121, v32, v121, 0xc0135761
    v_fmaak_f32 v122, v32, v122, 0xc0135761
    v_mfma_f32_16x16x32_bf16 v[144:147], v[48:51], a[128:131], 0
    ds_read_b64_tr_b16 v[44:45], v12 offset:34816
    v_fmaak_f32 v123, v32, v123, 0xc0135761
    v_mul_f32 v120, v120, v192
    v_mul_f32 v121, v121, v193
    v_mul_f32 v122, v122, v194
    v_mul_f32 v123, v123, v195
    v_mfma_f32_16x16x32_bf16 v[152:155], v[48:51], a[132:135], 0
    ds_read_b64_tr_b16 v[46:47], v12 offset:35328
    v_exp_f32 v120, v120
    v_exp_f32 v121, v121
    v_mfma_f32_16x16x32_bf16 v[132:135], v[52:55], a[0:3], 0
    s_waitcnt vmcnt(4)
    v_cmp_eq_u32 vcc, 0, v35
    s_nop 0
    s_and_b32 s91, vcc_lo, 65535
    s_cbranch_scc1 LA_poll1_retry
LA_poll1_ok:
    s_and_b32 s93, s90, 0xfffff800
    v_mfma_f32_16x16x32_bf16 v[140:143], v[52:55], a[4:7], 0
    v_lshrrev_b32 v104, 2, v1
    buffer_load_dword v96, v104, s[52:55], s93 offen sc1
    v_exp_f32 v122, v122
    v_exp_f32 v123, v123
    v_mfma_f32_16x16x32_bf16 v[148:151], v[52:55], a[128:131], 0
    buffer_load_dword v97, v104, s[52:55], s93 offen offset:256 sc1
    v_mul_f32 v224, v192, v224
    v_mul_f32 v225, v193, v225
    v_mul_f32 v226, v194, v226
    v_mul_f32 v227, v195, v227
    v_add_f32 v120, 1.0, v120
    v_mfma_f32_16x16x32_bf16 v[156:159], v[52:55], a[132:135], 0
    buffer_load_dword v98, v104, s[52:55], s93 offen offset:512 sc1
    v_add_f32 v121, 1.0, v121
    v_add_f32 v122, 1.0, v122
    v_add_f32 v123, 1.0, v123
    s_waitcnt lgkmcnt(4)
    v_mfma_f32_16x16x32_bf16 v[128:131], v[56:59], a[8:11], v[128:131]
    ds_read_b64_tr_b16 v[48:49], v9 offset:43008
    buffer_load_dword v99, v104, s[52:55], s93 offen offset:768 sc1
    v_rcp_f32 v120, v120
    v_rcp_f32 v121, v121
    v_mfma_f32_16x16x32_bf16 v[136:139], v[56:59], a[12:15], v[136:139]
    ds_read_b64_tr_b16 v[50:51], v9 offset:43520
    buffer_load_dword v100, v104, s[52:55], s93 offen offset:1024 sc1
    v_rcp_f32 v122, v122
    v_rcp_f32 v123, v123
    v_mfma_f32_16x16x32_bf16 v[144:147], v[56:59], a[136:139], v[144:147]
    ds_read_b64_tr_b16 v[52:53], v12 offset:43008
    buffer_load_dword v101, v104, s[52:55], s93 offen offset:1280 sc1
    v_mul_f32 v224, v224, v120
    v_mul_f32 v225, v225, v121
    v_mul_f32 v226, v226, v122
    v_mul_f32 v227, v227, v123
    v_mfma_f32_16x16x32_bf16 v[152:155], v[56:59], a[140:143], v[152:155]
    ds_read_b64_tr_b16 v[54:55], v12 offset:43520
    buffer_load_dword v102, v104, s[52:55], s93 offen offset:1536 sc1
    v_cvt_pk_bf16_f32 v192, v224, v225
    v_cvt_pk_bf16_f32 v193, v226, v227
    v_mul_f32 v124, v196, v196
    v_mul_f32 v125, v197, v197
    v_mfma_f32_16x16x32_bf16 v[132:135], v[60:63], a[8:11], v[132:135]
    buffer_load_dword v103, v104, s[52:55], s93 offen offset:1792 sc1
    s_and_b32 s93, s89, 0xffffc000
    v_mul_f32 v126, v198, v198
    v_mul_f32 v127, v199, v199
    v_fmaak_f32 v124, v32, v124, 0xc0135761
    v_fmaak_f32 v125, v32, v125, 0xc0135761
    v_mfma_f32_16x16x32_bf16 v[140:143], v[60:63], a[12:15], v[140:143]
    buffer_load_dwordx4 v[64:67], v1, s[52:55], s93 offen sc1
    v_fmaak_f32 v126, v32, v126, 0xc0135761
    v_fmaak_f32 v127, v32, v127, 0xc0135761
    v_mul_f32 v124, v124, v196
    v_mul_f32 v125, v125, v197
    v_mul_f32 v126, v126, v198
    v_mfma_f32_16x16x32_bf16 v[148:151], v[60:63], a[136:139], v[148:151]
    v_mul_f32 v127, v127, v199
    v_exp_f32 v124, v124
    v_exp_f32 v125, v125
    v_mfma_f32_16x16x32_bf16 v[156:159], v[60:63], a[140:143], v[156:159]
    v_exp_f32 v126, v126
    v_exp_f32 v127, v127
    v_mul_f32 v228, v196, v228
    s_waitcnt lgkmcnt(4)
    v_mfma_f32_16x16x32_bf16 v[128:131], v[40:43], a[16:19], v[128:131]
    s_waitcnt lgkmcnt(0)
    s_barrier
    ds_read_b64_tr_b16 v[56:57], v9 offset:49152
    buffer_load_dwordx4 v[68:71], v1, s[52:55], s93 offen offset:1024 sc1
    s_add_u32 m0, s5, 98304
    v_mul_f32 v229, v197, v229
    v_mfma_f32_16x16x32_bf16 v[136:139], v[40:43], a[20:23], v[136:139]
    ds_read_b64_tr_b16 v[58:59], v9 offset:49664
    v_mul_f32 v230, v198, v230
    v_mul_f32 v231, v199, v231
    v_add_f32 v124, 1.0, v124
    v_add_f32 v125, 1.0, v125
    v_add_f32 v126, 1.0, v126
    v_mfma_f32_16x16x32_bf16 v[144:147], v[40:43], a[144:147], v[144:147]
    ds_read_b64_tr_b16 v[60:61], v12 offset:49152
    v_add_f32 v127, 1.0, v127
    v_rcp_f32 v124, v124
    v_rcp_f32 v125, v125
    v_mfma_f32_16x16x32_bf16 v[152:155], v[40:43], a[148:151], v[152:155]
    ds_read_b64_tr_b16 v[62:63], v12 offset:49664
    buffer_load_dwordx4 v[72:75], v1, s[52:55], s93 offen offset:2048 sc1
    v_rcp_f32 v126, v126
    v_rcp_f32 v127, v127
    v_mfma_f32_16x16x32_bf16 v[132:135], v[44:47], a[16:19], v[132:135]
    v_mul_f32 v228, v228, v124
    v_mul_f32 v229, v229, v125
    v_mul_f32 v230, v230, v126
    v_mul_f32 v231, v231, v127
    v_cvt_pk_bf16_f32 v194, v228, v229
    v_cvt_pk_bf16_f32 v195, v230, v231
    v_mfma_f32_16x16x32_bf16 v[140:143], v[44:47], a[20:23], v[140:143]
    v_mfma_f32_16x16x32_bf16 v[148:151], v[44:47], a[144:147], v[148:151]
    buffer_store_dwordx4 v[192:195], v1, s[52:55], s96 offen sc1
    v_mul_f32 v120, v200, v200
    v_mul_f32 v121, v201, v201
    v_mul_f32 v122, v202, v202
    v_mul_f32 v123, v203, v203
    v_fmaak_f32 v120, v32, v120, 0xc0135761
    v_mfma_f32_16x16x32_bf16 v[156:159], v[44:47], a[148:151], v[156:159]
    v_fmaak_f32 v121, v32, v121, 0xc0135761
    v_fmaak_f32 v122, v32, v122, 0xc0135761
    v_fmaak_f32 v123, v32, v123, 0xc0135761
    v_mul_f32 v120, v120, v200
    v_mul_f32 v121, v121, v201
    v_mfma_f32_16x16x32_bf16 v[128:131], v[48:51], a[24:27], v[128:131]
    ds_read_b64_tr_b16 v[40:41], v9 offset:57344
    buffer_load_dwordx4 v[76:79], v1, s[52:55], s93 offen offset:3072 sc1
    s_add_u32 s93, s93, 4096
    v_mul_f32 v122, v122, v202
    v_mul_f32 v123, v123, v203
    v_mfma_f32_16x16x32_bf16 v[136:139], v[48:51], a[28:31], v[136:139]
    ds_read_b64_tr_b16 v[42:43], v9 offset:57856
    v_exp_f32 v120, v120
    v_exp_f32 v121, v121
    v_mfma_f32_16x16x32_bf16 v[144:147], v[48:51], a[152:155], v[144:147]
    ds_read_b64_tr_b16 v[44:45], v12 offset:57344
    v_exp_f32 v122, v122
    v_exp_f32 v123, v123
    v_mul_f32 v232, v200, v232
    v_mfma_f32_16x16x32_bf16 v[152:155], v[48:51], a[156:159], v[152:155]
    ds_read_b64_tr_b16 v[46:47], v12 offset:57856
    buffer_load_dwordx4 v[80:83], v1, s[52:55], s93 offen sc1
    v_mul_f32 v233, v201, v233
    v_mul_f32 v234, v202, v234
    v_mul_f32 v235, v203, v235
    v_add_f32 v120, 1.0, v120
    v_mfma_f32_16x16x32_bf16 v[132:135], v[52:55], a[24:27], v[132:135]
    v_add_f32 v121, 1.0, v121
    v_add_f32 v122, 1.0, v122
    v_add_f32 v123, 1.0, v123
    v_rcp_f32 v120, v120
    v_mfma_f32_16x16x32_bf16 v[140:143], v[52:55], a[28:31], v[140:143]
    v_rcp_f32 v121, v121
    v_rcp_f32 v122, v122
    v_rcp_f32 v123, v123
    v_mfma_f32_16x16x32_bf16 v[148:151], v[52:55], a[152:155], v[148:151]
    buffer_load_dwordx4 v[84:87], v1, s[52:55], s93 offen offset:1024 sc1
    v_mul_f32 v232, v232, v120
    v_mul_f32 v233, v233, v121
    v_mul_f32 v234, v234, v122
    v_mul_f32 v235, v235, v123
    v_cvt_pk_bf16_f32 v196, v232, v233
    v_mfma_f32_16x16x32_bf16 v[156:159], v[52:55], a[156:159], v[156:159]
    v_cvt_pk_bf16_f32 v197, v234, v235
    v_mul_f32 v124, v204, v204
    v_mul_f32 v125, v205, v205
    v_mul_f32 v126, v206, v206
    v_mul_f32 v127, v207, v207
    s_waitcnt lgkmcnt(4)
    v_mfma_f32_16x16x32_bf16 v[128:131], v[56:59], a[32:35], v[128:131]
    ds_read_b64_tr_b16 v[48:49], v9 offset:51200
    buffer_load_dword v35, v33, s[52:55], s14 offen sc1
    v_fmaak_f32 v124, v32, v124, 0xc0135761
    v_fmaak_f32 v125, v32, v125, 0xc0135761
    v_fmaak_f32 v126, v32, v126, 0xc0135761
    v_fmaak_f32 v127, v32, v127, 0xc0135761
    v_mfma_f32_16x16x32_bf16 v[136:139], v[56:59], a[36:39], v[136:139]
    ds_read_b64_tr_b16 v[50:51], v9 offset:51712
    v_mul_f32 v124, v124, v204
    v_mul_f32 v125, v125, v205
    v_mul_f32 v126, v126, v206
    v_mul_f32 v127, v127, v207
    v_mfma_f32_16x16x32_bf16 v[144:147], v[56:59], a[160:163], v[144:147]
    ds_read_b64_tr_b16 v[52:53], v12 offset:51200
    v_exp_f32 v124, v124
    v_exp_f32 v125, v125
    v_mfma_f32_16x16x32_bf16 v[152:155], v[56:59], a[164:167], v[152:155]
    ds_read_b64_tr_b16 v[54:55], v12 offset:51712
    buffer_load_dwordx4 v[88:91], v1, s[52:55], s93 offen offset:2048 sc1
    v_exp_f32 v126, v126
    v_exp_f32 v127, v127
    v_mfma_f32_16x16x32_bf16 v[132:135], v[60:63], a[32:35], v[132:135]
    v_mul_f32 v236, v204, v236
    v_mul_f32 v237, v205, v237
    v_mul_f32 v238, v206, v238
    v_mul_f32 v239, v207, v239
    v_add_f32 v124, 1.0, v124
    v_add_f32 v125, 1.0, v125
    v_mfma_f32_16x16x32_bf16 v[140:143], v[60:63], a[36:39], v[140:143]
    v_add_f32 v126, 1.0, v126
    v_add_f32 v127, 1.0, v127
    v_rcp_f32 v124, v124
    v_rcp_f32 v125, v125
    v_mfma_f32_16x16x32_bf16 v[148:151], v[60:63], a[160:163], v[148:151]
    buffer_load_dwordx4 v[92:95], v1, s[52:55], s93 offen offset:3072 sc1
    s_add_u32 s93, s93, 4096
    v_rcp_f32 v126, v126
    v_rcp_f32 v127, v127
    v_mfma_f32_16x16x32_bf16 v[156:159], v[60:63], a[164:167], v[156:159]
    v_mul_f32 v236, v236, v124
    v_mul_f32 v237, v237, v125
    v_mul_f32 v238, v238, v126
    v_mul_f32 v239, v239, v127
    v_cvt_pk_bf16_f32 v198, v236, v237
    s_waitcnt lgkmcnt(4)
    v_mfma_f32_16x16x32_bf16 v[128:131], v[40:43], a[40:43], v[128:131]
    ds_read_b64_tr_b16 v[56:57], v9 offset:59392
    buffer_load_dwordx4 v[160:163], v1, s[52:55], s93 offen sc1
    v_cvt_pk_bf16_f32 v199, v238, v239
    v_mfma_f32_16x16x32_bf16 v[136:139], v[40:43], a[44:47], v[136:139]
    ds_read_b64_tr_b16 v[58:59], v9 offset:59904
    v_mfma_f32_16x16x32_bf16 v[144:147], v[40:43], a[168:171], v[144:147]
    ds_read_b64_tr_b16 v[60:61], v12 offset:59392
    v_mfma_f32_16x16x32_bf16 v[152:155], v[40:43], a[172:175], v[152:155]
    ds_read_b64_tr_b16 v[62:63], v12 offset:59904
    v_mfma_f32_16x16x32_bf16 v[132:135], v[44:47], a[40:43], v[132:135]
    buffer_store_dwordx4 v[196:199], v1, s[52:55], s96 offen offset:1024 sc1
    v_mul_f32 v120, v208, v208
    v_mul_f32 v121, v209, v209
    v_mul_f32 v122, v210, v210
    v_mul_f32 v123, v211, v211
    v_fmaak_f32 v120, v32, v120, 0xc0135761
    v_mfma_f32_16x16x32_bf16 v[140:143], v[44:47], a[44:47], v[140:143]
    v_fmaak_f32 v121, v32, v121, 0xc0135761
    v_fmaak_f32 v122, v32, v122, 0xc0135761
    v_fmaak_f32 v123, v32, v123, 0xc0135761
    v_mul_f32 v120, v120, v208
    v_mul_f32 v121, v121, v209
    v_mul_f32 v122, v122, v210
    v_mfma_f32_16x16x32_bf16 v[148:151], v[44:47], a[168:171], v[148:151]
    buffer_load_dwordx4 v[164:167], v1, s[52:55], s93 offen offset:1024 sc1
    v_mul_f32 v123, v123, v211
    v_exp_f32 v120, v120
    v_exp_f32 v121, v121
    v_mfma_f32_16x16x32_bf16 v[156:159], v[44:47], a[172:175], v[156:159]
    v_exp_f32 v122, v122
    v_exp_f32 v123, v123
    v_mul_f32 v240, v208, v240
    s_waitcnt lgkmcnt(4)
    v_mfma_f32_16x16x32_bf16 v[128:131], v[48:51], a[48:51], v[128:131]
    s_waitcnt lgkmcnt(0)
    s_barrier
    ds_read_b64_tr_b16 v[40:41], v10 offset:0
    buffer_load_dwordx4 v[168:171], v1, s[52:55], s93 offen offset:2048 sc1
    v_mul_f32 v241, v209, v241
    v_mul_f32 v242, v210, v242
    v_mfma_f32_16x16x32_bf16 v[136:139], v[48:51], a[52:55], v[136:139]
    ds_read_b64_tr_b16 v[42:43], v10 offset:512
    v_mul_f32 v243, v211, v243
    v_add_f32 v120, 1.0, v120
    v_add_f32 v121, 1.0, v121
    v_add_f32 v122, 1.0, v122
    v_add_f32 v123, 1.0, v123
    v_mfma_f32_16x16x32_bf16 v[144:147], v[48:51], a[176:179], v[144:147]
    ds_read_b64_tr_b16 v[44:45], v13 offset:0
    v_rcp_f32 v120, v120
    v_rcp_f32 v121, v121
    v_mfma_f32_16x16x32_bf16 v[152:155], v[48:51], a[180:183], v[152:155]
    ds_read_b64_tr_b16 v[46:47], v13 offset:512
    buffer_load_dwordx4 v[172:175], v1, s[52:55], s93 offen offset:3072 sc1
    s_add_u32 s93, s93, 4096
    v_rcp_f32 v122, v122
    v_mfma_f32_16x16x32_bf16 v[132:135], v[52:55], a[48:51], v[132:135]
    v_rcp_f32 v123, v123
    v_mul_f32 v240, v240, v120
    v_mul_f32 v241, v241, v121
    v_mul_f32 v242, v242, v122
    v_mul_f32 v243, v243, v123
    v_mfma_f32_16x16x32_bf16 v[140:143], v[52:55], a[52:55], v[140:143]
    v_cvt_pk_bf16_f32 v208, v240, v241
    v_cvt_pk_bf16_f32 v209, v242, v243
    v_mul_f32 v124, v212, v212
    v_mul_f32 v125, v213, v213
    v_mul_f32 v126, v214, v214
    v_mul_f32 v127, v215, v215
    v_mfma_f32_16x16x32_bf16 v[148:151], v[52:55], a[176:179], v[148:151]
    buffer_load_dwordx4 v[176:179], v1, s[52:55], s93 offen sc1
    v_fmaak_f32 v124, v32, v124, 0xc0135761
    v_fmaak_f32 v125, v32, v125, 0xc0135761
    v_fmaak_f32 v126, v32, v126, 0xc0135761
    v_fmaak_f32 v127, v32, v127, 0xc0135761
    v_mul_f32 v124, v124, v212
    v_mfma_f32_16x16x32_bf16 v[156:159], v[52:55], a[180:183], v[156:159]
    v_mul_f32 v125, v125, v213
    v_mul_f32 v126, v126, v214
    v_mul_f32 v127, v127, v215
    v_exp_f32 v124, v124
    v_mfma_f32_16x16x32_bf16 v[128:131], v[56:59], a[56:59], v[128:131]
    ds_read_b64_tr_b16 v[48:49], v10 offset:8192
    buffer_load_dwordx4 v[180:183], v1, s[52:55], s93 offen offset:1024 sc1
    v_exp_f32 v125, v125
    v_exp_f32 v126, v126
    v_mfma_f32_16x16x32_bf16 v[136:139], v[56:59], a[60:63], v[136:139]
    ds_read_b64_tr_b16 v[50:51], v10 offset:8704
    v_exp_f32 v127, v127
    v_mul_f32 v244, v212, v244
    v_mul_f32 v245, v213, v245
    v_mul_f32 v246, v214, v246
    v_mfma_f32_16x16x32_bf16 v[144:147], v[56:59], a[184:187], v[144:147]
    ds_read_b64_tr_b16 v[52:53], v13 offset:8192
    buffer_load_dwordx4 v[184:187], v1, s[52:55], s93 offen offset:2048 sc1
    v_mul_f32 v247, v215, v247
    v_add_f32 v124, 1.0, v124
    v_add_f32 v125, 1.0, v125
    v_add_f32 v126, 1.0, v126
    v_mfma_f32_16x16x32_bf16 v[152:155], v[56:59], a[188:191], v[152:155]
    ds_read_b64_tr_b16 v[54:55], v13 offset:8704
    v_add_f32 v127, 1.0, v127
    v_rcp_f32 v124, v124
    v_rcp_f32 v125, v125
    v_mfma_f32_16x16x32_bf16 v[132:135], v[60:63], a[56:59], v[132:135]
    v_rcp_f32 v126, v126
    v_rcp_f32 v127, v127
    v_mul_f32 v244, v244, v124
    v_mul_f32 v245, v245, v125
    v_mfma_f32_16x16x32_bf16 v[140:143], v[60:63], a[60:63], v[140:143]
    buffer_load_dwordx4 v[188:191], v1, s[52:55], s93 offen offset:3072 sc1
    s_waitcnt vmcnt(11)
    v_cmp_eq_u32 vcc, 0, v35
    s_nop 0
    s_and_b32 s91, vcc_lo, 255
    s_cbranch_scc1 LA_poll2_retry
LA_poll2_ok:
    v_mfma_f32_16x16x32_bf16 v[148:151], v[60:63], a[184:187], v[148:151]
    s_add_u32 s14, s14, 4096
    v_mul_f32 v246, v246, v126
    v_mul_f32 v247, v247, v127
    v_cvt_pk_bf16_f32 v210, v244, v245
    v_cvt_pk_bf16_f32 v211, v246, v247
    v_mfma_f32_16x16x32_bf16 v[156:159], v[60:63], a[188:191], v[156:159]
    s_waitcnt lgkmcnt(4)
    v_mfma_f32_16x16x32_bf16 v[128:131], v[40:43], a[64:67], v[128:131]
    ds_read_b64_tr_b16 v[56:57], v10 offset:2048
    buffer_store_dwordx4 v[208:211], v1, s[52:55], s97 offen sc1
    v_mul_f32 v120, v216, v216
    v_mul_f32 v121, v217, v217
    v_mul_f32 v122, v218, v218
    v_mul_f32 v123, v219, v219
    v_mfma_f32_16x16x32_bf16 v[136:139], v[40:43], a[68:71], v[136:139]
    ds_read_b64_tr_b16 v[58:59], v10 offset:2560
    v_fmaak_f32 v120, v32, v120, 0xc0135761
    v_fmaak_f32 v121, v32, v121, 0xc0135761
    v_fmaak_f32 v122, v32, v122, 0xc0135761
    v_fmaak_f32 v123, v32, v123, 0xc0135761
    v_mul_f32 v120, v120, v216
    v_mfma_f32_16x16x32_bf16 v[144:147], v[40:43], a[192:195], v[144:147]
    ds_read_b64_tr_b16 v[60:61], v13 offset:2048
    s_lshr_b32 s93, s80, 3
    buffer_load_dwordx4 a[128:131], v2, s[32:35], s93 offen sc1
    v_mul_f32 v121, v121, v217
    v_mul_f32 v122, v122, v218
    v_mul_f32 v123, v123, v219
    v_mfma_f32_16x16x32_bf16 v[152:155], v[40:43], a[196:199], v[152:155]
    ds_read_b64_tr_b16 v[62:63], v13 offset:2560
    v_exp_f32 v120, v120
    v_exp_f32 v121, v121
    v_mfma_f32_16x16x32_bf16 v[132:135], v[44:47], a[64:67], v[132:135]
    v_exp_f32 v122, v122
    v_exp_f32 v123, v123
    v_mul_f32 v248, v216, v248
    v_mul_f32 v249, v217, v249
    v_mfma_f32_16x16x32_bf16 v[140:143], v[44:47], a[68:71], v[140:143]
    buffer_load_dwordx4 a[132:135], v3, s[32:35], s93 offen sc1
    v_mul_f32 v250, v218, v250
    v_mul_f32 v251, v219, v251
    v_add_f32 v120, 1.0, v120
    v_add_f32 v121, 1.0, v121
    v_add_f32 v122, 1.0, v122
    v_mfma_f32_16x16x32_bf16 v[148:151], v[44:47], a[192:195], v[148:151]
    v_add_f32 v123, 1.0, v123
    v_rcp_f32 v120, v120
    v_rcp_f32 v121, v121
    v_mfma_f32_16x16x32_bf16 v[156:159], v[44:47], a[196:199], v[156:159]
    v_rcp_f32 v122, v122
    v_rcp_f32 v123, v123
    v_mul_f32 v248, v248, v120
    s_waitcnt lgkmcnt(4)
    v_mfma_f32_16x16x32_bf16 v[128:131], v[48:51], a[72:75], v[128:131]
    ds_read_b64_tr_b16 v[40:41], v10 offset:10240
    buffer_load_dwordx4 a[136:139], v4, s[32:35], s93 offen sc1
    v_mul_f32 v249, v249, v121
    v_mul_f32 v250, v250, v122
    v_mul_f32 v251, v251, v123
    v_cvt_pk_bf16_f32 v212, v248, v249
    v_mfma_f32_16x16x32_bf16 v[136:139], v[48:51], a[76:79], v[136:139]
    ds_read_b64_tr_b16 v[42:43], v10 offset:10752
    v_cvt_pk_bf16_f32 v213, v250, v251
    v_mul_f32 v124, v220, v220
    v_mul_f32 v125, v221, v221
    v_mul_f32 v126, v222, v222
    v_mul_f32 v127, v223, v223
    v_mfma_f32_16x16x32_bf16 v[144:147], v[48:51], a[200:203], v[144:147]
    ds_read_b64_tr_b16 v[44:45], v13 offset:10240
    buffer_load_dwordx4 a[140:143], v5, s[32:35], s93 offen sc1
    v_fmaak_f32 v124, v32, v124, 0xc0135761
    v_fmaak_f32 v125, v32, v125, 0xc0135761
    v_fmaak_f32 v126, v32, v126, 0xc0135761
    v_fmaak_f32 v127, v32, v127, 0xc0135761
    v_mfma_f32_16x16x32_bf16 v[152:155], v[48:51], a[204:207], v[152:155]
    ds_read_b64_tr_b16 v[46:47], v13 offset:10752
    v_mul_f32 v124, v124, v220
    v_mul_f32 v125, v125, v221
    v_mul_f32 v126, v126, v222
    v_mul_f32 v127, v127, v223
    v_mfma_f32_16x16x32_bf16 v[132:135], v[52:55], a[72:75], v[132:135]
    v_exp_f32 v124, v124
    v_exp_f32 v125, v125
    v_exp_f32 v126, v126
    v_mfma_f32_16x16x32_bf16 v[140:143], v[52:55], a[76:79], v[140:143]
    s_lshr_b32 s93, s81, 3
    buffer_load_dwordx4 a[144:147], v2, s[32:35], s93 offen sc1
    v_exp_f32 v127, v127
    v_mul_f32 v252, v220, v252
    v_mul_f32 v253, v221, v253
    v_mfma_f32_16x16x32_bf16 v[148:151], v[52:55], a[200:203], v[148:151]
    v_mul_f32 v254, v222, v254
    v_mul_f32 v255, v223, v255
    v_add_f32 v124, 1.0, v124
    v_add_f32 v125, 1.0, v125
    v_add_f32 v126, 1.0, v126
    v_add_f32 v127, 1.0, v127
    v_mfma_f32_16x16x32_bf16 v[156:159], v[52:55], a[204:207], v[156:159]
    v_rcp_f32 v124, v124
    v_rcp_f32 v125, v125
    s_waitcnt lgkmcnt(4)
    v_mfma_f32_16x16x32_bf16 v[128:131], v[56:59], a[80:83], v[128:131]
    s_waitcnt lgkmcnt(0)
    s_barrier
    ds_read_b64_tr_b16 v[48:49], v8 offset:0
    buffer_load_dwordx4 a[148:151], v3, s[32:35], s93 offen sc1
    v_rcp_f32 v126, v126
    v_mfma_f32_16x16x32_bf16 v[136:139], v[56:59], a[84:87], v[136:139]
    ds_read_b64_tr_b16 v[50:51], v8 offset:512
    v_rcp_f32 v127, v127
    v_mul_f32 v252, v252, v124
    v_mul_f32 v253, v253, v125
    v_mul_f32 v254, v254, v126
    v_mfma_f32_16x16x32_bf16 v[144:147], v[56:59], a[208:211], v[144:147]
    ds_read_b64_tr_b16 v[52:53], v11 offset:0
    v_mul_f32 v255, v255, v127
    v_cvt_pk_bf16_f32 v214, v252, v253
    v_cvt_pk_bf16_f32 v215, v254, v255
    buffer_store_dwordx4 v[212:215], v1, s[52:55], s97 offen offset:1024 sc1
    s_and_b32 s96, s4, 1
    v_mfma_f32_16x16x32_bf16 v[152:155], v[56:59], a[212:215], v[152:155]
    ds_read_b64_tr_b16 v[54:55], v11 offset:512
    s_lshl_b32 s96, s96, 11
    s_add_u32 s96, s96, 155648
    v_add_u32 v109, s96, v1
    s_lshr_b32 s97, s4, 1
    s_lshl_b32 s97, s97, 3
    v_mfma_f32_16x16x32_bf16 v[132:135], v[60:63], a[80:83], v[132:135]
    v_add_u32 v108, s97, v109
    s_lshl_b32 s97, s97, 5
    s_add_u32 s97, s97, s96
    s_add_u32 s97, s97, 1024
    v_lshrrev_b32 v110, 2, v1
    v_add_u32 v110, s97, v110
    v_mfma_f32_16x16x32_bf16 v[140:143], v[60:63], a[84:87], v[140:143]
    buffer_load_dwordx4 a[152:155], v4, s[32:35], s93 offen sc1
    v_lshrrev_b32 v111, 4, v1
    v_and_b32 v111, 48, v111
    s_add_u32 s96, s96, 1024
    v_add_u32 v111, s96, v111
    v_add_f32 v96, v96, v97
    v_mfma_f32_16x16x32_bf16 v[148:151], v[60:63], a[208:211], v[148:151]
    v_add_f32 v96, v96, v98
    v_add_f32 v96, v96, v99
    v_add_f32 v96, v96, v100
    v_add_f32 v96, v96, v101
    v_add_f32 v96, v96, v102
    v_add_f32 v96, v96, v103
    v_mfma_f32_16x16x32_bf16 v[156:159], v[60:63], a[212:215], v[156:159]
    buffer_load_dwordx4 a[156:159], v5, s[32:35], s93 offen sc1
    v_add_f32 v64, v64, v68
    v_add_f32 v65, v65, v69
    v_add_f32 v66, v66, v70
    v_add_f32 v67, v67, v71
    v_mfma_f32_16x16x32_bf16 v[128:131], v[40:43], a[88:91], v[128:131]
    ds_read_b64_tr_b16 v[56:57], v8 offset:8192
    v_add_f32 v64, v64, v72
    v_add_f32 v65, v65, v73
    v_add_f32 v66, v66, v74
    v_add_f32 v67, v67, v75
    v_add_f32 v64, v64, v76
    v_mfma_f32_16x16x32_bf16 v[136:139], v[40:43], a[92:95], v[136:139]
    ds_read_b64_tr_b16 v[58:59], v8 offset:8704
    s_lshr_b32 s93, s82, 3
    buffer_load_dwordx4 a[160:163], v2, s[32:35], s93 offen sc1
    v_add_f32 v65, v65, v77
    v_add_f32 v66, v66, v78
    v_add_f32 v67, v67, v79
    v_mfma_f32_16x16x32_bf16 v[144:147], v[40:43], a[216:219], v[144:147]
    ds_read_b64_tr_b16 v[60:61], v11 offset:8192
    v_add_f32 v64, v64, v80
    v_add_f32 v65, v65, v81
    v_add_f32 v66, v66, v82
    v_add_f32 v67, v67, v83
    v_add_f32 v64, v64, v84
    v_mfma_f32_16x16x32_bf16 v[152:155], v[40:43], a[220:223], v[152:155]
    ds_read_b64_tr_b16 v[62:63], v11 offset:8704
    v_add_f32 v65, v65, v85
    v_add_f32 v66, v66, v86
    v_add_f32 v67, v67, v87
    s_waitcnt vmcnt(21)
    v_add_f32 v64, v64, v88
    v_mfma_f32_16x16x32_bf16 v[132:135], v[44:47], a[88:91], v[132:135]
    buffer_load_dwordx4 a[164:167], v3, s[32:35], s93 offen sc1
    v_add_f32 v65, v65, v89
    v_add_f32 v66, v66, v90
    v_add_f32 v67, v67, v91
    s_waitcnt vmcnt(21)
    v_add_f32 v64, v64, v92
    v_mfma_f32_16x16x32_bf16 v[140:143], v[44:47], a[92:95], v[140:143]
    v_add_f32 v65, v65, v93
    v_add_f32 v66, v66, v94
    v_add_f32 v67, v67, v95
    s_waitcnt vmcnt(20)
    v_add_f32 v64, v64, v160
    v_add_f32 v65, v65, v161
    v_mfma_f32_16x16x32_bf16 v[148:151], v[44:47], a[216:219], v[148:151]
    buffer_load_dwordx4 a[168:171], v4, s[32:35], s93 offen sc1
    v_add_f32 v66, v66, v162
    v_add_f32 v67, v67, v163
    s_waitcnt vmcnt(19)
    v_add_f32 v64, v64, v164
    v_add_f32 v65, v65, v165
    v_mfma_f32_16x16x32_bf16 v[156:159], v[44:47], a[220:223], v[156:159]
    v_add_f32 v66, v66, v166
    v_add_f32 v67, v67, v167
    s_waitcnt vmcnt(18)
    v_add_f32 v64, v64, v168
    v_add_f32 v65, v65, v169
    s_waitcnt lgkmcnt(4)
    v_mfma_f32_16x16x32_bf16 v[128:131], v[48:51], a[96:99], v[128:131]
    ds_read_b64_tr_b16 v[40:41], v8 offset:2048
    buffer_load_dwordx4 a[172:175], v5, s[32:35], s93 offen sc1
    v_add_f32 v66, v66, v170
    v_add_f32 v67, v67, v171
    s_waitcnt vmcnt(18)
    v_add_f32 v64, v64, v172
    v_mfma_f32_16x16x32_bf16 v[136:139], v[48:51], a[100:103], v[136:139]
    ds_read_b64_tr_b16 v[42:43], v8 offset:2560
    v_add_f32 v65, v65, v173
    v_add_f32 v66, v66, v174
    v_add_f32 v67, v67, v175
    s_waitcnt vmcnt(17)
    v_add_f32 v64, v64, v176
    v_mfma_f32_16x16x32_bf16 v[144:147], v[48:51], a[224:227], v[144:147]
    ds_read_b64_tr_b16 v[44:45], v11 offset:2048
    s_lshr_b32 s93, s83, 3
    buffer_load_dwordx4 a[176:179], v2, s[32:35], s93 offen sc1
    v_add_f32 v65, v65, v177
    v_add_f32 v66, v66, v178
    v_add_f32 v67, v67, v179
    v_mfma_f32_16x16x32_bf16 v[152:155], v[48:51], a[228:231], v[152:155]
    ds_read_b64_tr_b16 v[46:47], v11 offset:2560
    s_waitcnt vmcnt(17)
    v_add_f32 v64, v64, v180
    v_add_f32 v65, v65, v181
    v_add_f32 v66, v66, v182
    v_add_f32 v67, v67, v183
    v_mfma_f32_16x16x32_bf16 v[132:135], v[52:55], a[96:99], v[132:135]
    s_waitcnt vmcnt(16)
    v_add_f32 v64, v64, v184
    v_add_f32 v65, v65, v185
    v_add_f32 v66, v66, v186
    v_add_f32 v67, v67, v187
    v_mfma_f32_16x16x32_bf16 v[140:143], v[52:55], a[100:103], v[140:143]
    buffer_load_dwordx4 a[180:183], v3, s[32:35], s93 offen sc1
    s_waitcnt vmcnt(16)
    v_add_f32 v64, v64, v188
    v_add_f32 v65, v65, v189
    v_add_f32 v66, v66, v190
    v_add_f32 v67, v67, v191
    v_mfma_f32_16x16x32_bf16 v[148:151], v[52:55], a[224:227], v[148:151]
    v_cvt_pk_bf16_f32 v64, v64, v65
    v_cvt_pk_bf16_f32 v65, v66, v67
    v_mov_b32 v97, v96
    ds_write_b64 v108, v[64:65]
    s_nop 0
    v_permlane32_swap_b32 v96, v97
    v_mfma_f32_16x16x32_bf16 v[156:159], v[52:55], a[228:231], v[156:159]
    buffer_load_dwordx4 a[184:187], v4, s[32:35], s93 offen sc1
    v_add_f32 v96, v96, v97
    ds_write_b32 v110, v96
    s_waitcnt lgkmcnt(6)
    v_mfma_f32_16x16x32_bf16 v[128:131], v[56:59], a[104:107], v[128:131]
    ds_read_b64_tr_b16 v[48:49], v8 offset:10240
    v_mfma_f32_16x16x32_bf16 v[136:139], v[56:59], a[108:111], v[136:139]
    ds_read_b64_tr_b16 v[50:51], v8 offset:10752
    v_mfma_f32_16x16x32_bf16 v[144:147], v[56:59], a[232:235], v[144:147]
    ds_read_b64_tr_b16 v[52:53], v11 offset:10240
    v_mfma_f32_16x16x32_bf16 v[152:155], v[56:59], a[236:239], v[152:155]
    ds_read_b64_tr_b16 v[54:55], v11 offset:10752
    buffer_load_dwordx4 a[188:191], v5, s[32:35], s93 offen sc1
    v_mfma_f32_16x16x32_bf16 v[132:135], v[60:63], a[104:107], v[132:135]
    v_mfma_f32_16x16x32_bf16 v[140:143], v[60:63], a[108:111], v[140:143]
    v_mfma_f32_16x16x32_bf16 v[148:151], v[60:63], a[232:235], v[148:151]
    v_mfma_f32_16x16x32_bf16 v[156:159], v[60:63], a[236:239], v[156:159]
    s_waitcnt lgkmcnt(6)
    v_mfma_f32_16x16x32_bf16 v[128:131], v[40:43], a[112:115], v[128:131]
    s_waitcnt lgkmcnt(0)
    s_barrier
    ds_read_b64_tr_b16 v[56:57], v20 offset:16384
    buffer_load_dwordx4 v6, s[56:59], s17 offen lds
    v_mfma_f32_16x16x32_bf16 v[136:139], v[40:43], a[116:119], v[136:139]
    ds_read_b64_tr_b16 v[58:59], v20 offset:18432
    v_mfma_f32_16x16x32_bf16 v[144:147], v[40:43], a[240:243], v[144:147]
    ds_read_b64_tr_b16 v[60:61], v23 offset:16384
    v_mfma_f32_16x16x32_bf16 v[152:155], v[40:43], a[244:247], v[152:155]
    ds_read_b64_tr_b16 v[62:63], v23 offset:18432
    v_mfma_f32_16x16x32_bf16 v[132:135], v[44:47], a[112:115], v[132:135]
    v_mfma_f32_16x16x32_bf16 v[140:143], v[44:47], a[116:119], v[140:143]
    s_waitcnt vmcnt(11)
    buffer_store_dword v0, v37, s[52:55], s13 offen sc1
    s_add_u32 s13, s13, 4096
    v_mfma_f32_16x16x32_bf16 v[148:151], v[44:47], a[240:243], v[148:151]
    v_mfma_f32_16x16x32_bf16 v[156:159], v[44:47], a[244:247], v[156:159]
    v_mfma_f32_16x16x32_bf16 v[128:131], v[48:51], a[120:123], v[128:131]
    ds_read_b64_tr_b16 v[40:41], v26 offset:16384
    v_mfma_f32_16x16x32_bf16 v[136:139], v[48:51], a[124:127], v[136:139]
    ds_read_b64_tr_b16 v[42:43], v26 offset:18432
    buffer_load_dwordx4 v7, s[56:59], s17 offen offset:1024 lds
    v_mfma_f32_16x16x32_bf16 v[144:147], v[48:51], a[248:251], v[144:147]
    ds_read_b64_tr_b16 v[44:45], v29 offset:16384
    v_mfma_f32_16x16x32_bf16 v[152:155], v[48:51], a[252:255], v[152:155]
    ds_read_b64_tr_b16 v[46:47], v29 offset:18432
    v_mfma_f32_16x16x32_bf16 v[132:135], v[52:55], a[120:123], v[132:135]
    v_mfma_f32_16x16x32_bf16 v[140:143], v[52:55], a[124:127], v[140:143]
    v_mfma_f32_16x16x32_bf16 v[148:151], v[52:55], a[248:251], v[148:151]
    buffer_load_dwordx4 v6, s[60:63], s17 offen offset:2048 lds
    v_mfma_f32_16x16x32_bf16 v[156:159], v[52:55], a[252:255], v[156:159]
    v_mov_b32 v116, 0x3fb8aa3b
    ds_read_b128 v[64:67], v109
    ds_read_b128 v[68:71], v111
    ds_read_b128 v[72:75], v111 offset:64
    ds_read_b128 v[76:79], v111 offset:256
    ds_read_b128 v[80:83], v111 offset:320
    v_pk_mul_f32 v[120:121], v[128:129], v[116:117] op_sel_hi:[1,0]
    v_pk_mul_f32 v[122:123], v[130:131], v[116:117] op_sel_hi:[1,0]
    v_pk_mul_f32 v[124:125], v[132:133], v[116:117] op_sel_hi:[1,0]
    v_pk_mul_f32 v[126:127], v[134:135], v[116:117] op_sel_hi:[1,0]
    v_exp_f32 v120, v120 clamp
    v_exp_f32 v121, v121 clamp
    v_exp_f32 v122, v122 clamp
    v_exp_f32 v123, v123 clamp
    buffer_load_dwordx4 v7, s[60:63], s17 offen offset:3072 lds
    s_add_u32 m0, s5, 114688
    v_exp_f32 v124, v124 clamp
    v_exp_f32 v125, v125 clamp
    v_exp_f32 v126, v126 clamp
    v_exp_f32 v127, v127 clamp
    v_max_f32 v128, 0x358637bd, v128
    v_max_f32 v129, 0x358637bd, v129
    v_max_f32 v130, 0x358637bd, v130
    v_max_f32 v131, 0x358637bd, v131
    v_max_f32 v132, 0x358637bd, v132
    v_max_f32 v133, 0x358637bd, v133
    v_max_f32 v134, 0x358637bd, v134
    v_max_f32 v135, 0x358637bd, v135
    buffer_load_dwordx4 v6, s[56:59], s18 offen lds
    v_pk_add_f32 v[128:129], v[128:129], v[120:121]
    v_pk_add_f32 v[130:131], v[130:131], v[122:123]
    v_pk_add_f32 v[132:133], v[132:133], v[124:125]
    v_pk_add_f32 v[134:135], v[134:135], v[126:127]
    v_cvt_pk_bf16_f32 v128, v128, v129
    v_cvt_pk_bf16_f32 v129, v130, v131
    v_cvt_pk_bf16_f32 v130, v132, v133
    v_cvt_pk_bf16_f32 v131, v134, v135
    v_pk_mul_f32 v[120:121], v[136:137], v[116:117] op_sel_hi:[1,0]
    v_pk_mul_f32 v[122:123], v[138:139], v[116:117] op_sel_hi:[1,0]
    v_pk_mul_f32 v[124:125], v[140:141], v[116:117] op_sel_hi:[1,0]
    v_pk_mul_f32 v[126:127], v[142:143], v[116:117] op_sel_hi:[1,0]
    v_exp_f32 v120, v120 clamp
    v_exp_f32 v121, v121 clamp
    buffer_load_dwordx4 v7, s[56:59], s18 offen offset:1024 lds
    v_exp_f32 v122, v122 clamp
    v_exp_f32 v123, v123 clamp
    v_exp_f32 v124, v124 clamp
    v_exp_f32 v125, v125 clamp
    v_exp_f32 v126, v126 clamp
    v_exp_f32 v127, v127 clamp
    v_max_f32 v136, 0x358637bd, v136
    v_max_f32 v137, 0x358637bd, v137
    v_max_f32 v138, 0x358637bd, v138
    v_max_f32 v139, 0x358637bd, v139
    buffer_load_dwordx4 v6, s[60:63], s18 offen offset:2048 lds
    v_max_f32 v140, 0x358637bd, v140
    v_max_f32 v141, 0x358637bd, v141
    v_max_f32 v142, 0x358637bd, v142
    v_max_f32 v143, 0x358637bd, v143
    v_pk_add_f32 v[136:137], v[136:137], v[120:121]
    v_pk_add_f32 v[138:139], v[138:139], v[122:123]
    v_pk_add_f32 v[140:141], v[140:141], v[124:125]
    v_pk_add_f32 v[142:143], v[142:143], v[126:127]
    v_cvt_pk_bf16_f32 v132, v136, v137
    v_cvt_pk_bf16_f32 v133, v138, v139
    v_cvt_pk_bf16_f32 v134, v140, v141
    v_cvt_pk_bf16_f32 v135, v142, v143
    v_pk_mul_f32 v[120:121], v[144:145], v[116:117] op_sel_hi:[1,0]
    v_pk_mul_f32 v[122:123], v[146:147], v[116:117] op_sel_hi:[1,0]
    v_pk_mul_f32 v[124:125], v[148:149], v[116:117] op_sel_hi:[1,0]
    v_pk_mul_f32 v[126:127], v[150:151], v[116:117] op_sel_hi:[1,0]
    buffer_load_dwordx4 v7, s[60:63], s18 offen offset:3072 lds
    s_add_u32 m0, s5, 131072
    v_exp_f32 v120, v120 clamp
    v_exp_f32 v121, v121 clamp
    v_exp_f32 v122, v122 clamp
    v_exp_f32 v123, v123 clamp
    v_exp_f32 v124, v124 clamp
    v_exp_f32 v125, v125 clamp
    v_exp_f32 v126, v126 clamp
    v_exp_f32 v127, v127 clamp
    buffer_load_dwordx4 v6, s[56:59], s19 offen lds
    v_max_f32 v144, 0x358637bd, v144
    v_max_f32 v145, 0x358637bd, v145
    v_max_f32 v146, 0x358637bd, v146
    v_max_f32 v147, 0x358637bd, v147
    v_max_f32 v148, 0x358637bd, v148
    v_max_f32 v149, 0x358637bd, v149
    v_max_f32 v150, 0x358637bd, v150
    v_max_f32 v151, 0x358637bd, v151
    v_pk_add_f32 v[144:145], v[144:145], v[120:121]
    v_pk_add_f32 v[146:147], v[146:147], v[122:123]
    v_pk_add_f32 v[148:149], v[148:149], v[124:125]
    v_pk_add_f32 v[150:151], v[150:151], v[126:127]
    v_cvt_pk_bf16_f32 v144, v144, v145
    v_cvt_pk_bf16_f32 v145, v146, v147
    v_cvt_pk_bf16_f32 v146, v148, v149
    v_cvt_pk_bf16_f32 v147, v150, v151
    v_pk_mul_f32 v[120:121], v[152:153], v[116:117] op_sel_hi:[1,0]
    buffer_load_dwordx4 v7, s[56:59], s19 offen offset:1024 lds
    v_pk_mul_f32 v[122:123], v[154:155], v[116:117] op_sel_hi:[1,0]
    v_pk_mul_f32 v[124:125], v[156:157], v[116:117] op_sel_hi:[1,0]
    v_pk_mul_f32 v[126:127], v[158:159], v[116:117] op_sel_hi:[1,0]
    v_exp_f32 v120, v120 clamp
    v_exp_f32 v121, v121 clamp
    v_exp_f32 v122, v122 clamp
    v_exp_f32 v123, v123 clamp
    v_exp_f32 v124, v124 clamp
    v_exp_f32 v125, v125 clamp
    v_exp_f32 v126, v126 clamp
    buffer_load_dwordx4 v6, s[60:63], s19 offen offset:2048 lds
    v_exp_f32 v127, v127 clamp
    v_max_f32 v152, 0x358637bd, v152
    v_max_f32 v153, 0x358637bd, v153
    v_max_f32 v154, 0x358637bd, v154
    v_max_f32 v155, 0x358637bd, v155
    v_max_f32 v156, 0x358637bd, v156
    v_max_f32 v157, 0x358637bd, v157
    v_max_f32 v158, 0x358637bd, v158
    v_max_f32 v159, 0x358637bd, v159
    v_pk_add_f32 v[152:153], v[152:153], v[120:121]
    v_pk_add_f32 v[154:155], v[154:155], v[122:123]
    v_pk_add_f32 v[156:157], v[156:157], v[124:125]
    v_pk_add_f32 v[158:159], v[158:159], v[126:127]
    v_cvt_pk_bf16_f32 v148, v152, v153
    v_cvt_pk_bf16_f32 v149, v154, v155
    v_cvt_pk_bf16_f32 v150, v156, v157
    buffer_load_dwordx4 v7, s[60:63], s19 offen offset:3072 lds
    s_add_u32 m0, s5, 0
    v_cvt_pk_bf16_f32 v151, v158, v159
    s_waitcnt lgkmcnt(1)
    v_pk_add_f32 v[68:69], v[68:69], v[76:77]
    v_pk_add_f32 v[70:71], v[70:71], v[78:79]
    s_waitcnt lgkmcnt(0)
    v_pk_add_f32 v[72:73], v[72:73], v[80:81]
    v_pk_add_f32 v[74:75], v[74:75], v[82:83]
    v_cvt_pk_bf16_f32 v68, v68, v69
    v_cvt_pk_bf16_f32 v69, v70, v71
    v_cvt_pk_bf16_f32 v70, v72, v73
    v_cvt_pk_bf16_f32 v71, v74, v75
    s_lshl_b32 s97, s7, 6
    s_add_u32 s97, s97, 229376
    s_add_u32 s96, s97, s11
    s_add_u32 s97, s97, s12
    buffer_load_dwordx4 v6, s[56:59], s20 offen lds
    v_mfma_f32_16x16x16_bf16 v[168:171], v[68:69], v[128:129], 0
    v_mfma_f32_16x16x16_bf16 v[172:175], v[70:71], v[130:131], 0
    v_mfma_f32_16x16x16_bf16 v[160:163], v[64:65], v[128:129], 0
    v_mfma_f32_16x16x16_bf16 v[164:167], v[66:67], v[130:131], 0
    v_mfma_f32_16x16x16_bf16 v[184:187], v[68:69], v[132:133], 0
    buffer_load_dwordx4 v7, s[56:59], s20 offen offset:1024 lds
    v_mfma_f32_16x16x16_bf16 v[188:191], v[70:71], v[134:135], 0
    v_mfma_f32_16x16x16_bf16 v[176:179], v[64:65], v[132:133], 0
    v_mfma_f32_16x16x16_bf16 v[180:183], v[66:67], v[134:135], 0
    v_mfma_f32_16x16x16_bf16 v[92:95], v[68:69], v[144:145], 0
    v_mfma_f32_16x16x16_bf16 v[96:99], v[70:71], v[146:147], 0
    buffer_load_dwordx4 v6, s[60:63], s20 offen offset:2048 lds
    v_mfma_f32_16x16x16_bf16 v[84:87], v[64:65], v[144:145], 0
    v_mfma_f32_16x16x16_bf16 v[88:91], v[66:67], v[146:147], 0
    v_mfma_f32_16x16x16_bf16 v[108:111], v[68:69], v[148:149], 0
    v_mfma_f32_16x16x16_bf16 v[112:115], v[70:71], v[150:151], 0
    v_mfma_f32_16x16x16_bf16 v[100:103], v[64:65], v[148:149], 0
    buffer_load_dwordx4 v7, s[60:63], s20 offen offset:3072 lds
    v_mfma_f32_16x16x16_bf16 v[104:107], v[66:67], v[150:151], 0
    v_add_f32 v120, 0x358637bd, v168
    v_add_f32 v121, 0x358637bd, v172
    v_add_f32 v122, 0x358637bd, v184
    v_add_f32 v123, 0x358637bd, v188
    v_add_f32 v124, 0x358637bd, v92
    v_add_f32 v125, 0x358637bd, v96
    v_add_f32 v126, 0x358637bd, v108
    v_add_f32 v127, 0x358637bd, v112
    v_rcp_f32 v120, v120
    v_rcp_f32 v121, v121
    v_rcp_f32 v122, v122
    v_rcp_f32 v123, v123
    v_rcp_f32 v124, v124
    v_rcp_f32 v125, v125
    v_rcp_f32 v126, v126
    v_rcp_f32 v127, v127
    v_pk_mul_f32 v[160:161], v[160:161], v[120:121] op_sel_hi:[1,0]
    v_pk_mul_f32 v[162:163], v[162:163], v[120:121] op_sel_hi:[1,0]
    v_pk_mul_f32 v[164:165], v[164:165], v[120:121] op_sel:[0,1] op_sel_hi:[1,1]
    v_pk_mul_f32 v[166:167], v[166:167], v[120:121] op_sel:[0,1] op_sel_hi:[1,1]
    v_cvt_pk_bf16_f32 v136, v160, v161
    v_cvt_pk_bf16_f32 v137, v162, v163
    v_cvt_pk_bf16_f32 v138, v164, v165
    v_cvt_pk_bf16_f32 v139, v166, v167
    buffer_store_dwordx4 v[136:139], v1, s[52:55], s96 offen sc1
    v_pk_mul_f32 v[176:177], v[176:177], v[122:123] op_sel_hi:[1,0]
    v_pk_mul_f32 v[178:179], v[178:179], v[122:123] op_sel_hi:[1,0]
    v_pk_mul_f32 v[180:181], v[180:181], v[122:123] op_sel:[0,1] op_sel_hi:[1,1]
    v_pk_mul_f32 v[182:183], v[182:183], v[122:123] op_sel:[0,1] op_sel_hi:[1,1]
    v_cvt_pk_bf16_f32 v140, v176, v177
    v_cvt_pk_bf16_f32 v141, v178, v179
    v_cvt_pk_bf16_f32 v142, v180, v181
    v_cvt_pk_bf16_f32 v143, v182, v183
    buffer_store_dwordx4 v[140:143], v1, s[52:55], s96 offen offset:1024 sc1
    v_pk_mul_f32 v[84:85], v[84:85], v[124:125] op_sel_hi:[1,0]
    v_pk_mul_f32 v[86:87], v[86:87], v[124:125] op_sel_hi:[1,0]
    v_pk_mul_f32 v[88:89], v[88:89], v[124:125] op_sel:[0,1] op_sel_hi:[1,1]
    v_pk_mul_f32 v[90:91], v[90:91], v[124:125] op_sel:[0,1] op_sel_hi:[1,1]
    v_cvt_pk_bf16_f32 v152, v84, v85
    v_cvt_pk_bf16_f32 v153, v86, v87
    v_cvt_pk_bf16_f32 v154, v88, v89
    v_cvt_pk_bf16_f32 v155, v90, v91
    buffer_store_dwordx4 v[152:155], v1, s[52:55], s97 offen sc1
    v_pk_mul_f32 v[100:101], v[100:101], v[126:127] op_sel_hi:[1,0]
    v_pk_mul_f32 v[102:103], v[102:103], v[126:127] op_sel_hi:[1,0]
    v_pk_mul_f32 v[104:105], v[104:105], v[126:127] op_sel:[0,1] op_sel_hi:[1,1]
    v_pk_mul_f32 v[106:107], v[106:107], v[126:127] op_sel:[0,1] op_sel_hi:[1,1]
    v_cvt_pk_bf16_f32 v156, v100, v101
    v_cvt_pk_bf16_f32 v157, v102, v103
    v_cvt_pk_bf16_f32 v158, v104, v105
    v_cvt_pk_bf16_f32 v159, v106, v107
    buffer_store_dwordx4 v[156:159], v1, s[52:55], s97 offen offset:1024 sc1
    ds_read_b64_tr_b16 a[0:1], v21 offset:16384
    ds_read_b64_tr_b16 a[2:3], v21 offset:18432
    ds_read_b64_tr_b16 a[4:5], v24 offset:16384
    ds_read_b64_tr_b16 a[6:7], v24 offset:18432
    ds_read_b64_tr_b16 a[8:9], v27 offset:16384
    v_mfma_f32_16x16x32_bf16 v[192:195], v[56:59], a[128:131], 0
    ds_read_b64_tr_b16 v[48:49], v20 offset:32768
    ds_read_b64_tr_b16 a[10:11], v27 offset:18432
    ds_read_b64_tr_b16 a[12:13], v30 offset:16384
    v_mfma_f32_16x16x32_bf16 v[208:211], v[56:59], a[132:135], 0
    ds_read_b64_tr_b16 v[50:51], v20 offset:34816
    ds_read_b64_tr_b16 a[14:15], v30 offset:18432
    v_mfma_f32_16x16x32_bf16 v[224:227], v[56:59], a[136:139], 0
    ds_read_b64_tr_b16 v[52:53], v23 offset:32768
    s_waitcnt vmcnt(16)
    ds_read_b64_tr_b16 a[16:17], v21 offset:32768
    v_mfma_f32_16x16x32_bf16 v[240:243], v[56:59], a[140:143], 0
    ds_read_b64_tr_b16 v[54:55], v23 offset:34816
    ds_read_b64_tr_b16 a[18:19], v21 offset:34816
    ds_read_b64_tr_b16 a[20:21], v24 offset:32768
    v_mfma_f32_16x16x32_bf16 v[196:199], v[60:63], a[128:131], 0
    s_waitcnt lgkmcnt(14)
    ds_read_b64_tr_b16 a[22:23], v24 offset:34816
    s_waitcnt lgkmcnt(14)
    ds_read_b64_tr_b16 a[24:25], v27 offset:32768
    v_mfma_f32_16x16x32_bf16 v[212:215], v[60:63], a[132:135], 0
    s_waitcnt lgkmcnt(14)
    ds_read_b64_tr_b16 a[26:27], v27 offset:34816
    s_waitcnt lgkmcnt(14)
    ds_read_b64_tr_b16 a[28:29], v30 offset:32768
    v_mfma_f32_16x16x32_bf16 v[228:231], v[60:63], a[136:139], 0
    s_waitcnt lgkmcnt(14)
    ds_read_b64_tr_b16 a[30:31], v30 offset:34816
    s_waitcnt lgkmcnt(10)
    v_mfma_f32_16x16x32_bf16 v[244:247], v[60:63], a[140:143], 0
    s_add_u32 m0, s5, 81920
    s_nop 0
    buffer_load_dwordx4 v6, s[56:59], s21 offen lds
    v_mfma_f32_16x16x32_bf16 v[200:203], v[40:43], a[128:131], 0
    ds_read_b64_tr_b16 v[56:57], v26 offset:32768
    s_waitcnt vmcnt(13)
    ds_read_b64_tr_b16 a[32:33], v21 offset:49152
    v_mfma_f32_16x16x32_bf16 v[216:219], v[40:43], a[132:135], 0
    ds_read_b64_tr_b16 v[58:59], v26 offset:34816
    ds_read_b64_tr_b16 a[34:35], v21 offset:51200
    ds_read_b64_tr_b16 a[36:37], v24 offset:49152
    v_mfma_f32_16x16x32_bf16 v[232:235], v[40:43], a[136:139], 0
    s_waitcnt lgkmcnt(14)
    ds_read_b64_tr_b16 v[60:61], v29 offset:32768
    s_waitcnt lgkmcnt(14)
    ds_read_b64_tr_b16 a[38:39], v24 offset:51200
    v_mfma_f32_16x16x32_bf16 v[248:251], v[40:43], a[140:143], 0
    s_waitcnt lgkmcnt(14)
    ds_read_b64_tr_b16 v[62:63], v29 offset:34816
    buffer_load_dwordx4 v7, s[56:59], s21 offen offset:1024 lds
    v_mfma_f32_16x16x32_bf16 v[204:207], v[44:47], a[128:131], 0
    s_waitcnt lgkmcnt(14)
    ds_read_b64_tr_b16 a[40:41], v27 offset:49152
    s_waitcnt lgkmcnt(14)
    ds_read_b64_tr_b16 a[42:43], v27 offset:51200
    v_mfma_f32_16x16x32_bf16 v[220:223], v[44:47], a[132:135], 0
    s_waitcnt lgkmcnt(14)
    ds_read_b64_tr_b16 a[44:45], v30 offset:49152
    s_waitcnt lgkmcnt(14)
    ds_read_b64_tr_b16 a[46:47], v30 offset:51200
    v_mfma_f32_16x16x32_bf16 v[236:239], v[44:47], a[136:139], 0
    s_waitcnt lgkmcnt(12) vmcnt(10)
    ds_read_b64_tr_b16 a[48:49], v22 offset:0
    ds_read_b64_tr_b16 a[50:51], v22 offset:2048
    v_mfma_f32_16x16x32_bf16 v[252:255], v[44:47], a[140:143], 0
    buffer_load_dwordx4 v6, s[60:63], s21 offen offset:2048 lds
    ds_read_b64_tr_b16 a[52:53], v25 offset:0
    v_mfma_f32_16x16x32_bf16 v[192:195], v[48:51], a[144:147], v[192:195]
    s_waitcnt lgkmcnt(14)
    ds_read_b64_tr_b16 v[40:41], v20 offset:49152
    s_waitcnt lgkmcnt(14)
    ds_read_b64_tr_b16 a[54:55], v25 offset:2048
    v_mfma_f32_16x16x32_bf16 v[208:211], v[48:51], a[148:151], v[208:211]
    s_waitcnt lgkmcnt(14)
    ds_read_b64_tr_b16 v[42:43], v20 offset:51200
    s_waitcnt lgkmcnt(14)
    ds_read_b64_tr_b16 a[56:57], v28 offset:0
    v_mfma_f32_16x16x32_bf16 v[224:227], v[48:51], a[152:155], v[224:227]
    s_waitcnt lgkmcnt(14)
    ds_read_b64_tr_b16 v[44:45], v23 offset:49152
    s_waitcnt lgkmcnt(14)
    ds_read_b64_tr_b16 a[58:59], v28 offset:2048
    v_mfma_f32_16x16x32_bf16 v[240:243], v[48:51], a[156:159], v[240:243]
    s_waitcnt lgkmcnt(14)
    ds_read_b64_tr_b16 v[46:47], v23 offset:51200
    buffer_load_dwordx4 v7, s[60:63], s21 offen offset:3072 lds
    v_mfma_f32_16x16x32_bf16 v[196:199], v[52:55], a[144:147], v[196:199]
    s_add_u32 m0, s5, 16384
    s_waitcnt lgkmcnt(14)
    ds_read_b64_tr_b16 a[60:61], v31 offset:0
    v_mfma_f32_16x16x32_bf16 v[212:215], v[52:55], a[148:151], v[212:215]
    s_waitcnt lgkmcnt(14)
    ds_read_b64_tr_b16 a[62:63], v31 offset:2048
    s_waitcnt lgkmcnt(12)
    v_mfma_f32_16x16x32_bf16 v[228:231], v[52:55], a[152:155], v[228:231]
    s_waitcnt vmcnt(8)
    ds_read_b64_tr_b16 a[64:65], v20 offset:0
    ds_read_b64_tr_b16 a[66:67], v20 offset:2048
    v_mfma_f32_16x16x32_bf16 v[244:247], v[52:55], a[156:159], v[244:247]
    buffer_load_dwordx4 v6, s[56:59], s22 offen lds
    ds_read_b64_tr_b16 a[68:69], v23 offset:0
    v_mfma_f32_16x16x32_bf16 v[200:203], v[56:59], a[144:147], v[200:203]
    s_waitcnt lgkmcnt(14)
    ds_read_b64_tr_b16 v[48:49], v26 offset:49152
    s_waitcnt lgkmcnt(14)
    ds_read_b64_tr_b16 a[70:71], v23 offset:2048
    v_mfma_f32_16x16x32_bf16 v[216:219], v[56:59], a[148:151], v[216:219]
    s_waitcnt lgkmcnt(14)
    ds_read_b64_tr_b16 v[50:51], v26 offset:51200
    s_waitcnt lgkmcnt(14)
    ds_read_b64_tr_b16 a[72:73], v26 offset:0
    v_mfma_f32_16x16x32_bf16 v[232:235], v[56:59], a[152:155], v[232:235]
    s_waitcnt lgkmcnt(14)
    ds_read_b64_tr_b16 v[52:53], v29 offset:49152
    s_waitcnt lgkmcnt(14)
    ds_read_b64_tr_b16 a[74:75], v26 offset:2048
    v_mfma_f32_16x16x32_bf16 v[248:251], v[56:59], a[156:159], v[248:251]
    s_waitcnt lgkmcnt(14)
    ds_read_b64_tr_b16 v[54:55], v29 offset:51200
    buffer_load_dwordx4 v7, s[56:59], s22 offen offset:1024 lds
    v_mfma_f32_16x16x32_bf16 v[204:207], v[60:63], a[144:147], v[204:207]
    s_waitcnt lgkmcnt(14)
    ds_read_b64_tr_b16 a[76:77], v29 offset:0
    s_waitcnt lgkmcnt(14)
    ds_read_b64_tr_b16 a[78:79], v29 offset:2048
    v_mfma_f32_16x16x32_bf16 v[220:223], v[60:63], a[148:151], v[220:223]
    s_waitcnt lgkmcnt(12)
    v_mfma_f32_16x16x32_bf16 v[236:239], v[60:63], a[152:155], v[236:239]
    v_mfma_f32_16x16x32_bf16 v[252:255], v[60:63], a[156:159], v[252:255]
    buffer_load_dwordx4 v6, s[60:63], s22 offen offset:2048 lds
    v_mfma_f32_16x16x32_bf16 v[192:195], v[40:43], a[160:163], v[192:195]
    ds_read_b64_tr_b16 v[56:57], v21 offset:0
    v_mfma_f32_16x16x32_bf16 v[208:211], v[40:43], a[164:167], v[208:211]
    ds_read_b64_tr_b16 v[58:59], v21 offset:2048
    v_mfma_f32_16x16x32_bf16 v[224:227], v[40:43], a[168:171], v[224:227]
    ds_read_b64_tr_b16 v[60:61], v24 offset:0
    v_mfma_f32_16x16x32_bf16 v[240:243], v[40:43], a[172:175], v[240:243]
    s_waitcnt lgkmcnt(14)
    ds_read_b64_tr_b16 v[62:63], v24 offset:2048
    buffer_load_dwordx4 v7, s[60:63], s22 offen offset:3072 lds
    v_mfma_f32_16x16x32_bf16 v[196:199], v[44:47], a[160:163], v[196:199]
    s_add_u32 m0, s5, 98304
    s_waitcnt lgkmcnt(4)
    v_mfma_f32_16x16x32_bf16 v[212:215], v[44:47], a[164:167], v[212:215]
    v_mfma_f32_16x16x32_bf16 v[228:231], v[44:47], a[168:171], v[228:231]
    v_mfma_f32_16x16x32_bf16 v[244:247], v[44:47], a[172:175], v[244:247]
    buffer_load_dwordx4 v6, s[56:59], s23 offen lds
    v_mfma_f32_16x16x32_bf16 v[200:203], v[48:51], a[160:163], v[200:203]
    ds_read_b64_tr_b16 v[40:41], v27 offset:0
    v_mfma_f32_16x16x32_bf16 v[216:219], v[48:51], a[164:167], v[216:219]
    ds_read_b64_tr_b16 v[42:43], v27 offset:2048
    v_mfma_f32_16x16x32_bf16 v[232:235], v[48:51], a[168:171], v[232:235]
    ds_read_b64_tr_b16 v[44:45], v30 offset:0
    v_mfma_f32_16x16x32_bf16 v[248:251], v[48:51], a[172:175], v[248:251]
    ds_read_b64_tr_b16 v[46:47], v30 offset:2048
    s_waitcnt vmcnt(9)
    buffer_store_dword v0, v37, s[52:55], s13 offen sc1
    s_add_u32 s13, s13, 4096
    v_mfma_f32_16x16x32_bf16 v[204:207], v[52:55], a[160:163], v[204:207]
    v_mfma_f32_16x16x32_bf16 v[220:223], v[52:55], a[164:167], v[220:223]
    v_mfma_f32_16x16x32_bf16 v[236:239], v[52:55], a[168:171], v[236:239]
    v_mfma_f32_16x16x32_bf16 v[252:255], v[52:55], a[172:175], v[252:255]
    buffer_load_dwordx4 v7, s[56:59], s23 offen offset:1024 lds
    s_waitcnt lgkmcnt(4)
    v_mfma_f32_16x16x32_bf16 v[192:195], v[56:59], a[176:179], v[192:195]
    v_mfma_f32_16x16x32_bf16 v[208:211], v[56:59], a[180:183], v[208:211]
    v_mfma_f32_16x16x32_bf16 v[224:227], v[56:59], a[184:187], v[224:227]
    v_mfma_f32_16x16x32_bf16 v[240:243], v[56:59], a[188:191], v[240:243]
    buffer_load_dwordx4 v6, s[60:63], s23 offen offset:2048 lds
    v_mfma_f32_16x16x32_bf16 v[196:199], v[60:63], a[176:179], v[196:199]
    v_mfma_f32_16x16x32_bf16 v[212:215], v[60:63], a[180:183], v[212:215]
    v_mfma_f32_16x16x32_bf16 v[228:231], v[60:63], a[184:187], v[228:231]
    v_mfma_f32_16x16x32_bf16 v[244:247], v[60:63], a[188:191], v[244:247]
    buffer_load_dwordx4 v7, s[60:63], s23 offen offset:3072 lds
    s_add_u32 m0, s5, 114688
    s_waitcnt lgkmcnt(0)
    v_mfma_f32_16x16x32_bf16 v[200:203], v[40:43], a[176:179], v[200:203]
    v_mfma_f32_16x16x32_bf16 v[216:219], v[40:43], a[180:183], v[216:219]
    v_mfma_f32_16x16x32_bf16 v[232:235], v[40:43], a[184:187], v[232:235]
    v_mfma_f32_16x16x32_bf16 v[248:251], v[40:43], a[188:191], v[248:251]
    buffer_load_dwordx4 v6, s[56:59], s6 offen lds
    v_mfma_f32_16x16x32_bf16 v[204:207], v[44:47], a[176:179], v[204:207]
    v_mfma_f32_16x16x32_bf16 v[220:223], v[44:47], a[180:183], v[220:223]
    v_mfma_f32_16x16x32_bf16 v[236:239], v[44:47], a[184:187], v[236:239]
    v_mfma_f32_16x16x32_bf16 v[252:255], v[44:47], a[188:191], v[252:255]
    buffer_load_dwordx4 v7, s[56:59], s6 offen offset:1024 lds
    buffer_load_dwordx4 v6, s[60:63], s6 offen offset:2048 lds
    buffer_load_dwordx4 v7, s[60:63], s6 offen offset:3072 lds
    s_add_u32 m0, s5, 32768
    s_xor_b32 s26, s6, 32768
    buffer_load_dwordx4 v6, s[56:59], s26 offen lds
    buffer_load_dwordx4 v7, s[56:59], s26 offen offset:1024 lds
    buffer_load_dwordx4 v6, s[60:63], s26 offen offset:2048 lds
    buffer_load_dwordx4 v7, s[60:63], s26 offen offset:3072 lds
    s_add_u32 m0, s5, 131072
    s_nop 0
    buffer_load_dwordx4 v6, s[64:67], s84 offen lds
    buffer_load_dwordx4 v7, s[64:67], s84 offen offset:1024 lds
    buffer_load_dwordx4 v6, s[68:71], s84 offen offset:2048 lds
    buffer_load_dwordx4 v[80:83], v33, s[52:55], s14 offen sc1
    buffer_load_dwordx4 v7, s[68:71], s84 offen offset:3072 lds
    s_add_u32 m0, s5, 0
    s_nop 0
    buffer_load_dwordx4 v6, s[64:67], s85 offen lds
    buffer_load_dwordx4 v7, s[64:67], s85 offen offset:1024 lds
    buffer_load_dwordx4 v6, s[68:71], s85 offen offset:2048 lds
    buffer_load_dwordx4 v7, s[68:71], s85 offen offset:3072 lds
    s_add_u32 m0, s5, 49152
    s_nop 0
    buffer_load_dwordx4 v6, s[64:67], s86 offen lds
    buffer_load_dwordx4 v7, s[64:67], s86 offen offset:1024 lds
    buffer_load_dwordx4 v6, s[68:71], s86 offen offset:2048 lds
    buffer_load_dwordx4 v7, s[68:71], s86 offen offset:3072 lds
    s_add_u32 m0, s5, 65536
    s_nop 0
    buffer_load_dwordx4 v6, s[64:67], s87 offen lds
    buffer_load_dwordx4 v7, s[64:67], s87 offen offset:1024 lds
    buffer_load_dwordx4 v6, s[68:71], s87 offen offset:2048 lds
    buffer_load_dwordx4 v7, s[68:71], s87 offen offset:3072 lds
    s_waitcnt vmcnt(13)
    v_cmp_eq_u32 vcc, 0, v80
    s_nop 0
    s_and_b32 s91, vcc_lo, 255
    s_cbranch_scc1 LA_poll3_retry
LA_poll3_ok:
    v_subrev_u32 v35, 2048, v33
    v_lshrrev_b32 v35, 3, v35
    v_add_u32 v35, 159744, v35
    ds_write_b128 v35, v[80:83]
    s_add_u32 s14, s14, 4096
    s_lshr_b32 s93, s16, 3
    buffer_load_dwordx4 a[128:131], v2, s[32:35], s93 offen sc1
    buffer_load_dwordx4 a[132:135], v3, s[32:35], s93 offen sc1
    buffer_load_dwordx4 a[136:139], v4, s[32:35], s93 offen sc1
    buffer_load_dwordx4 a[140:143], v5, s[32:35], s93 offen sc1
    s_lshr_b32 s93, s17, 3
    buffer_load_dwordx4 a[144:147], v2, s[32:35], s93 offen sc1
    buffer_load_dwordx4 a[148:151], v3, s[32:35], s93 offen sc1
    buffer_load_dwordx4 a[152:155], v4, s[32:35], s93 offen sc1
    buffer_load_dwordx4 a[156:159], v5, s[32:35], s93 offen sc1
    s_lshr_b32 s93, s18, 3
    buffer_load_dwordx4 a[160:163], v2, s[32:35], s93 offen sc1
    buffer_load_dwordx4 a[164:167], v3, s[32:35], s93 offen sc1
    buffer_load_dwordx4 a[168:171], v4, s[32:35], s93 offen sc1
    buffer_load_dwordx4 a[172:175], v5, s[32:35], s93 offen sc1
    s_waitcnt vmcnt(11)
    v_mfma_f32_16x16x32_bf16 v[192:195], a[0:3], a[128:131], v[192:195]
    s_waitcnt vmcnt(10)
    v_mfma_f32_16x16x32_bf16 v[208:211], a[0:3], a[132:135], v[208:211]
    s_waitcnt vmcnt(9)
    v_mfma_f32_16x16x32_bf16 v[224:227], a[0:3], a[136:139], v[224:227]
    s_waitcnt vmcnt(8)
    v_mfma_f32_16x16x32_bf16 v[240:243], a[0:3], a[140:143], v[240:243]
    s_lshr_b32 s93, s19, 3
    buffer_load_dwordx4 a[176:179], v2, s[32:35], s93 offen sc1
    v_mfma_f32_16x16x32_bf16 v[196:199], a[4:7], a[128:131], v[196:199]
    v_mfma_f32_16x16x32_bf16 v[212:215], a[4:7], a[132:135], v[212:215]
    v_mfma_f32_16x16x32_bf16 v[228:231], a[4:7], a[136:139], v[228:231]
    v_mfma_f32_16x16x32_bf16 v[244:247], a[4:7], a[140:143], v[244:247]
    buffer_load_dwordx4 a[180:183], v3, s[32:35], s93 offen sc1
    v_mfma_f32_16x16x32_bf16 v[200:203], a[8:11], a[128:131], v[200:203]
    v_mfma_f32_16x16x32_bf16 v[216:219], a[8:11], a[132:135], v[216:219]
    v_mfma_f32_16x16x32_bf16 v[232:235], a[8:11], a[136:139], v[232:235]
    v_mfma_f32_16x16x32_bf16 v[248:251], a[8:11], a[140:143], v[248:251]
    buffer_load_dwordx4 a[184:187], v4, s[32:35], s93 offen sc1
    v_mfma_f32_16x16x32_bf16 v[204:207], a[12:15], a[128:131], v[204:207]
    v_mfma_f32_16x16x32_bf16 v[220:223], a[12:15], a[132:135], v[220:223]
    v_mfma_f32_16x16x32_bf16 v[236:239], a[12:15], a[136:139], v[236:239]
    v_mfma_f32_16x16x32_bf16 v[252:255], a[12:15], a[140:143], v[252:255]
    buffer_load_dwordx4 a[188:191], v5, s[32:35], s93 offen sc1
    s_waitcnt vmcnt(8)
    v_mfma_f32_16x16x32_bf16 v[192:195], a[16:19], a[144:147], v[192:195]
    v_mfma_f32_16x16x32_bf16 v[208:211], a[16:19], a[148:151], v[208:211]
    v_mfma_f32_16x16x32_bf16 v[224:227], a[16:19], a[152:155], v[224:227]
    v_mfma_f32_16x16x32_bf16 v[240:243], a[16:19], a[156:159], v[240:243]
    s_lshr_b32 s93, s20, 3
    buffer_load_dwordx4 a[128:131], v2, s[32:35], s93 offen sc1
    v_mfma_f32_16x16x32_bf16 v[196:199], a[20:23], a[144:147], v[196:199]
    v_mfma_f32_16x16x32_bf16 v[212:215], a[20:23], a[148:151], v[212:215]
    v_mfma_f32_16x16x32_bf16 v[228:231], a[20:23], a[152:155], v[228:231]
    v_mfma_f32_16x16x32_bf16 v[244:247], a[20:23], a[156:159], v[244:247]
    buffer_load_dwordx4 a[132:135], v3, s[32:35], s93 offen sc1
    v_mfma_f32_16x16x32_bf16 v[200:203], a[24:27], a[144:147], v[200:203]
    v_mfma_f32_16x16x32_bf16 v[216:219], a[24:27], a[148:151], v[216:219]
    v_mfma_f32_16x16x32_bf16 v[232:235], a[24:27], a[152:155], v[232:235]
    v_mfma_f32_16x16x32_bf16 v[248:251], a[24:27], a[156:159], v[248:251]
    buffer_load_dwordx4 a[136:139], v4, s[32:35], s93 offen sc1
    v_mfma_f32_16x16x32_bf16 v[204:207], a[28:31], a[144:147], v[204:207]
    v_mfma_f32_16x16x32_bf16 v[220:223], a[28:31], a[148:151], v[220:223]
    v_mfma_f32_16x16x32_bf16 v[236:239], a[28:31], a[152:155], v[236:239]
    v_mfma_f32_16x16x32_bf16 v[252:255], a[28:31], a[156:159], v[252:255]
    buffer_load_dwordx4 a[140:143], v5, s[32:35], s93 offen sc1
    s_waitcnt vmcnt(8)
    v_mfma_f32_16x16x32_bf16 v[192:195], a[32:35], a[160:163], v[192:195]
    v_mfma_f32_16x16x32_bf16 v[208:211], a[32:35], a[164:167], v[208:211]
    v_mfma_f32_16x16x32_bf16 v[224:227], a[32:35], a[168:171], v[224:227]
    v_mfma_f32_16x16x32_bf16 v[240:243], a[32:35], a[172:175], v[240:243]
    buffer_load_dword v35, v33, s[52:55], s14 offen sc1
    v_mfma_f32_16x16x32_bf16 v[196:199], a[36:39], a[160:163], v[196:199]
    v_mfma_f32_16x16x32_bf16 v[212:215], a[36:39], a[164:167], v[212:215]
    v_mfma_f32_16x16x32_bf16 v[228:231], a[36:39], a[168:171], v[228:231]
    v_mfma_f32_16x16x32_bf16 v[244:247], a[36:39], a[172:175], v[244:247]
    s_lshr_b32 s93, s21, 3
    buffer_load_dwordx4 a[144:147], v2, s[32:35], s93 offen sc1
    v_mfma_f32_16x16x32_bf16 v[200:203], a[40:43], a[160:163], v[200:203]
    v_mfma_f32_16x16x32_bf16 v[216:219], a[40:43], a[164:167], v[216:219]
    v_mfma_f32_16x16x32_bf16 v[232:235], a[40:43], a[168:171], v[232:235]
    v_mfma_f32_16x16x32_bf16 v[248:251], a[40:43], a[172:175], v[248:251]
    buffer_load_dwordx4 a[148:151], v3, s[32:35], s93 offen sc1
    v_mfma_f32_16x16x32_bf16 v[204:207], a[44:47], a[160:163], v[204:207]
    v_mfma_f32_16x16x32_bf16 v[220:223], a[44:47], a[164:167], v[220:223]
    v_mfma_f32_16x16x32_bf16 v[236:239], a[44:47], a[168:171], v[236:239]
    v_mfma_f32_16x16x32_bf16 v[252:255], a[44:47], a[172:175], v[252:255]
    buffer_load_dwordx4 a[152:155], v4, s[32:35], s93 offen sc1
    s_waitcnt vmcnt(8)
    v_mfma_f32_16x16x32_bf16 v[192:195], a[48:51], a[176:179], v[192:195]
    v_mfma_f32_16x16x32_bf16 v[208:211], a[48:51], a[180:183], v[208:211]
    v_mfma_f32_16x16x32_bf16 v[224:227], a[48:51], a[184:187], v[224:227]
    v_mfma_f32_16x16x32_bf16 v[240:243], a[48:51], a[188:191], v[240:243]
    buffer_load_dwordx4 a[156:159], v5, s[32:35], s93 offen sc1
    v_mfma_f32_16x16x32_bf16 v[196:199], a[52:55], a[176:179], v[196:199]
    v_mfma_f32_16x16x32_bf16 v[212:215], a[52:55], a[180:183], v[212:215]
    v_mfma_f32_16x16x32_bf16 v[228:231], a[52:55], a[184:187], v[228:231]
    v_mfma_f32_16x16x32_bf16 v[244:247], a[52:55], a[188:191], v[244:247]
    s_lshr_b32 s93, s22, 3
    buffer_load_dwordx4 a[160:163], v2, s[32:35], s93 offen sc1
    v_mfma_f32_16x16x32_bf16 v[200:203], a[56:59], a[176:179], v[200:203]
    v_mfma_f32_16x16x32_bf16 v[216:219], a[56:59], a[180:183], v[216:219]
    v_mfma_f32_16x16x32_bf16 v[232:235], a[56:59], a[184:187], v[232:235]
    v_mfma_f32_16x16x32_bf16 v[248:251], a[56:59], a[188:191], v[248:251]
    buffer_load_dwordx4 a[164:167], v3, s[32:35], s93 offen sc1
    v_mfma_f32_16x16x32_bf16 v[204:207], a[60:63], a[176:179], v[204:207]
    v_mfma_f32_16x16x32_bf16 v[220:223], a[60:63], a[180:183], v[220:223]
    v_mfma_f32_16x16x32_bf16 v[236:239], a[60:63], a[184:187], v[236:239]
    v_mfma_f32_16x16x32_bf16 v[252:255], a[60:63], a[188:191], v[252:255]
    buffer_load_dwordx4 a[168:171], v4, s[32:35], s93 offen sc1
    s_waitcnt vmcnt(8)
    v_mfma_f32_16x16x32_bf16 v[192:195], a[64:67], a[128:131], v[192:195]
    ds_read_b64_tr_b16 v[56:57], v21 offset:16384
    ds_read_b64_tr_b16 a[0:1], v22 offset:0
    ds_read_b64_tr_b16 a[2:3], v22 offset:2048
    v_mfma_f32_16x16x32_bf16 v[208:211], a[64:67], a[132:135], v[208:211]
    ds_read_b64_tr_b16 v[58:59], v21 offset:18432
    ds_read_b64_tr_b16 a[4:5], v25 offset:0
    ds_read_b64_tr_b16 a[6:7], v25 offset:2048
    v_mfma_f32_16x16x32_bf16 v[224:227], a[64:67], a[136:139], v[224:227]
    ds_read_b64_tr_b16 v[60:61], v24 offset:16384
    ds_read_b64_tr_b16 a[8:9], v28 offset:0
    ds_read_b64_tr_b16 a[10:11], v28 offset:2048
    v_mfma_f32_16x16x32_bf16 v[240:243], a[64:67], a[140:143], v[240:243]
    ds_read_b64_tr_b16 v[62:63], v24 offset:18432
    buffer_load_dwordx4 a[172:175], v5, s[32:35], s93 offen sc1
    ds_read_b64_tr_b16 a[12:13], v31 offset:0
    v_mfma_f32_16x16x32_bf16 v[196:199], a[68:71], a[128:131], v[196:199]
    ds_read_b64_tr_b16 a[14:15], v31 offset:2048
    ds_read_b64_tr_b16 a[16:17], v20 offset:0
    ds_read_b64_tr_b16 a[18:19], v20 offset:2048
    v_mfma_f32_16x16x32_bf16 v[212:215], a[68:71], a[132:135], v[212:215]
    s_waitcnt lgkmcnt(14)
    ds_read_b64_tr_b16 a[20:21], v23 offset:0
    s_waitcnt lgkmcnt(14)
    ds_read_b64_tr_b16 a[22:23], v23 offset:2048
    v_mfma_f32_16x16x32_bf16 v[228:231], a[68:71], a[136:139], v[228:231]
    s_waitcnt lgkmcnt(14)
    ds_read_b64_tr_b16 a[24:25], v26 offset:0
    s_waitcnt lgkmcnt(14)
    ds_read_b64_tr_b16 a[26:27], v26 offset:2048
    v_mfma_f32_16x16x32_bf16 v[244:247], a[68:71], a[140:143], v[244:247]
    s_lshr_b32 s93, s23, 3
    buffer_load_dwordx4 a[176:179], v2, s[32:35], s93 offen sc1
    v_mfma_f32_16x16x32_bf16 v[200:203], a[72:75], a[128:131], v[200:203]
    s_waitcnt lgkmcnt(14)
    ds_read_b64_tr_b16 v[40:41], v27 offset:16384
    s_waitcnt lgkmcnt(14)
    ds_read_b64_tr_b16 a[28:29], v29 offset:0
    v_mfma_f32_16x16x32_bf16 v[216:219], a[72:75], a[132:135], v[216:219]
    s_waitcnt lgkmcnt(14)
    ds_read_b64_tr_b16 v[42:43], v27 offset:18432
    s_waitcnt lgkmcnt(14)
    ds_read_b64_tr_b16 a[30:31], v29 offset:2048
    v_mfma_f32_16x16x32_bf16 v[232:235], a[72:75], a[136:139], v[232:235]
    s_waitcnt lgkmcnt(14)
    ds_read_b64_tr_b16 v[44:45], v30 offset:16384
    s_waitcnt lgkmcnt(11)
    v_mfma_f32_16x16x32_bf16 v[248:251], a[72:75], a[140:143], v[248:251]
    ds_read_b64_tr_b16 v[46:47], v30 offset:18432
    buffer_load_dwordx4 a[180:183], v3, s[32:35], s93 offen sc1
    v_mfma_f32_16x16x32_bf16 v[204:207], a[76:79], a[128:131], v[204:207]
    ds_read_b64_tr_b16 a[32:33], v20 offset:49152
    ds_read_b64_tr_b16 a[34:35], v20 offset:51200
    ds_read_b64_tr_b16 a[36:37], v23 offset:49152
    v_mfma_f32_16x16x32_bf16 v[220:223], a[76:79], a[132:135], v[220:223]
    s_waitcnt lgkmcnt(14)
    ds_read_b64_tr_b16 a[38:39], v23 offset:51200
    s_waitcnt lgkmcnt(14)
    ds_read_b64_tr_b16 a[40:41], v26 offset:49152
    v_mfma_f32_16x16x32_bf16 v[236:239], a[76:79], a[136:139], v[236:239]
    s_waitcnt lgkmcnt(14)
    ds_read_b64_tr_b16 a[42:43], v26 offset:51200
    s_waitcnt lgkmcnt(14)
    ds_read_b64_tr_b16 a[44:45], v29 offset:49152
    v_mfma_f32_16x16x32_bf16 v[252:255], a[76:79], a[140:143], v[252:255]
    buffer_load_dwordx4 a[184:187], v4, s[32:35], s93 offen sc1
    s_waitcnt lgkmcnt(14)
    ds_read_b64_tr_b16 a[46:47], v29 offset:51200
    s_waitcnt vmcnt(7)
    v_mfma_f32_16x16x32_bf16 v[192:195], v[56:59], a[144:147], v[192:195]
    s_waitcnt lgkmcnt(14)
    ds_read_b64_tr_b16 v[48:49], v20 offset:16384
    s_waitcnt lgkmcnt(11)
    v_mfma_f32_16x16x32_bf16 v[208:211], v[56:59], a[148:151], v[208:211]
    ds_read_b64_tr_b16 v[50:51], v20 offset:18432
    ds_read_b64_tr_b16 a[48:49], v21 offset:0
    ds_read_b64_tr_b16 a[50:51], v21 offset:2048
    v_mfma_f32_16x16x32_bf16 v[224:227], v[56:59], a[152:155], v[224:227]
    ds_read_b64_tr_b16 v[52:53], v23 offset:16384
    s_waitcnt lgkmcnt(14)
    ds_read_b64_tr_b16 a[52:53], v24 offset:0
    v_mfma_f32_16x16x32_bf16 v[240:243], v[56:59], a[156:159], v[240:243]
    s_waitcnt lgkmcnt(14)
    ds_read_b64_tr_b16 v[54:55], v23 offset:18432
    buffer_load_dwordx4 a[188:191], v5, s[32:35], s93 offen sc1
    v_mfma_f32_16x16x32_bf16 v[196:199], v[60:63], a[144:147], v[196:199]
    s_barrier
    v_cmp_eq_u32 vcc, 0, v35
    s_nop 0
    s_and_b32 s91, vcc_lo, 255
    s_cbranch_scc1 LA_poll4_retry
LA_poll4_ok:
    v_mfma_f32_16x16x32_bf16 v[212:215], v[60:63], a[148:151], v[212:215]
    s_waitcnt lgkmcnt(14)
    ds_read_b64_tr_b16 a[54:55], v24 offset:2048
    s_waitcnt lgkmcnt(14)
    ds_read_b64_tr_b16 a[56:57], v27 offset:0
    v_mfma_f32_16x16x32_bf16 v[228:231], v[60:63], a[152:155], v[228:231]
    s_waitcnt lgkmcnt(14)
    ds_read_b64_tr_b16 a[58:59], v27 offset:2048
    s_waitcnt lgkmcnt(14)
    ds_read_b64_tr_b16 a[60:61], v30 offset:0
    v_mfma_f32_16x16x32_bf16 v[244:247], v[60:63], a[156:159], v[244:247]
    s_lshr_b32 s93, s6, 3
    buffer_load_dwordx4 a[128:131], v2, s[32:35], s93 offen sc1
    v_mfma_f32_16x16x32_bf16 v[200:203], v[40:43], a[144:147], v[200:203]
    s_waitcnt lgkmcnt(14)
    ds_read_b64_tr_b16 v[56:57], v26 offset:16384
    s_waitcnt lgkmcnt(14)
    ds_read_b64_tr_b16 a[62:63], v30 offset:2048
    v_mfma_f32_16x16x32_bf16 v[216:219], v[40:43], a[148:151], v[216:219]
    s_waitcnt lgkmcnt(14)
    ds_read_b64_tr_b16 v[58:59], v26 offset:18432
    s_waitcnt lgkmcnt(14)
    v_mfma_f32_16x16x32_bf16 v[232:235], v[40:43], a[152:155], v[232:235]
    ds_read_b64_tr_b16 v[60:61], v29 offset:16384
    v_lshrrev_b32 v64, 10, v2
    v_lshl_add_u32 v64, v64, 6, v34
    v_mfma_f32_16x16x32_bf16 v[248:251], v[40:43], a[156:159], v[248:251]
    s_waitcnt lgkmcnt(14)
    ds_read_b64_tr_b16 v[62:63], v29 offset:18432
    buffer_load_dwordx4 a[132:135], v3, s[32:35], s93 offen sc1
    v_mfma_f32_16x16x32_bf16 v[204:207], v[44:47], a[144:147], v[204:207]
    s_waitcnt lgkmcnt(14)
    ds_read_b32 v84, v64
    v_lshrrev_b32 v64, 10, v3
    v_mfma_f32_16x16x32_bf16 v[220:223], v[44:47], a[148:151], v[220:223]
    v_lshl_add_u32 v64, v64, 6, v34
    s_waitcnt lgkmcnt(14)
    ds_read_b32 v85, v64
    v_mfma_f32_16x16x32_bf16 v[236:239], v[44:47], a[152:155], v[236:239]
    v_lshrrev_b32 v64, 10, v4
    v_lshl_add_u32 v64, v64, 6, v34
    s_waitcnt lgkmcnt(14)
    ds_read_b32 v86, v64
    v_mfma_f32_16x16x32_bf16 v[252:255], v[44:47], a[156:159], v[252:255]
    buffer_load_dwordx4 a[136:139], v4, s[32:35], s93 offen sc1
    s_waitcnt lgkmcnt(6) vmcnt(7)
    v_mfma_f32_16x16x32_bf16 v[192:195], v[48:51], a[160:163], v[192:195]
    ds_read_b64_tr_b16 v[40:41], v21 offset:32768
    v_lshrrev_b32 v64, 10, v5
    v_lshl_add_u32 v64, v64, 6, v34
    v_mfma_f32_16x16x32_bf16 v[208:211], v[48:51], a[164:167], v[208:211]
    ds_read_b64_tr_b16 v[42:43], v21 offset:34816
    ds_read_b32 v87, v64
    v_mfma_f32_16x16x32_bf16 v[224:227], v[48:51], a[168:171], v[224:227]
    ds_read_b64_tr_b16 v[44:45], v24 offset:32768
    v_mfma_f32_16x16x32_bf16 v[240:243], v[48:51], a[172:175], v[240:243]
    ds_read_b64_tr_b16 v[46:47], v24 offset:34816
    buffer_load_dwordx4 a[140:143], v5, s[32:35], s93 offen sc1
    v_mfma_f32_16x16x32_bf16 v[196:199], v[52:55], a[160:163], v[196:199]
    v_mfma_f32_16x16x32_bf16 v[212:215], v[52:55], a[164:167], v[212:215]
    v_mfma_f32_16x16x32_bf16 v[228:231], v[52:55], a[168:171], v[228:231]
    v_mfma_f32_16x16x32_bf16 v[244:247], v[52:55], a[172:175], v[244:247]
    s_xor_b32 s93, s6, 32768
    s_lshr_b32 s93, s93, 3
    buffer_load_dwordx4 a[144:147], v2, s[32:35], s93 offen sc1
    s_waitcnt lgkmcnt(8)
    v_mfma_f32_16x16x32_bf16 v[200:203], v[56:59], a[160:163], v[200:203]
    ds_read_b64_tr_b16 v[48:49], v27 offset:32768
    s_waitcnt lgkmcnt(8)
    v_sub_f32 v88, 2.0, v84
    v_mfma_f32_16x16x32_bf16 v[216:219], v[56:59], a[164:167], v[216:219]
    ds_read_b64_tr_b16 v[50:51], v27 offset:34816
    v_subrev_f32 v84, 1.0, v84
    v_mfma_f32_16x16x32_bf16 v[232:235], v[56:59], a[168:171], v[232:235]
    ds_read_b64_tr_b16 v[52:53], v30 offset:32768
    s_waitcnt lgkmcnt(9)
    v_sub_f32 v89, 2.0, v85
    v_mfma_f32_16x16x32_bf16 v[248:251], v[56:59], a[172:175], v[248:251]
    ds_read_b64_tr_b16 v[54:55], v30 offset:34816
    buffer_load_dwordx4 a[148:151], v3, s[32:35], s93 offen sc1
    v_subrev_f32 v85, 1.0, v85
    v_mfma_f32_16x16x32_bf16 v[204:207], v[60:63], a[160:163], v[204:207]
    s_waitcnt lgkmcnt(9)
    v_sub_f32 v90, 2.0, v86
    v_subrev_f32 v86, 1.0, v86
    v_mfma_f32_16x16x32_bf16 v[220:223], v[60:63], a[164:167], v[220:223]
    s_waitcnt lgkmcnt(6)
    v_sub_f32 v91, 2.0, v87
    v_subrev_f32 v87, 1.0, v87
    v_mfma_f32_16x16x32_bf16 v[236:239], v[60:63], a[168:171], v[236:239]
    v_add_u32 v64, s5, v1
    s_add_u32 s96, s4, 3
    s_and_b32 s96, s96, 3
    s_lshl_b32 s96, s96, 12
    v_add_u32 v65, s96, v1
    v_mfma_f32_16x16x32_bf16 v[252:255], v[60:63], a[172:175], v[252:255]
    buffer_load_dwordx4 a[152:155], v4, s[32:35], s93 offen sc1
    s_add_u32 s96, s4, 2
    s_and_b32 s96, s96, 3
    s_lshl_b32 s96, s96, 12
    v_add_u32 v66, s96, v1
    s_waitcnt vmcnt(7) lgkmcnt(4)
    v_mfma_f32_16x16x32_bf16 v[192:195], v[40:43], a[176:179], v[192:195]
    ds_read_b64_tr_b16 v[56:57], v21 offset:49152
    s_add_u32 s96, s4, 1
    s_and_b32 s96, s96, 3
    s_lshl_b32 s96, s96, 12
    v_add_u32 v67, s96, v1
    v_mfma_f32_16x16x32_bf16 v[208:211], v[40:43], a[180:183], v[208:211]
    ds_read_b64_tr_b16 v[58:59], v21 offset:51200
    v_bfe_u32 v68, v1, 4, 4
    v_lshlrev_b32 v68, 10, v68
    v_mfma_f32_16x16x32_bf16 v[224:227], v[40:43], a[184:187], v[224:227]
    ds_read_b64_tr_b16 v[60:61], v24 offset:49152
    v_bfe_u32 v69, v1, 8, 1
    v_lshl_add_u32 v68, v69, 5, v68
    v_mfma_f32_16x16x32_bf16 v[240:243], v[40:43], a[188:191], v[240:243]
    ds_read_b64_tr_b16 v[62:63], v24 offset:51200
    buffer_load_dwordx4 a[156:159], v5, s[32:35], s93 offen sc1
    v_lshrrev_b32 v69, 9, v1
    v_mfma_f32_16x16x32_bf16 v[196:199], v[44:47], a[176:179], v[196:199]
    s_lshr_b32 s84, s84, 3
    s_add_u32 s84, s84, 229376
    v_lshl_add_u32 v68, v69, 4, v68
    v_mfma_f32_16x16x32_bf16 v[212:215], v[44:47], a[180:183], v[212:215]
    s_lshr_b32 s85, s85, 3
    s_add_u32 s85, s85, 229376
    v_bfe_u32 v69, v1, 4, 4
    v_mfma_f32_16x16x32_bf16 v[228:231], v[44:47], a[184:187], v[228:231]
    s_lshr_b32 s86, s86, 3
    s_add_u32 s86, s86, 229376
    v_mul_u32_u24 v69, 144, v69
    v_mfma_f32_16x16x32_bf16 v[244:247], v[44:47], a[188:191], v[244:247]
    s_lshr_b32 s87, s87, 3
    s_add_u32 s87, s87, 229376
    s_waitcnt lgkmcnt(4)
    v_mfma_f32_16x16x32_bf16 v[200:203], v[48:51], a[176:179], v[200:203]
    ds_read_b64_tr_b16 v[40:41], v27 offset:49152
    buffer_load_dwordx4 a[192:195], v2, s[32:35], s84 offen sc1
    v_lshrrev_b32 v70, 8, v1
    v_mfma_f32_16x16x32_bf16 v[216:219], v[48:51], a[180:183], v[216:219]
    ds_read_b64_tr_b16 v[42:43], v27 offset:51200
    v_lshl_add_u32 v69, v70, 3, v69
    v_add_u32 v69, s5, v69
    v_mfma_f32_16x16x32_bf16 v[232:235], v[48:51], a[184:187], v[232:235]
    ds_read_b64_tr_b16 v[44:45], v30 offset:49152
    v_lshrrev_b32 v71, 7, v1
    v_and_b32 v68, 0x70, v1
    v_mfma_f32_16x16x32_bf16 v[248:251], v[48:51], a[188:191], v[248:251]
    ds_read_b64_tr_b16 v[46:47], v30 offset:51200
    v_mul_u32_u24 v70, 144, v71
    v_add3_u32 v70, v70, v68, s5
    v_mfma_f32_16x16x32_bf16 v[204:207], v[52:55], a[176:179], v[204:207]
    buffer_load_dwordx4 a[208:211], v2, s[32:35], s85 offen sc1
    v_lshl_add_u32 v68, v71, 10, v68
    v_add_u32 v71, 0x2000, v68
    v_mfma_f32_16x16x32_bf16 v[220:223], v[52:55], a[180:183], v[220:223]
    v_mfma_f32_16x16x32_bf16 v[236:239], v[52:55], a[184:187], v[236:239]
    v_mfma_f32_16x16x32_bf16 v[252:255], v[52:55], a[188:191], v[252:255]
    s_waitcnt vmcnt(6) lgkmcnt(4)
    v_mfma_f32_16x16x32_bf16 v[192:195], v[56:59], a[128:131], v[192:195]
    ds_read_b64_tr_b16 v[48:49], v20 offset:32768
    buffer_load_dwordx4 a[224:227], v2, s[32:35], s86 offen sc1
    v_mfma_f32_16x16x32_bf16 v[208:211], v[56:59], a[132:135], v[208:211]
    ds_read_b64_tr_b16 v[50:51], v20 offset:34816
    v_mfma_f32_16x16x32_bf16 v[224:227], v[56:59], a[136:139], v[224:227]
    ds_read_b64_tr_b16 v[52:53], v23 offset:32768
    v_mfma_f32_16x16x32_bf16 v[240:243], v[56:59], a[140:143], v[240:243]
    ds_read_b64_tr_b16 v[54:55], v23 offset:34816
    v_mfma_f32_16x16x32_bf16 v[196:199], v[60:63], a[128:131], v[196:199]
    buffer_load_dwordx4 a[240:243], v2, s[32:35], s87 offen sc1
    v_mfma_f32_16x16x32_bf16 v[212:215], v[60:63], a[132:135], v[212:215]
    v_mfma_f32_16x16x32_bf16 v[228:231], v[60:63], a[136:139], v[228:231]
    v_mfma_f32_16x16x32_bf16 v[244:247], v[60:63], a[140:143], v[244:247]
    s_waitcnt lgkmcnt(4)
    v_mfma_f32_16x16x32_bf16 v[200:203], v[40:43], a[128:131], v[200:203]
    ds_read_b64_tr_b16 v[56:57], v26 offset:32768
    buffer_load_dwordx4 a[196:199], v3, s[32:35], s84 offen sc1
    v_mfma_f32_16x16x32_bf16 v[216:219], v[40:43], a[132:135], v[216:219]
    ds_read_b64_tr_b16 v[58:59], v26 offset:34816
    v_mfma_f32_16x16x32_bf16 v[232:235], v[40:43], a[136:139], v[232:235]
    ds_read_b64_tr_b16 v[60:61], v29 offset:32768
    v_mfma_f32_16x16x32_bf16 v[248:251], v[40:43], a[140:143], v[248:251]
    ds_read_b64_tr_b16 v[62:63], v29 offset:34816
    v_mfma_f32_16x16x32_bf16 v[204:207], v[44:47], a[128:131], v[204:207]
    buffer_load_dwordx4 a[212:215], v3, s[32:35], s85 offen sc1
    v_mfma_f32_16x16x32_bf16 v[220:223], v[44:47], a[132:135], v[220:223]
    v_mfma_f32_16x16x32_bf16 v[236:239], v[44:47], a[136:139], v[236:239]
    v_mfma_f32_16x16x32_bf16 v[252:255], v[44:47], a[140:143], v[252:255]
    s_waitcnt vmcnt(6) lgkmcnt(4)
    v_mfma_f32_16x16x32_bf16 v[192:195], v[48:51], a[144:147], v[192:195]
    buffer_load_dwordx4 a[228:231], v3, s[32:35], s86 offen sc1
    v_mfma_f32_16x16x32_bf16 v[208:211], v[48:51], a[148:151], v[208:211]
    v_mfma_f32_16x16x32_bf16 v[224:227], v[48:51], a[152:155], v[224:227]
    v_mfma_f32_16x16x32_bf16 v[240:243], v[48:51], a[156:159], v[240:243]
    v_mfma_f32_16x16x32_bf16 v[196:199], v[52:55], a[144:147], v[196:199]
    buffer_load_dwordx4 a[244:247], v3, s[32:35], s87 offen sc1
    v_mfma_f32_16x16x32_bf16 v[212:215], v[52:55], a[148:151], v[212:215]
    v_mfma_f32_16x16x32_bf16 v[228:231], v[52:55], a[152:155], v[228:231]
    v_mfma_f32_16x16x32_bf16 v[244:247], v[52:55], a[156:159], v[244:247]
    s_waitcnt lgkmcnt(0)
    v_mfma_f32_16x16x32_bf16 v[200:203], v[56:59], a[144:147], v[200:203]
    buffer_load_dwordx4 a[200:203], v4, s[32:35], s84 offen sc1
    v_mfma_f32_16x16x32_bf16 v[216:219], v[56:59], a[148:151], v[216:219]
    v_mfma_f32_16x16x32_bf16 v[232:235], v[56:59], a[152:155], v[232:235]
    v_mfma_f32_16x16x32_bf16 v[248:251], v[56:59], a[156:159], v[248:251]
    v_mfma_f32_16x16x32_bf16 v[204:207], v[60:63], a[144:147], v[204:207]
    buffer_load_dwordx4 a[216:219], v4, s[32:35], s85 offen sc1
    v_mfma_f32_16x16x32_bf16 v[220:223], v[60:63], a[148:151], v[220:223]
    v_mfma_f32_16x16x32_bf16 v[236:239], v[60:63], a[152:155], v[236:239]
    v_mfma_f32_16x16x32_bf16 v[252:255], v[60:63], a[156:159], v[252:255]
    s_waitcnt vmcnt(6)
    v_mfma_f32_16x16x32_bf16 v[128:131], a[0:3], a[192:195], 0
    buffer_load_dwordx4 a[232:235], v4, s[32:35], s86 offen sc1
    v_mul_f32 v192, v192, v88
    v_mul_f32 v193, v193, v88
    v_mul_f32 v194, v194, v88
    v_mfma_f32_16x16x32_bf16 v[132:135], a[4:7], a[192:195], 0
    v_mul_f32 v195, v195, v88
    v_mul_f32 v196, v196, v88
    v_mul_f32 v197, v197, v88
    v_mul_f32 v198, v198, v88
    v_mfma_f32_16x16x32_bf16 v[136:139], a[8:11], a[192:195], 0
    v_mul_f32 v199, v199, v88
    v_mul_f32 v200, v200, v88
    v_mul_f32 v201, v201, v88
    v_mul_f32 v202, v202, v88
    v_mfma_f32_16x16x32_bf16 v[140:143], a[12:15], a[192:195], 0
    v_mul_f32 v203, v203, v88
    v_mul_f32 v204, v204, v88
    v_mul_f32 v205, v205, v88
    v_mul_f32 v206, v206, v88
    v_mfma_f32_16x16x32_bf16 v[128:131], a[16:19], a[208:211], v[128:131]
    buffer_load_dwordx4 a[248:251], v4, s[32:35], s87 offen sc1
    v_mul_f32 v207, v207, v88
    v_mul_f32 v208, v208, v89
    v_mul_f32 v209, v209, v89
    v_mfma_f32_16x16x32_bf16 v[132:135], a[20:23], a[208:211], v[132:135]
    v_mul_f32 v210, v210, v89
    v_mul_f32 v211, v211, v89
    v_mul_f32 v212, v212, v89
    v_mul_f32 v213, v213, v89
    v_mfma_f32_16x16x32_bf16 v[136:139], a[24:27], a[208:211], v[136:139]
    v_mul_f32 v214, v214, v89
    v_mul_f32 v215, v215, v89
    v_mul_f32 v216, v216, v89
    v_mul_f32 v217, v217, v89
    v_mfma_f32_16x16x32_bf16 v[140:143], a[28:31], a[208:211], v[140:143]
    v_mul_f32 v218, v218, v89
    v_mul_f32 v219, v219, v89
    v_mul_f32 v220, v220, v89
    v_mfma_f32_16x16x32_bf16 v[128:131], a[32:35], a[224:227], v[128:131]
    buffer_load_dwordx4 a[204:207], v5, s[32:35], s84 offen sc1
    v_mul_f32 v221, v221, v89
    v_mul_f32 v222, v222, v89
    v_mul_f32 v223, v223, v89
    v_mfma_f32_16x16x32_bf16 v[132:135], a[36:39], a[224:227], v[132:135]
    v_mul_f32 v224, v224, v90
    v_mul_f32 v225, v225, v90
    v_mul_f32 v226, v226, v90
    v_mul_f32 v227, v227, v90
    v_mfma_f32_16x16x32_bf16 v[136:139], a[40:43], a[224:227], v[136:139]
    v_mul_f32 v228, v228, v90
    v_mul_f32 v229, v229, v90
    v_mul_f32 v230, v230, v90
    v_mul_f32 v231, v231, v90
    v_mfma_f32_16x16x32_bf16 v[140:143], a[44:47], a[224:227], v[140:143]
    v_mul_f32 v232, v232, v90
    v_mul_f32 v233, v233, v90
    v_mul_f32 v234, v234, v90
    v_mul_f32 v235, v235, v90
    v_mfma_f32_16x16x32_bf16 v[128:131], a[48:51], a[240:243], v[128:131]
    buffer_load_dwordx4 a[220:223], v5, s[32:35], s85 offen sc1
    v_mul_f32 v236, v236, v90
    v_mul_f32 v237, v237, v90
    v_mul_f32 v238, v238, v90
    v_mfma_f32_16x16x32_bf16 v[132:135], a[52:55], a[240:243], v[132:135]
    v_mul_f32 v239, v239, v90
    v_mul_f32 v240, v240, v91
    v_mul_f32 v241, v241, v91
    v_mul_f32 v242, v242, v91
    v_mfma_f32_16x16x32_bf16 v[136:139], a[56:59], a[240:243], v[136:139]
    v_mul_f32 v243, v243, v91
    v_mul_f32 v244, v244, v91
    v_mul_f32 v245, v245, v91
    v_mul_f32 v246, v246, v91
    v_mfma_f32_16x16x32_bf16 v[140:143], a[60:63], a[240:243], v[140:143]
    v_mul_f32 v247, v247, v91
    v_mul_f32 v248, v248, v91
    v_mul_f32 v249, v249, v91
    s_waitcnt vmcnt(6)
    v_mfma_f32_16x16x32_bf16 v[144:147], a[0:3], a[196:199], 0
    buffer_load_dwordx4 a[236:239], v5, s[32:35], s86 offen sc1
    v_mul_f32 v250, v250, v91
    v_mul_f32 v251, v251, v91
    v_mul_f32 v252, v252, v91
    v_mfma_f32_16x16x32_bf16 v[148:151], a[4:7], a[196:199], 0
    v_mul_f32 v253, v253, v91
    v_mul_f32 v254, v254, v91
    v_mul_f32 v255, v255, v91
    v_fmac_f32 v192, v128, v84
    v_mfma_f32_16x16x32_bf16 v[152:155], a[8:11], a[196:199], 0
    v_fmac_f32 v193, v129, v84
    v_fmac_f32 v194, v130, v84
    v_fmac_f32 v195, v131, v84
    v_fmac_f32 v196, v132, v84
    v_mfma_f32_16x16x32_bf16 v[156:159], a[12:15], a[196:199], 0
    v_fmac_f32 v197, v133, v84
    v_fmac_f32 v198, v134, v84
    v_fmac_f32 v199, v135, v84
    v_fmac_f32 v200, v136, v84
    v_mfma_f32_16x16x32_bf16 v[144:147], a[16:19], a[212:215], v[144:147]
    buffer_load_dwordx4 a[252:255], v5, s[32:35], s87 offen sc1
    v_fmac_f32 v201, v137, v84
    v_fmac_f32 v202, v138, v84
    v_fmac_f32 v203, v139, v84
    v_mfma_f32_16x16x32_bf16 v[148:151], a[20:23], a[212:215], v[148:151]
    v_fmac_f32 v204, v140, v84
    v_fmac_f32 v205, v141, v84
    v_fmac_f32 v206, v142, v84
    v_fmac_f32 v207, v143, v84
    v_mfma_f32_16x16x32_bf16 v[152:155], a[24:27], a[212:215], v[152:155]
    ds_write_b128 v64, v[192:195] offset:0
    v_mfma_f32_16x16x32_bf16 v[156:159], a[28:31], a[212:215], v[156:159]
    v_mfma_f32_16x16x32_bf16 v[144:147], a[32:35], a[228:231], v[144:147]
    ds_write_b128 v64, v[196:199] offset:1024
    v_mfma_f32_16x16x32_bf16 v[148:151], a[36:39], a[228:231], v[148:151]
    v_mfma_f32_16x16x32_bf16 v[152:155], a[40:43], a[228:231], v[152:155]
    ds_write_b128 v64, v[200:203] offset:2048
    v_mfma_f32_16x16x32_bf16 v[156:159], a[44:47], a[228:231], v[156:159]
    v_mfma_f32_16x16x32_bf16 v[144:147], a[48:51], a[244:247], v[144:147]
    ds_write_b128 v64, v[204:207] offset:3072
    v_mfma_f32_16x16x32_bf16 v[148:151], a[52:55], a[244:247], v[148:151]
    v_mfma_f32_16x16x32_bf16 v[152:155], a[56:59], a[244:247], v[152:155]
    v_mfma_f32_16x16x32_bf16 v[156:159], a[60:63], a[244:247], v[156:159]
    s_waitcnt vmcnt(4)
    v_mfma_f32_16x16x32_bf16 v[160:163], a[0:3], a[200:203], 0
    s_nop 1
    v_fmac_f32 v208, v144, v85
    v_fmac_f32 v209, v145, v85
    v_mfma_f32_16x16x32_bf16 v[164:167], a[4:7], a[200:203], 0
    v_fmac_f32 v210, v146, v85
    v_fmac_f32 v211, v147, v85
    v_fmac_f32 v212, v148, v85
    v_fmac_f32 v213, v149, v85
    v_mfma_f32_16x16x32_bf16 v[168:171], a[8:11], a[200:203], 0
    v_fmac_f32 v214, v150, v85
    v_fmac_f32 v215, v151, v85
    v_fmac_f32 v216, v152, v85
    v_fmac_f32 v217, v153, v85
    v_mfma_f32_16x16x32_bf16 v[172:175], a[12:15], a[200:203], 0
    v_fmac_f32 v218, v154, v85
    v_fmac_f32 v219, v155, v85
    v_fmac_f32 v220, v156, v85
    v_fmac_f32 v221, v157, v85
    v_mfma_f32_16x16x32_bf16 v[160:163], a[16:19], a[216:219], v[160:163]
    v_fmac_f32 v222, v158, v85
    v_fmac_f32 v223, v159, v85
    v_mfma_f32_16x16x32_bf16 v[164:167], a[20:23], a[216:219], v[164:167]
    ds_write_b128 v64, v[208:211] offset:16384
    v_mfma_f32_16x16x32_bf16 v[168:171], a[24:27], a[216:219], v[168:171]
    v_mfma_f32_16x16x32_bf16 v[172:175], a[28:31], a[216:219], v[172:175]
    ds_write_b128 v64, v[212:215] offset:17408
    v_mfma_f32_16x16x32_bf16 v[160:163], a[32:35], a[232:235], v[160:163]
    v_mfma_f32_16x16x32_bf16 v[164:167], a[36:39], a[232:235], v[164:167]
    ds_write_b128 v64, v[216:219] offset:18432
    v_mfma_f32_16x16x32_bf16 v[168:171], a[40:43], a[232:235], v[168:171]
    v_mfma_f32_16x16x32_bf16 v[172:175], a[44:47], a[232:235], v[172:175]
    ds_write_b128 v64, v[220:223] offset:19456
    v_mfma_f32_16x16x32_bf16 v[160:163], a[48:51], a[248:251], v[160:163]
    v_mfma_f32_16x16x32_bf16 v[164:167], a[52:55], a[248:251], v[164:167]
    v_mfma_f32_16x16x32_bf16 v[168:171], a[56:59], a[248:251], v[168:171]
    v_mfma_f32_16x16x32_bf16 v[172:175], a[60:63], a[248:251], v[172:175]
    s_waitcnt vmcnt(0)
    v_mfma_f32_16x16x32_bf16 v[176:179], a[0:3], a[204:207], 0
    s_nop 2
    v_fmac_f32 v224, v160, v86
    v_mfma_f32_16x16x32_bf16 v[180:183], a[4:7], a[204:207], 0
    v_fmac_f32 v225, v161, v86
    v_fmac_f32 v226, v162, v86
    v_fmac_f32 v227, v163, v86
    v_fmac_f32 v228, v164, v86
    v_mfma_f32_16x16x32_bf16 v[184:187], a[8:11], a[204:207], 0
    v_fmac_f32 v229, v165, v86
    v_fmac_f32 v230, v166, v86
    v_fmac_f32 v231, v167, v86
    v_fmac_f32 v232, v168, v86
    v_mfma_f32_16x16x32_bf16 v[188:191], a[12:15], a[204:207], 0
    v_fmac_f32 v233, v169, v86
    v_fmac_f32 v234, v170, v86
    v_fmac_f32 v235, v171, v86
    v_fmac_f32 v236, v172, v86
    v_mfma_f32_16x16x32_bf16 v[176:179], a[16:19], a[220:223], v[176:179]
    v_fmac_f32 v237, v173, v86
    v_fmac_f32 v238, v174, v86
    v_fmac_f32 v239, v175, v86
    v_mfma_f32_16x16x32_bf16 v[180:183], a[20:23], a[220:223], v[180:183]
    ds_write_b128 v64, v[224:227] offset:32768
    v_mfma_f32_16x16x32_bf16 v[184:187], a[24:27], a[220:223], v[184:187]
    v_mfma_f32_16x16x32_bf16 v[188:191], a[28:31], a[220:223], v[188:191]
    ds_write_b128 v64, v[228:231] offset:33792
    v_mfma_f32_16x16x32_bf16 v[176:179], a[32:35], a[236:239], v[176:179]
    v_mfma_f32_16x16x32_bf16 v[180:183], a[36:39], a[236:239], v[180:183]
    ds_write_b128 v64, v[232:235] offset:34816
    v_mfma_f32_16x16x32_bf16 v[184:187], a[40:43], a[236:239], v[184:187]
    v_mfma_f32_16x16x32_bf16 v[188:191], a[44:47], a[236:239], v[188:191]
    ds_write_b128 v64, v[236:239] offset:35840
    s_waitcnt lgkmcnt(0)
    s_barrier
    ds_read_b128 v[128:131], v65 offset:0
    v_mfma_f32_16x16x32_bf16 v[176:179], a[48:51], a[252:255], v[176:179]
    ds_read_b128 v[132:135], v65 offset:1024
    ds_read_b128 v[136:139], v65 offset:2048
    ds_read_b128 v[140:143], v65 offset:3072
    ds_read_b128 v[144:147], v66 offset:16384
    v_mfma_f32_16x16x32_bf16 v[180:183], a[52:55], a[252:255], v[180:183]
    ds_read_b128 v[148:151], v66 offset:17408
    ds_read_b128 v[152:155], v66 offset:18432
    ds_read_b128 v[156:159], v66 offset:19456
    ds_read_b128 v[160:163], v67 offset:32768
    v_mfma_f32_16x16x32_bf16 v[184:187], a[56:59], a[252:255], v[184:187]
    ds_read_b128 v[164:167], v67 offset:33792
    ds_read_b128 v[168:171], v67 offset:34816
    ds_read_b128 v[172:175], v67 offset:35840
    v_mfma_f32_16x16x32_bf16 v[188:191], a[60:63], a[252:255], v[188:191]
    v_pk_fma_f32 v[240:241], v[176:177], v[86:87], v[240:241] op_sel:[0,1,0] op_sel_hi:[1,1,1]
    v_pk_fma_f32 v[242:243], v[178:179], v[86:87], v[242:243] op_sel:[0,1,0] op_sel_hi:[1,1,1]
    v_pk_fma_f32 v[244:245], v[180:181], v[86:87], v[244:245] op_sel:[0,1,0] op_sel_hi:[1,1,1]
    v_pk_fma_f32 v[246:247], v[182:183], v[86:87], v[246:247] op_sel:[0,1,0] op_sel_hi:[1,1,1]
    v_pk_fma_f32 v[248:249], v[184:185], v[86:87], v[248:249] op_sel:[0,1,0] op_sel_hi:[1,1,1]
    v_pk_fma_f32 v[250:251], v[186:187], v[86:87], v[250:251] op_sel:[0,1,0] op_sel_hi:[1,1,1]
    s_nop 1
    v_pk_fma_f32 v[252:253], v[188:189], v[86:87], v[252:253] op_sel:[0,1,0] op_sel_hi:[1,1,1]
    v_pk_fma_f32 v[254:255], v[190:191], v[86:87], v[254:255] op_sel:[0,1,0] op_sel_hi:[1,1,1]
    s_waitcnt lgkmcnt(11)
    v_pk_add_f32 v[240:241], v[240:241], v[128:129]
    v_pk_add_f32 v[242:243], v[242:243], v[130:131]
    s_waitcnt lgkmcnt(10)
    v_pk_add_f32 v[244:245], v[244:245], v[132:133]
    v_pk_add_f32 v[246:247], v[246:247], v[134:135]
    s_waitcnt lgkmcnt(9)
    v_pk_add_f32 v[248:249], v[248:249], v[136:137]
    v_pk_add_f32 v[250:251], v[250:251], v[138:139]
    s_waitcnt lgkmcnt(8)
    v_pk_add_f32 v[252:253], v[252:253], v[140:141]
    v_pk_add_f32 v[254:255], v[254:255], v[142:143]
    s_waitcnt lgkmcnt(7)
    v_pk_add_f32 v[240:241], v[240:241], v[144:145]
    v_pk_add_f32 v[242:243], v[242:243], v[146:147]
    s_waitcnt lgkmcnt(6)
    v_pk_add_f32 v[244:245], v[244:245], v[148:149]
    v_pk_add_f32 v[246:247], v[246:247], v[150:151]
    s_waitcnt lgkmcnt(5)
    v_pk_add_f32 v[248:249], v[248:249], v[152:153]
    v_pk_add_f32 v[250:251], v[250:251], v[154:155]
    s_waitcnt lgkmcnt(4)
    v_pk_add_f32 v[252:253], v[252:253], v[156:157]
    v_pk_add_f32 v[254:255], v[254:255], v[158:159]
    s_waitcnt lgkmcnt(3)
    v_pk_add_f32 v[240:241], v[240:241], v[160:161]
    v_pk_add_f32 v[242:243], v[242:243], v[162:163]
    s_waitcnt lgkmcnt(2)
    v_pk_add_f32 v[244:245], v[244:245], v[164:165]
    v_pk_add_f32 v[246:247], v[246:247], v[166:167]
    s_waitcnt lgkmcnt(1)
    v_pk_add_f32 v[248:249], v[248:249], v[168:169]
    v_pk_add_f32 v[250:251], v[250:251], v[170:171]
    s_waitcnt lgkmcnt(0)
    v_pk_add_f32 v[252:253], v[252:253], v[172:173]
    v_pk_add_f32 v[254:255], v[254:255], v[174:175]
    v_cvt_pk_bf16_f32 v176, v240, v241
    v_cvt_pk_bf16_f32 v177, v242, v243
    v_cvt_pk_bf16_f32 v178, v244, v245
    v_cvt_pk_bf16_f32 v179, v246, v247
    v_cvt_pk_bf16_f32 v180, v248, v249
    v_cvt_pk_bf16_f32 v181, v250, v251
    v_cvt_pk_bf16_f32 v182, v252, v253
    v_cvt_pk_bf16_f32 v183, v254, v255
    ds_write_b64 v69, v[176:177] offset:49152
    ds_write_b64 v69, v[178:179] offset:49184
    ds_write_b64 v69, v[180:181] offset:49216
    ds_write_b64 v69, v[182:183] offset:49248
    s_waitcnt lgkmcnt(0)
    ds_read_b128 v[184:187], v70 offset:49152
    ds_read_b128 v[188:191], v70 offset:50304
    s_waitcnt lgkmcnt(1)
    buffer_store_dwordx4 v[184:187], v68, s[72:75], s92 offen sc1
    s_waitcnt lgkmcnt(0)
    buffer_store_dwordx4 v[188:191], v71, s[72:75], s92 offen sc1
    s_endpgm
LA_poll0_retry:
    s_mov_b32 s95, 0
LA_poll0_loop:
    s_sleep 4
    buffer_load_dword v35, v37, s[76:79], 0 offen offset:128 sc1

    s_add_u32 s95, s95, 1
    s_cmp_ge_u32 s95, 400000
    s_waitcnt vmcnt(0)
    s_cbranch_scc1 LA_poll0_ok
    v_cmp_eq_u32 vcc, 0, v35
    s_nop 0
    s_and_b32 s91, vcc_lo, -1
    s_cbranch_scc1 LA_poll0_loop
    s_branch LA_poll0_ok
LA_poll1_retry:
    s_mov_b32 s95, 0
LA_poll1_loop:
    s_sleep 4
    buffer_load_dword v35, v36, s[52:55], 0 offen sc1

    s_add_u32 s95, s95, 1
    s_cmp_ge_u32 s95, 400000
    s_waitcnt vmcnt(0)
    s_cbranch_scc1 LA_poll1_ok
    v_cmp_eq_u32 vcc, 0, v35
    s_nop 0
    s_and_b32 s91, vcc_lo, 65535
    s_cbranch_scc1 LA_poll1_loop
    s_branch LA_poll1_ok
LA_poll2_retry:
    s_mov_b32 s95, 0
LA_poll2_loop:
    s_sleep 4
    buffer_load_dword v35, v33, s[52:55], s14 offen sc1

    s_add_u32 s95, s95, 1
    s_cmp_ge_u32 s95, 400000
    s_waitcnt vmcnt(0)
    s_cbranch_scc1 LA_poll2_ok
    v_cmp_eq_u32 vcc, 0, v35
    s_nop 0
    s_and_b32 s91, vcc_lo, 255
    s_cbranch_scc1 LA_poll2_loop
    s_branch LA_poll2_ok
LA_poll3_retry:
    s_mov_b32 s95, 0
LA_poll3_loop:
    s_sleep 4
    buffer_load_dwordx4 v[80:83], v33, s[52:55], s14 offen sc1

    s_add_u32 s95, s95, 1
    s_cmp_ge_u32 s95, 400000
    s_waitcnt vmcnt(0)
    s_cbranch_scc1 LA_poll3_ok
    v_cmp_eq_u32 vcc, 0, v80
    s_nop 0
    s_and_b32 s91, vcc_lo, 255
    s_cbranch_scc1 LA_poll3_loop
    s_branch LA_poll3_ok
LA_poll4_retry:
    s_mov_b32 s95, 0
LA_poll4_loop:
    s_sleep 4
    buffer_load_dword v35, v33, s[52:55], s14 offen sc1

    s_add_u32 s95, s95, 1
    s_cmp_ge_u32 s95, 400000
    s_waitcnt vmcnt(0)
    s_cbranch_scc1 LA_poll4_ok
    v_cmp_eq_u32 vcc, 0, v35
    s_nop 0
    s_and_b32 s91, vcc_lo, 255
    s_cbranch_scc1 LA_poll4_loop
    s_branch LA_poll4_ok
L_typeB:
    s_add_u32 s45, s45, 64
    s_and_b32 s18, s45, 511
    s_add_u32 s45, s45, 64
    s_and_b32 s19, s45, 511
    s_add_u32 s45, s45, 64
    s_and_b32 s20, s45, 511
    s_add_u32 s45, s45, 64
    s_and_b32 s21, s45, 511
    s_add_u32 s45, s45, 64
    s_and_b32 s22, s45, 511
    s_add_u32 s45, s45, 64
    s_and_b32 s23, s45, 511
    v_lshlrev_b32 v1, 4, v0
    v_and_b32 v100, 6, v96
    v_xor_b32 v100, v100, v98
    v_lshlrev_b32 v100, 4, v100
    v_lshl_add_u32 v6, v96, 10, v100
    v_add_u32 v7, 7168, v6
    s_add_u32 s9, s8, 128
    s_lshr_b32 s61, s4, 1
    s_and_b32 s62, s4, 1
    s_lshl1_add_u32 s63, s58, s61
    s_bfe_u32 s64, s2, 0x20001
    s_lshl3_add_u32 s64, s64, s56
    s_and_b32 s65, s2, 1
    s_lshl2_add_u32 s65, s65, s57
    s_lshl3_add_u32 s66, s60, s59
    s_lshl1_add_u32 s66, s66, s62
    s_add_u32 m0, s5, 49152
    s_mul_i32 s26, s17, 3584
    buffer_load_dwordx4 v2, s[36:39], s26 offen lds
    buffer_load_dwordx4 v3, s[36:39], s26 offen offset:1024 lds
    buffer_load_dwordx4 v2, s[40:43], s26 offen offset:2048 lds
    buffer_load_dwordx4 v3, s[40:43], s26 offen offset:3072 lds
    v_bfe_u32 v96, v0, 2, 2
    v_and_b32 v98, 3, v0
    v_lshlrev_b32 v96, 7, v96
    v_lshl_add_u32 v96, v98, 3, v96
    v_bfe_u32 v97, v0, 3, 2
    v_lshlrev_b32 v97, 5, v97
    v_lshrrev_b32 v99, 4, v0
    v_and_b32 v98, 1, v99
    v_lshl_add_u32 v100, v98, 10, v96
    v_lshrrev_b32 v98, 1, v99
    v_lshl_add_u32 v100, v98, 12, v100
    v_add_u32 v100, v100, v97
    s_lshl_b32 s3, s62, 6
    v_xor_b32 v8, s3, v100
    v_add_u32 v9, 0x10000, v8
    v_add_u32 v10, 0x20000, v8
    v_xor_b32 v11, 32, v8
    v_xor_b32 v12, 32, v9
    v_xor_b32 v13, 32, v10
    v_and_b32 v100, 15, v0
    v_lshrrev_b32 v98, 1, v100
    s_lshl_b32 s3, s4, 5
    v_add_u32 v100, s3, v100
    v_xor_b32 v98, v98, v99
    v_lshlrev_b32 v98, 4, v98
    v_lshl_add_u32 v66, v100, 7, v98
    v_xor_b32 v67, 4096, v66
    v_xor_b32 v68, 64, v66
    v_xor_b32 v69, 64, v67
    s_add_u32 m0, s5, 65536
    s_lshl_b32 s26, s18, 1
    buffer_load_dwordx4 v64, s[28:31], s26 offen lds
    buffer_load_dwordx4 v65, s[28:31], s26 offen offset:1024 lds
    buffer_load_dwordx4 v64, s[32:35], s26 offen offset:2048 lds
    buffer_load_dwordx4 v65, s[32:35], s26 offen offset:3072 lds
    s_waitcnt vmcnt(12)
    s_barrier
    ds_read_b128 a[0:3], v66 offset:0
    ds_read_b128 a[4:7], v66 offset:2048
    ds_read_b128 a[128:131], v67 offset:0
    ds_read_b128 a[132:135], v67 offset:2048
    ds_read_b64_tr_b16 v[40:41], v8 offset:16384
    ds_read_b64_tr_b16 v[42:43], v8 offset:16896
    ds_read_b64_tr_b16 v[44:45], v11 offset:16384
    ds_read_b64_tr_b16 v[46:47], v11 offset:16896
    ds_read_b64_tr_b16 v[48:49], v8 offset:18432
    ds_read_b64_tr_b16 v[50:51], v8 offset:18944
    ds_read_b64_tr_b16 v[52:53], v11 offset:18432
    ds_read_b64_tr_b16 v[54:55], v11 offset:18944
    s_waitcnt lgkmcnt(6)
    v_mfma_f32_16x16x32_bf16 v[128:131], v[40:43], a[0:3], 0
    ds_read_b128 a[8:11], v68 offset:0
    s_add_u32 m0, s5, 81920
    s_mul_i32 s26, s18, 3584
    buffer_load_dwordx4 v2, s[36:39], s26 offen lds
    v_mfma_f32_16x16x32_bf16 v[136:139], v[40:43], a[4:7], 0
    ds_read_b128 a[12:15], v68 offset:2048
    s_mov_b32 s76, s82
    s_mov_b32 s77, s83
    s_mov_b32 s78, 256
    s_mov_b32 s79, 0x20000
    v_mfma_f32_16x16x32_bf16 v[144:147], v[40:43], a[128:131], 0
    ds_read_b128 a[136:139], v69 offset:0
    v_lshl_add_u32 v100, v99, 9, v96
    v_add3_u32 v20, v100, v97, s5
    v_add_u32 v21, 0x10000, v20
    v_mfma_f32_16x16x32_bf16 v[152:155], v[40:43], a[132:135], 0
    ds_read_b128 a[140:143], v69 offset:2048
    v_add_u32 v22, 0x20000, v20
    v_xor_b32 v23, 32, v20
    s_waitcnt lgkmcnt(8)
    v_mfma_f32_16x16x32_bf16 v[132:135], v[44:47], a[0:3], 0
    ds_read_b64_tr_b16 v[56:57], v8 offset:24576
    buffer_load_dwordx4 v3, s[36:39], s26 offen offset:1024 lds
    v_xor_b32 v24, 32, v21
    v_xor_b32 v25, 32, v22
    v_mfma_f32_16x16x32_bf16 v[140:143], v[44:47], a[4:7], 0
    ds_read_b64_tr_b16 v[58:59], v8 offset:25088
    v_xor_b32 v26, 64, v20
    v_xor_b32 v27, 64, v21
    v_xor_b32 v28, 64, v22
    v_mfma_f32_16x16x32_bf16 v[148:151], v[44:47], a[128:131], 0
    ds_read_b64_tr_b16 v[60:61], v11 offset:24576
    v_xor_b32 v29, 96, v20
    v_xor_b32 v30, 96, v21
    v_xor_b32 v31, 96, v22
    v_mfma_f32_16x16x32_bf16 v[156:159], v[44:47], a[132:135], 0
    ds_read_b64_tr_b16 v[62:63], v11 offset:25088
    v_bfe_u32 v97, v0, 2, 2
    v_and_b32 v98, 3, v0
    s_waitcnt lgkmcnt(10)
    v_mfma_f32_16x16x32_bf16 v[160:163], v[48:51], a[0:3], 0
    ds_read_b64_tr_b16 v[40:41], v8 offset:26624
    buffer_load_dwordx4 v2, s[40:43], s26 offen offset:2048 lds
    v_lshlrev_b32 v97, 6, v97
    v_lshl_add_u32 v97, v98, 3, v97
    v_mfma_f32_16x16x32_bf16 v[168:171], v[48:51], a[4:7], 0
    ds_read_b64_tr_b16 v[42:43], v8 offset:27136
    v_and_b32 v100, 1, v99
    v_mul_u32_u24 v100, 544, v100
    v_add_u32 v97, v97, v100
    v_mfma_f32_16x16x32_bf16 v[176:179], v[48:51], a[128:131], 0
    ds_read_b64_tr_b16 v[44:45], v11 offset:26624
    v_lshrrev_b32 v100, 1, v99
    v_lshl_add_u32 v14, v100, 12, v97
    v_add_u32 v15, 0x10000, v14
    v_mfma_f32_16x16x32_bf16 v[184:187], v[48:51], a[132:135], 0
    ds_read_b64_tr_b16 v[46:47], v11 offset:27136
    v_add_u32 v16, 0x20000, v14
    v_xor_b32 v17, 32, v14
    s_waitcnt lgkmcnt(12)
    v_mfma_f32_16x16x32_bf16 v[164:167], v[52:55], a[0:3], 0
    buffer_load_dwordx4 v3, s[40:43], s26 offen offset:3072 lds
    s_add_u32 m0, s5, 98304
    s_lshl_b32 s26, s19, 1
    v_xor_b32 v18, 32, v15
    v_mfma_f32_16x16x32_bf16 v[172:175], v[52:55], a[4:7], 0
    v_xor_b32 v19, 32, v16
    v_lshlrev_b32 v100, 1, v100
    v_xor_b32 v98, v98, v100
    s_lshl_b32 s3, s4, 4
    v_mfma_f32_16x16x32_bf16 v[180:183], v[52:55], a[128:131], 0
    v_lshrrev_b32 v97, 2, v0
    v_add_u32 v97, s3, v97
    v_mul_u32_u24 v97, 3584, v97
    v_lshl_add_u32 v5, v98, 4, v97
    v_mfma_f32_16x16x32_bf16 v[188:191], v[52:55], a[132:135], 0
    v_add_u32 v4, 1024, v5
    s_mul_i32 s3, s63, 294912
    s_add_u32 s3, s3, 1048576
    s_waitcnt lgkmcnt(4)
    v_mfma_f32_16x16x32_bf16 v[128:131], v[56:59], a[8:11], v[128:131]
    s_waitcnt vmcnt(8) lgkmcnt(0)
    s_barrier
    ds_read_b128 a[16:19], v66 offset:32768
    buffer_load_dwordx4 v64, s[28:31], s26 offen lds
    v_mfma_f32_16x16x32_bf16 v[136:139], v[56:59], a[12:15], v[136:139]
    ds_read_b128 a[20:23], v66 offset:34816
    s_lshl_b32 s72, s62, 12
    s_add_u32 s3, s3, s72
    s_lshl_b32 s72, s62, 11
    v_mfma_f32_16x16x32_bf16 v[144:147], v[56:59], a[136:139], v[144:147]
    ds_read_b128 a[144:147], v67 offset:32768
    s_add_u32 s11, s3, s72
    s_xor_b32 s72, s72, 2048
    s_add_u32 s12, s3, s72
    v_mfma_f32_16x16x32_bf16 v[152:155], v[56:59], a[140:143], v[152:155]
    ds_read_b128 a[148:151], v67 offset:34816
    s_lshl_b32 s13, s63, 7
    s_add_u32 s13, s13, s66
    s_lshl_b32 s13, s13, 7
    v_mfma_f32_16x16x32_bf16 v[132:135], v[60:63], a[8:11], v[132:135]
    ds_read_b64_tr_b16 v[48:49], v8 offset:49152
    buffer_load_dwordx4 v65, s[28:31], s26 offen offset:1024 lds
    s_add_u32 s13, s13, 11534336
    s_lshl_b32 s14, s64, 14
    v_mfma_f32_16x16x32_bf16 v[140:143], v[60:63], a[12:15], v[140:143]
    ds_read_b64_tr_b16 v[50:51], v8 offset:49664
    s_add_u32 s14, s14, 11534336
    s_mul_i32 s15, s64, 294912
    s_add_u32 s15, s15, 1048576
    v_mfma_f32_16x16x32_bf16 v[148:151], v[60:63], a[136:139], v[148:151]
    ds_read_b64_tr_b16 v[52:53], v11 offset:49152
    s_mov_b32 s24, 0xffff
    s_mov_b32 s25, 0xffff
    v_mov_b32 v32, 0xbdd2d3e8
    v_mfma_f32_16x16x32_bf16 v[156:159], v[60:63], a[140:143], v[156:159]
    ds_read_b64_tr_b16 v[54:55], v11 offset:49664
    v_mov_b32 v100, 0x7fff0000
    v_and_b32 v96, 15, v0
    v_mfma_f32_16x16x32_bf16 v[160:163], v[40:43], a[8:11], v[160:163]
    ds_read_b64_tr_b16 v[56:57], v8 offset:51200
    buffer_load_dwordx4 v64, s[32:35], s26 offen offset:2048 lds
    v_lshlrev_b32 v96, 2, v96
    v_lshlrev_b32 v98, 2, v0
    v_mfma_f32_16x16x32_bf16 v[168:171], v[40:43], a[12:15], v[168:171]
    ds_read_b64_tr_b16 v[58:59], v8 offset:51712
    v_cmp_gt_u32 vcc, 32, v0
    v_add_u32 v34, 159744, v96
    v_and_b32 v97, 4, v0
    v_cndmask_b32 v37, v100, v98, vcc
    v_mfma_f32_16x16x32_bf16 v[176:179], v[40:43], a[136:139], v[176:179]
    ds_read_b64_tr_b16 v[60:61], v11 offset:51200
    v_and_b32 v98, 3, v0
    v_lshl_add_u32 v97, v97, 2, v98
    s_lshl_b32 s3, s4, 2
    v_mfma_f32_16x16x32_bf16 v[184:187], v[40:43], a[140:143], v[184:187]
    ds_read_b64_tr_b16 v[62:63], v11 offset:51712
    v_cmp_gt_u32 vcc, 8, v0
    v_add_lshl_u32 v97, v97, s3, 7
    s_lshl_b32 s3, s61, 14
    v_cndmask_b32 v33, v100, v97, vcc
    v_mfma_f32_16x16x32_bf16 v[164:167], v[44:47], a[8:11], v[164:167]
    buffer_load_dwordx4 v65, s[32:35], s26 offen offset:3072 lds
    s_add_u32 m0, s5, 114688
    s_mul_i32 s26, s19, 3584
    s_lshl_b32 s93, s65, 7
    v_mfma_f32_16x16x32_bf16 v[172:175], v[44:47], a[12:15], v[172:175]
    s_add_u32 s68, s88, 14336
    s_addc_u32 s69, s89, 0
    s_add_u32 s68, s68, s93
    s_addc_u32 s69, s69, 0
    s_sub_u32 s70, 509952, s93
    s_mov_b32 s71, 0x20000
    v_mfma_f32_16x16x32_bf16 v[180:183], v[44:47], a[136:139], v[180:183]
    s_and_b32 s3, s59, 1
    s_lshl_b32 s95, s3, 6
    s_sub_u32 s3, s3, s62
    s_lshl_b32 s94, s3, 12
    v_mfma_f32_16x16x32_bf16 v[188:191], v[44:47], a[140:143], v[188:191]
    s_lshl2_add_u32 s3, s64, s4
    s_lshl_b32 s3, s3, 14
    s_add_u32 s92, s3, s93
    s_waitcnt lgkmcnt(4)
    v_mfma_f32_16x16x32_bf16 v[128:131], v[48:51], a[16:19], v[128:131]
    ds_read_b128 a[24:27], v68 offset:32768
    buffer_load_dwordx4 v2, s[36:39], s26 offen lds
    s_add_u32 s3, s64, s65
    s_mul_i32 s72, s4, 10
    v_mfma_f32_16x16x32_bf16 v[136:139], v[48:51], a[20:23], v[136:139]
    ds_read_b128 a[28:31], v68 offset:34816
    s_lshl_b32 s73, s4, 2
    v_add_u32 v96, s3, v0
    v_and_b32 v96, 3, v96
    v_mfma_f32_16x16x32_bf16 v[144:147], v[48:51], a[144:147], v[144:147]
    ds_read_b128 a[152:155], v69 offset:32768
    v_add_lshl_u32 v98, v96, s73, 15
    v_and_b32 v97, 2, v96
    v_lshl_add_u32 v96, v97, 1, v96
    v_mfma_f32_16x16x32_bf16 v[152:155], v[48:51], a[148:151], v[152:155]
    ds_read_b128 a[156:159], v69 offset:34816
    v_add_lshl_u32 v97, v96, s72, 15
    s_add_u32 s6, s72, 4
    s_and_b32 s56, s3, 1
    v_mfma_f32_16x16x32_bf16 v[132:135], v[52:55], a[16:19], v[132:135]
    ds_read_b64_tr_b16 v[40:41], v8 offset:57344
    buffer_load_dwordx4 v3, s[36:39], s26 offen offset:1024 lds
    s_add_u32 s6, s6, s56
    s_lshl_b32 s6, s6, 15
    v_mfma_f32_16x16x32_bf16 v[140:143], v[52:55], a[20:23], v[140:143]
    ds_read_b64_tr_b16 v[42:43], v8 offset:57856
    s_lshl_b32 s3, s3, 0
    s_add_u32 s72, s72, 2
    s_add_u32 s73, s73, 36
    v_mfma_f32_16x16x32_bf16 v[148:151], v[52:55], a[144:147], v[148:151]
    ds_read_b64_tr_b16 v[44:45], v11 offset:57344
    v_add_u32 v99, s3, v0
    v_and_b32 v99, 3, v99
    v_and_b32 v96, 4, v0
    v_mfma_f32_16x16x32_bf16 v[156:159], v[52:55], a[148:151], v[156:159]
    ds_read_b64_tr_b16 v[46:47], v11 offset:57856
    v_or_b32 v99, v99, v96
    v_and_b32 v96, 2, v99
    s_waitcnt lgkmcnt(8)
    v_mfma_f32_16x16x32_bf16 v[160:163], v[56:59], a[16:19], v[160:163]
    ds_read_b64_tr_b16 v[48:49], v8 offset:59392
    buffer_load_dwordx4 v2, s[40:43], s26 offen offset:2048 lds
    v_lshl_add_u32 v96, v96, 1, v99
    v_add_u32 v96, s72, v96
    v_mfma_f32_16x16x32_bf16 v[168:171], v[56:59], a[20:23], v[168:171]
    ds_read_b64_tr_b16 v[50:51], v8 offset:59904
    v_cmp_gt_u32 vcc, 4, v99
    v_add_u32 v99, s73, v99
    v_mov_b32 v0, 1
    v_cndmask_b32 v38, v99, v96, vcc
    v_mfma_f32_16x16x32_bf16 v[176:179], v[56:59], a[144:147], v[176:179]
    ds_read_b64_tr_b16 v[52:53], v11 offset:59392
    v_lshlrev_b32 v38, 15, v38
    v_mfma_f32_16x16x32_bf16 v[184:187], v[56:59], a[148:151], v[184:187]
    ds_read_b64_tr_b16 v[54:55], v11 offset:59904
    s_mov_b32 s72, s80
    s_mov_b32 s73, s81
    s_mov_b32 s74, 2097152
    s_mov_b32 s75, 0x20000
    v_mfma_f32_16x16x32_bf16 v[164:167], v[60:63], a[16:19], v[164:167]
    buffer_load_dwordx4 v3, s[40:43], s26 offen offset:3072 lds
    s_add_u32 m0, s5, 131072
    s_lshl_b32 s26, s20, 1
    v_readlane_b32 s80, v97, 0
    v_mfma_f32_16x16x32_bf16 v[172:175], v[60:63], a[20:23], v[172:175]
    v_readlane_b32 s81, v97, 1
    v_readlane_b32 s82, v97, 2
    v_readlane_b32 s83, v97, 3
    v_readlane_b32 s84, v98, 0
    v_mfma_f32_16x16x32_bf16 v[180:183], v[60:63], a[144:147], v[180:183]
    v_readlane_b32 s85, v98, 1
    v_readlane_b32 s86, v98, 2
    v_readlane_b32 s87, v98, 3
    v_mfma_f32_16x16x32_bf16 v[188:191], v[60:63], a[148:151], v[188:191]
    s_add_u32 s56, s96, s93
    s_addc_u32 s57, s97, 0
    s_sub_u32 s58, 1835008, s93
    s_mov_b32 s59, 0x20000
    s_waitcnt lgkmcnt(4)
    v_mfma_f32_16x16x32_bf16 v[128:131], v[40:43], a[24:27], v[128:131]
    s_waitcnt vmcnt(8) lgkmcnt(0)
    s_barrier
    v_add_u32 v66, 0x10000, v66
    v_add_u32 v67, 0x10000, v67
    v_mfma_f32_16x16x32_bf16 v[136:139], v[40:43], a[28:31], v[136:139]
    v_add_u32 v68, 0x10000, v68
    v_add_u32 v69, 0x10000, v69
    buffer_load_dwordx4 v64, s[28:31], s26 offen lds
    v_mfma_f32_16x16x32_bf16 v[144:147], v[40:43], a[152:155], v[144:147]
    ds_read_b128 a[32:35], v66 offset:0
    ds_read_b128 a[36:39], v66 offset:2048
    v_mfma_f32_16x16x32_bf16 v[152:155], v[40:43], a[156:159], v[152:155]
    ds_read_b128 a[160:163], v67 offset:0
    ds_read_b128 a[164:167], v67 offset:2048
    v_mfma_f32_16x16x32_bf16 v[132:135], v[44:47], a[24:27], v[132:135]
    ds_read_b64_tr_b16 v[56:57], v9 offset:16384
    s_add_u32 s60, s96, 14336
    s_addc_u32 s61, s97, 0
    s_add_u32 s60, s60, s93
    s_addc_u32 s61, s61, 0
    s_sub_u32 s62, 1820672, s93
    s_mov_b32 s63, 0x20000
    v_mfma_f32_16x16x32_bf16 v[140:143], v[44:47], a[28:31], v[140:143]
    ds_read_b64_tr_b16 v[58:59], v9 offset:16896
    buffer_load_dwordx4 v65, s[28:31], s26 offen offset:1024 lds
    v_mfma_f32_16x16x32_bf16 v[148:151], v[44:47], a[152:155], v[148:151]
    ds_read_b64_tr_b16 v[60:61], v12 offset:16384
    s_add_u32 s64, s88, s93
    s_addc_u32 s65, s89, 0
    s_sub_u32 s66, 524288, s93
    s_mov_b32 s67, 0x20000
    v_mfma_f32_16x16x32_bf16 v[156:159], v[44:47], a[156:159], v[156:159]
    ds_read_b64_tr_b16 v[62:63], v12 offset:16896
    s_mov_b32 s88, s93
    s_sub_u32 s89, s95, 1024
    v_mfma_f32_16x16x32_bf16 v[160:163], v[48:51], a[24:27], v[160:163]
    ds_read_b64_tr_b16 v[40:41], v9 offset:18432
    v_mfma_f32_16x16x32_bf16 v[168:171], v[48:51], a[28:31], v[168:171]
    ds_read_b64_tr_b16 v[42:43], v9 offset:18944
    buffer_load_dwordx4 v64, s[32:35], s26 offen offset:2048 lds
    v_mfma_f32_16x16x32_bf16 v[176:179], v[48:51], a[152:155], v[176:179]
    ds_read_b64_tr_b16 v[44:45], v12 offset:18432
    v_mfma_f32_16x16x32_bf16 v[184:187], v[48:51], a[156:159], v[184:187]
    ds_read_b64_tr_b16 v[46:47], v12 offset:18944
    v_mfma_f32_16x16x32_bf16 v[164:167], v[52:55], a[24:27], v[164:167]
    v_mfma_f32_16x16x32_bf16 v[172:175], v[52:55], a[28:31], v[172:175]
    buffer_load_dwordx4 v65, s[32:35], s26 offen offset:3072 lds
    s_add_u32 m0, s5, 0
    s_mul_i32 s26, s20, 3584
    v_mfma_f32_16x16x32_bf16 v[180:183], v[52:55], a[152:155], v[180:183]
    v_mfma_f32_16x16x32_bf16 v[188:191], v[52:55], a[156:159], v[188:191]
    s_waitcnt lgkmcnt(4)
    v_mfma_f32_16x16x32_bf16 v[128:131], v[56:59], a[32:35], v[128:131]
    ds_read_b128 a[40:43], v68 offset:0
    v_mfma_f32_16x16x32_bf16 v[136:139], v[56:59], a[36:39], v[136:139]
    ds_read_b128 a[44:47], v68 offset:2048
    buffer_load_dwordx4 v2, s[36:39], s26 offen lds
    v_mfma_f32_16x16x32_bf16 v[144:147], v[56:59], a[160:163], v[144:147]
    ds_read_b128 a[168:171], v69 offset:0
    v_mfma_f32_16x16x32_bf16 v[152:155], v[56:59], a[164:167], v[152:155]
    ds_read_b128 a[172:175], v69 offset:2048
    v_mfma_f32_16x16x32_bf16 v[132:135], v[60:63], a[32:35], v[132:135]
    ds_read_b64_tr_b16 v[48:49], v9 offset:24576
    v_mfma_f32_16x16x32_bf16 v[140:143], v[60:63], a[36:39], v[140:143]
    ds_read_b64_tr_b16 v[50:51], v9 offset:25088
    buffer_load_dwordx4 v3, s[36:39], s26 offen offset:1024 lds
    v_mfma_f32_16x16x32_bf16 v[148:151], v[60:63], a[160:163], v[148:151]
    ds_read_b64_tr_b16 v[52:53], v12 offset:24576
    v_mfma_f32_16x16x32_bf16 v[156:159], v[60:63], a[164:167], v[156:159]
    ds_read_b64_tr_b16 v[54:55], v12 offset:25088
    s_waitcnt lgkmcnt(8)
    v_mfma_f32_16x16x32_bf16 v[160:163], v[40:43], a[32:35], v[160:163]
    ds_read_b64_tr_b16 v[56:57], v9 offset:26624
    v_mfma_f32_16x16x32_bf16 v[168:171], v[40:43], a[36:39], v[168:171]
    ds_read_b64_tr_b16 v[58:59], v9 offset:27136
    buffer_load_dwordx4 v2, s[40:43], s26 offen offset:2048 lds
    v_mfma_f32_16x16x32_bf16 v[176:179], v[40:43], a[160:163], v[176:179]
    ds_read_b64_tr_b16 v[60:61], v12 offset:26624
    v_mfma_f32_16x16x32_bf16 v[184:187], v[40:43], a[164:167], v[184:187]
    ds_read_b64_tr_b16 v[62:63], v12 offset:27136
    v_mfma_f32_16x16x32_bf16 v[164:167], v[44:47], a[32:35], v[164:167]
    v_mfma_f32_16x16x32_bf16 v[172:175], v[44:47], a[36:39], v[172:175]
    buffer_load_dwordx4 v3, s[40:43], s26 offen offset:3072 lds
    s_add_u32 m0, s5, 16384
    s_lshl_b32 s26, s21, 1
    v_mfma_f32_16x16x32_bf16 v[180:183], v[44:47], a[160:163], v[180:183]
    v_mfma_f32_16x16x32_bf16 v[188:191], v[44:47], a[164:167], v[188:191]
    s_waitcnt lgkmcnt(4)
    v_mfma_f32_16x16x32_bf16 v[128:131], v[48:51], a[40:43], v[128:131]
    s_waitcnt vmcnt(8) lgkmcnt(0)
    s_barrier
    ds_read_b128 a[48:51], v66 offset:32768
    v_mfma_f32_16x16x32_bf16 v[136:139], v[48:51], a[44:47], v[136:139]
    ds_read_b128 a[52:55], v66 offset:34816
    buffer_load_dwordx4 v64, s[28:31], s26 offen lds
    v_mfma_f32_16x16x32_bf16 v[144:147], v[48:51], a[168:171], v[144:147]
    ds_read_b128 a[176:179], v67 offset:32768
    v_mfma_f32_16x16x32_bf16 v[152:155], v[48:51], a[172:175], v[152:155]
    ds_read_b128 a[180:183], v67 offset:34816
    v_mfma_f32_16x16x32_bf16 v[132:135], v[52:55], a[40:43], v[132:135]
    ds_read_b64_tr_b16 v[40:41], v9 offset:49152
    v_mfma_f32_16x16x32_bf16 v[140:143], v[52:55], a[44:47], v[140:143]
    ds_read_b64_tr_b16 v[42:43], v9 offset:49664
    buffer_load_dwordx4 v65, s[28:31], s26 offen offset:1024 lds
    v_mfma_f32_16x16x32_bf16 v[148:151], v[52:55], a[168:171], v[148:151]
    ds_read_b64_tr_b16 v[44:45], v12 offset:49152
    v_mfma_f32_16x16x32_bf16 v[156:159], v[52:55], a[172:175], v[156:159]
    ds_read_b64_tr_b16 v[46:47], v12 offset:49664
    v_mfma_f32_16x16x32_bf16 v[160:163], v[56:59], a[40:43], v[160:163]
    ds_read_b64_tr_b16 v[48:49], v9 offset:51200
    v_mfma_f32_16x16x32_bf16 v[168:171], v[56:59], a[44:47], v[168:171]
    ds_read_b64_tr_b16 v[50:51], v9 offset:51712
    buffer_load_dwordx4 v64, s[32:35], s26 offen offset:2048 lds
    v_mfma_f32_16x16x32_bf16 v[176:179], v[56:59], a[168:171], v[176:179]
    ds_read_b64_tr_b16 v[52:53], v12 offset:51200
    v_mfma_f32_16x16x32_bf16 v[184:187], v[56:59], a[172:175], v[184:187]
    ds_read_b64_tr_b16 v[54:55], v12 offset:51712
    v_mfma_f32_16x16x32_bf16 v[164:167], v[60:63], a[40:43], v[164:167]
    v_mfma_f32_16x16x32_bf16 v[172:175], v[60:63], a[44:47], v[172:175]
    buffer_load_dwordx4 v65, s[32:35], s26 offen offset:3072 lds
    s_add_u32 m0, s5, 32768
    s_mul_i32 s26, s21, 3584
    v_mfma_f32_16x16x32_bf16 v[180:183], v[60:63], a[168:171], v[180:183]
    v_mfma_f32_16x16x32_bf16 v[188:191], v[60:63], a[172:175], v[188:191]
    s_waitcnt lgkmcnt(4)
    v_mfma_f32_16x16x32_bf16 v[128:131], v[40:43], a[48:51], v[128:131]
    ds_read_b128 a[56:59], v68 offset:32768
    v_mfma_f32_16x16x32_bf16 v[136:139], v[40:43], a[52:55], v[136:139]
    ds_read_b128 a[60:63], v68 offset:34816
    buffer_load_dwordx4 v2, s[36:39], s26 offen lds
    v_mfma_f32_16x16x32_bf16 v[144:147], v[40:43], a[176:179], v[144:147]
    ds_read_b128 a[184:187], v69 offset:32768
    v_mfma_f32_16x16x32_bf16 v[152:155], v[40:43], a[180:183], v[152:155]
    ds_read_b128 a[188:191], v69 offset:34816
    v_mfma_f32_16x16x32_bf16 v[132:135], v[44:47], a[48:51], v[132:135]
    ds_read_b64_tr_b16 v[56:57], v9 offset:57344
    v_mfma_f32_16x16x32_bf16 v[140:143], v[44:47], a[52:55], v[140:143]
    ds_read_b64_tr_b16 v[58:59], v9 offset:57856
    buffer_load_dwordx4 v3, s[36:39], s26 offen offset:1024 lds
    v_mfma_f32_16x16x32_bf16 v[148:151], v[44:47], a[176:179], v[148:151]
    ds_read_b64_tr_b16 v[60:61], v12 offset:57344
    v_mfma_f32_16x16x32_bf16 v[156:159], v[44:47], a[180:183], v[156:159]
    ds_read_b64_tr_b16 v[62:63], v12 offset:57856
    s_waitcnt lgkmcnt(8)
    v_mfma_f32_16x16x32_bf16 v[160:163], v[48:51], a[48:51], v[160:163]
    ds_read_b64_tr_b16 v[40:41], v9 offset:59392
    v_mfma_f32_16x16x32_bf16 v[168:171], v[48:51], a[52:55], v[168:171]
    ds_read_b64_tr_b16 v[42:43], v9 offset:59904
    buffer_load_dwordx4 v2, s[40:43], s26 offen offset:2048 lds
    v_mfma_f32_16x16x32_bf16 v[176:179], v[48:51], a[176:179], v[176:179]
    ds_read_b64_tr_b16 v[44:45], v12 offset:59392
    v_mfma_f32_16x16x32_bf16 v[184:187], v[48:51], a[180:183], v[184:187]
    ds_read_b64_tr_b16 v[46:47], v12 offset:59904
    v_mfma_f32_16x16x32_bf16 v[164:167], v[52:55], a[48:51], v[164:167]
    v_mfma_f32_16x16x32_bf16 v[172:175], v[52:55], a[52:55], v[172:175]
    buffer_load_dwordx4 v3, s[40:43], s26 offen offset:3072 lds
    s_add_u32 m0, s5, 49152
    s_lshl_b32 s26, s22, 1
    v_mfma_f32_16x16x32_bf16 v[180:183], v[52:55], a[176:179], v[180:183]
    v_mfma_f32_16x16x32_bf16 v[188:191], v[52:55], a[180:183], v[188:191]
    s_waitcnt lgkmcnt(4)
    v_mfma_f32_16x16x32_bf16 v[128:131], v[56:59], a[56:59], v[128:131]
    s_waitcnt vmcnt(8) lgkmcnt(0)
    s_barrier
    v_add_u32 v66, 0x10000, v66
    v_add_u32 v67, 0x10000, v67
    v_mfma_f32_16x16x32_bf16 v[136:139], v[56:59], a[60:63], v[136:139]
    v_add_u32 v68, 0x10000, v68
    v_add_u32 v69, 0x10000, v69
    buffer_load_dwordx4 v64, s[28:31], s26 offen lds
    v_mfma_f32_16x16x32_bf16 v[144:147], v[56:59], a[184:187], v[144:147]
    ds_read_b128 a[64:67], v66 offset:0
    ds_read_b128 a[68:71], v66 offset:2048
    v_mfma_f32_16x16x32_bf16 v[152:155], v[56:59], a[188:191], v[152:155]
    ds_read_b128 a[192:195], v67 offset:0
    ds_read_b128 a[196:199], v67 offset:2048
    v_mfma_f32_16x16x32_bf16 v[132:135], v[60:63], a[56:59], v[132:135]
    ds_read_b64_tr_b16 v[48:49], v8 offset:0
    v_mfma_f32_16x16x32_bf16 v[140:143], v[60:63], a[60:63], v[140:143]
    ds_read_b64_tr_b16 v[50:51], v8 offset:512
    buffer_load_dwordx4 v65, s[28:31], s26 offen offset:1024 lds
    v_mfma_f32_16x16x32_bf16 v[148:151], v[60:63], a[184:187], v[148:151]
    ds_read_b64_tr_b16 v[52:53], v11 offset:0
    v_mfma_f32_16x16x32_bf16 v[156:159], v[60:63], a[188:191], v[156:159]
    ds_read_b64_tr_b16 v[54:55], v11 offset:512
    v_mfma_f32_16x16x32_bf16 v[160:163], v[40:43], a[56:59], v[160:163]
    ds_read_b64_tr_b16 v[56:57], v8 offset:2048
    v_mfma_f32_16x16x32_bf16 v[168:171], v[40:43], a[60:63], v[168:171]
    ds_read_b64_tr_b16 v[58:59], v8 offset:2560
    buffer_load_dwordx4 v64, s[32:35], s26 offen offset:2048 lds
    v_mfma_f32_16x16x32_bf16 v[176:179], v[40:43], a[184:187], v[176:179]
    ds_read_b64_tr_b16 v[60:61], v11 offset:2048
    v_mfma_f32_16x16x32_bf16 v[184:187], v[40:43], a[188:191], v[184:187]
    ds_read_b64_tr_b16 v[62:63], v11 offset:2560
    v_mfma_f32_16x16x32_bf16 v[164:167], v[44:47], a[56:59], v[164:167]
    v_mfma_f32_16x16x32_bf16 v[172:175], v[44:47], a[60:63], v[172:175]
    buffer_load_dwordx4 v65, s[32:35], s26 offen offset:3072 lds
    s_add_u32 m0, s5, 65536
    s_mul_i32 s26, s22, 3584
    v_mfma_f32_16x16x32_bf16 v[180:183], v[44:47], a[184:187], v[180:183]
    v_mfma_f32_16x16x32_bf16 v[188:191], v[44:47], a[188:191], v[188:191]
    s_waitcnt lgkmcnt(4)
    v_mfma_f32_16x16x32_bf16 v[128:131], v[48:51], a[64:67], v[128:131]
    ds_read_b128 a[72:75], v68 offset:0
    v_mfma_f32_16x16x32_bf16 v[136:139], v[48:51], a[68:71], v[136:139]
    ds_read_b128 a[76:79], v68 offset:2048
    buffer_load_dwordx4 v2, s[36:39], s26 offen lds
    v_mfma_f32_16x16x32_bf16 v[144:147], v[48:51], a[192:195], v[144:147]
    ds_read_b128 a[200:203], v69 offset:0
    v_mfma_f32_16x16x32_bf16 v[152:155], v[48:51], a[196:199], v[152:155]
    ds_read_b128 a[204:207], v69 offset:2048
    v_mfma_f32_16x16x32_bf16 v[132:135], v[52:55], a[64:67], v[132:135]
    ds_read_b64_tr_b16 v[40:41], v8 offset:8192
    v_mfma_f32_16x16x32_bf16 v[140:143], v[52:55], a[68:71], v[140:143]
    ds_read_b64_tr_b16 v[42:43], v8 offset:8704
    buffer_load_dwordx4 v3, s[36:39], s26 offen offset:1024 lds
    v_mfma_f32_16x16x32_bf16 v[148:151], v[52:55], a[192:195], v[148:151]
    ds_read_b64_tr_b16 v[44:45], v11 offset:8192
    v_mfma_f32_16x16x32_bf16 v[156:159], v[52:55], a[196:199], v[156:159]
    ds_read_b64_tr_b16 v[46:47], v11 offset:8704
    s_waitcnt lgkmcnt(8)
    v_mfma_f32_16x16x32_bf16 v[160:163], v[56:59], a[64:67], v[160:163]
    ds_read_b64_tr_b16 v[48:49], v8 offset:10240
    v_mfma_f32_16x16x32_bf16 v[168:171], v[56:59], a[68:71], v[168:171]
    ds_read_b64_tr_b16 v[50:51], v8 offset:10752
    buffer_load_dwordx4 v2, s[40:43], s26 offen offset:2048 lds
    v_mfma_f32_16x16x32_bf16 v[176:179], v[56:59], a[192:195], v[176:179]
    ds_read_b64_tr_b16 v[52:53], v11 offset:10240
    v_mfma_f32_16x16x32_bf16 v[184:187], v[56:59], a[196:199], v[184:187]
    ds_read_b64_tr_b16 v[54:55], v11 offset:10752
    v_mfma_f32_16x16x32_bf16 v[164:167], v[60:63], a[64:67], v[164:167]
    v_mfma_f32_16x16x32_bf16 v[172:175], v[60:63], a[68:71], v[172:175]
    buffer_load_dwordx4 v3, s[40:43], s26 offen offset:3072 lds
    s_add_u32 m0, s5, 81920
    s_lshl_b32 s26, s23, 1
    v_mfma_f32_16x16x32_bf16 v[180:183], v[60:63], a[192:195], v[180:183]
    v_mfma_f32_16x16x32_bf16 v[188:191], v[60:63], a[196:199], v[188:191]
    s_waitcnt lgkmcnt(4)
    v_mfma_f32_16x16x32_bf16 v[128:131], v[40:43], a[72:75], v[128:131]
    s_waitcnt vmcnt(8) lgkmcnt(0)
    s_barrier
    v_subrev_u32 v66, 0x20000, v66
    v_subrev_u32 v67, 0x20000, v67
    v_mfma_f32_16x16x32_bf16 v[136:139], v[40:43], a[76:79], v[136:139]
    v_subrev_u32 v68, 0x20000, v68
    v_subrev_u32 v69, 0x20000, v69
    buffer_load_dwordx4 v64, s[28:31], s26 offen lds
    v_mfma_f32_16x16x32_bf16 v[144:147], v[40:43], a[200:203], v[144:147]
    ds_read_b128 a[80:83], v66 offset:16384
    ds_read_b128 a[84:87], v66 offset:18432
    v_mfma_f32_16x16x32_bf16 v[152:155], v[40:43], a[204:207], v[152:155]
    ds_read_b128 a[208:211], v67 offset:16384
    ds_read_b128 a[212:215], v67 offset:18432
    v_mfma_f32_16x16x32_bf16 v[132:135], v[44:47], a[72:75], v[132:135]
    ds_read_b64_tr_b16 v[56:57], v8 offset:32768
    v_mfma_f32_16x16x32_bf16 v[140:143], v[44:47], a[76:79], v[140:143]
    ds_read_b64_tr_b16 v[58:59], v8 offset:33280
    buffer_load_dwordx4 v65, s[28:31], s26 offen offset:1024 lds
    v_mfma_f32_16x16x32_bf16 v[148:151], v[44:47], a[200:203], v[148:151]
    ds_read_b64_tr_b16 v[60:61], v11 offset:32768
    v_mfma_f32_16x16x32_bf16 v[156:159], v[44:47], a[204:207], v[156:159]
    ds_read_b64_tr_b16 v[62:63], v11 offset:33280
    v_mfma_f32_16x16x32_bf16 v[160:163], v[48:51], a[72:75], v[160:163]
    ds_read_b64_tr_b16 v[40:41], v8 offset:34816
    v_mfma_f32_16x16x32_bf16 v[168:171], v[48:51], a[76:79], v[168:171]
    ds_read_b64_tr_b16 v[42:43], v8 offset:35328
    buffer_load_dwordx4 v64, s[32:35], s26 offen offset:2048 lds
    v_mfma_f32_16x16x32_bf16 v[176:179], v[48:51], a[200:203], v[176:179]
    ds_read_b64_tr_b16 v[44:45], v11 offset:34816
    v_mfma_f32_16x16x32_bf16 v[184:187], v[48:51], a[204:207], v[184:187]
    ds_read_b64_tr_b16 v[46:47], v11 offset:35328
    v_mfma_f32_16x16x32_bf16 v[164:167], v[52:55], a[72:75], v[164:167]
    v_mfma_f32_16x16x32_bf16 v[172:175], v[52:55], a[76:79], v[172:175]
    buffer_load_dwordx4 v65, s[32:35], s26 offen offset:3072 lds
    s_add_u32 m0, s5, 98304
    s_mul_i32 s26, s23, 3584
    v_mfma_f32_16x16x32_bf16 v[180:183], v[52:55], a[200:203], v[180:183]
    v_mfma_f32_16x16x32_bf16 v[188:191], v[52:55], a[204:207], v[188:191]
    s_waitcnt lgkmcnt(4)
    v_mfma_f32_16x16x32_bf16 v[128:131], v[56:59], a[80:83], v[128:131]
    ds_read_b128 a[88:91], v68 offset:16384
    v_mfma_f32_16x16x32_bf16 v[136:139], v[56:59], a[84:87], v[136:139]
    ds_read_b128 a[92:95], v68 offset:18432
    buffer_load_dwordx4 v2, s[36:39], s26 offen lds
    v_mfma_f32_16x16x32_bf16 v[144:147], v[56:59], a[208:211], v[144:147]
    ds_read_b128 a[216:219], v69 offset:16384
    v_mfma_f32_16x16x32_bf16 v[152:155], v[56:59], a[212:215], v[152:155]
    ds_read_b128 a[220:223], v69 offset:18432
    v_mfma_f32_16x16x32_bf16 v[132:135], v[60:63], a[80:83], v[132:135]
    ds_read_b64_tr_b16 v[48:49], v8 offset:40960
    v_mfma_f32_16x16x32_bf16 v[140:143], v[60:63], a[84:87], v[140:143]
    ds_read_b64_tr_b16 v[50:51], v8 offset:41472
    buffer_load_dwordx4 v3, s[36:39], s26 offen offset:1024 lds
    v_mfma_f32_16x16x32_bf16 v[148:151], v[60:63], a[208:211], v[148:151]
    ds_read_b64_tr_b16 v[52:53], v11 offset:40960
    v_mfma_f32_16x16x32_bf16 v[156:159], v[60:63], a[212:215], v[156:159]
    ds_read_b64_tr_b16 v[54:55], v11 offset:41472
    s_waitcnt lgkmcnt(8)
    v_mfma_f32_16x16x32_bf16 v[160:163], v[40:43], a[80:83], v[160:163]
    ds_read_b64_tr_b16 v[56:57], v8 offset:43008
    v_mfma_f32_16x16x32_bf16 v[168:171], v[40:43], a[84:87], v[168:171]
    ds_read_b64_tr_b16 v[58:59], v8 offset:43520
    buffer_load_dwordx4 v2, s[40:43], s26 offen offset:2048 lds
    v_mfma_f32_16x16x32_bf16 v[176:179], v[40:43], a[208:211], v[176:179]
    ds_read_b64_tr_b16 v[60:61], v11 offset:43008
    v_mfma_f32_16x16x32_bf16 v[184:187], v[40:43], a[212:215], v[184:187]
    ds_read_b64_tr_b16 v[62:63], v11 offset:43520
    v_mfma_f32_16x16x32_bf16 v[164:167], v[44:47], a[80:83], v[164:167]
    v_mfma_f32_16x16x32_bf16 v[172:175], v[44:47], a[84:87], v[172:175]
    buffer_load_dwordx4 v3, s[40:43], s26 offen offset:3072 lds
    s_lshr_b32 s26, s2, 0
    s_lshl_b32 s26, s26, 2
    s_add_u32 s26, s26, s4
    s_mul_i32 s26, s26, 3584
    v_mfma_f32_16x16x32_bf16 v[180:183], v[44:47], a[208:211], v[180:183]
    s_add_u32 s26, s26, 4293132288
    s_sub_u32 s26, s26, s88
    v_lshlrev_b32 v104, 3, v1
    v_cmp_gt_u32 vcc, 3584, v104
    v_mov_b32 v105, 0x7fff0000
    s_nop 0
    v_cndmask_b32 v104, v105, v104, vcc
    v_mfma_f32_16x16x32_bf16 v[188:191], v[44:47], a[212:215], v[188:191]
    s_waitcnt lgkmcnt(4)
    v_mfma_f32_16x16x32_bf16 v[128:131], v[48:51], a[88:91], v[128:131]
    s_waitcnt vmcnt(8) lgkmcnt(0)
    s_barrier
    ds_read_b128 a[96:99], v66 offset:49152
    v_mfma_f32_16x16x32_bf16 v[136:139], v[48:51], a[92:95], v[136:139]
    ds_read_b128 a[100:103], v66 offset:51200
    buffer_load_dword v36, v104, s[56:59], s26 offen
    v_mfma_f32_16x16x32_bf16 v[144:147], v[48:51], a[216:219], v[144:147]
    ds_read_b128 a[224:227], v67 offset:49152
    s_lshr_b32 s26, s2, 0
    s_lshl_b32 s26, s26, 2
    s_add_u32 s26, s26, s4
    s_mul_i32 s26, s26, 1024
    v_mfma_f32_16x16x32_bf16 v[152:155], v[48:51], a[220:223], v[152:155]
    ds_read_b128 a[228:231], v67 offset:51200
    s_add_u32 s26, s26, 4294443008
    s_sub_u32 s26, s26, s88
    v_lshlrev_b32 v104, 3, v1
    v_cmp_gt_u32 vcc, 1024, v104
    v_mov_b32 v105, 0x7fff0000
    s_nop 0
    v_cndmask_b32 v104, v105, v104, vcc
    v_mfma_f32_16x16x32_bf16 v[132:135], v[52:55], a[88:91], v[132:135]
    ds_read_b64_tr_b16 v[40:41], v9 offset:0
    v_mfma_f32_16x16x32_bf16 v[140:143], v[52:55], a[92:95], v[140:143]
    ds_read_b64_tr_b16 v[42:43], v9 offset:512
    buffer_load_dword v74, v104, s[64:67], s26 offen
    v_mfma_f32_16x16x32_bf16 v[148:151], v[52:55], a[216:219], v[148:151]
    ds_read_b64_tr_b16 v[44:45], v12 offset:0
    s_and_b32 s26, s2, 127
    s_lshl2_add_u32 s26, s26, s4
    s_mul_i32 s26, s26, 3584
    v_mfma_f32_16x16x32_bf16 v[156:159], v[52:55], a[220:223], v[156:159]
    ds_read_b64_tr_b16 v[46:47], v12 offset:512
    v_lshrrev_b32 v104, 4, v1
    v_cmp_gt_u32 vcc, 4, v104
    v_mul_u32_u24 v104, 640, v104
    v_mov_b32 v105, 0x7fff0000
    v_cndmask_b32 v104, v105, v104, vcc
    v_mfma_f32_16x16x32_bf16 v[160:163], v[56:59], a[88:91], v[160:163]
    ds_read_b64_tr_b16 v[48:49], v9 offset:2048
    s_add_u32 s26, s26, 256
    s_sub_u32 s26, s26, s8
    v_mfma_f32_16x16x32_bf16 v[168:171], v[56:59], a[92:95], v[168:171]
    ds_read_b64_tr_b16 v[50:51], v9 offset:2560
    buffer_load_dword v76, v104, s[36:39], s26 offen
    v_mfma_f32_16x16x32_bf16 v[176:179], v[56:59], a[216:219], v[176:179]
    ds_read_b64_tr_b16 v[52:53], v12 offset:2048
    v_mfma_f32_16x16x32_bf16 v[184:187], v[56:59], a[220:223], v[184:187]
    ds_read_b64_tr_b16 v[54:55], v12 offset:2560
    v_mfma_f32_16x16x32_bf16 v[164:167], v[60:63], a[88:91], v[164:167]
    v_mfma_f32_16x16x32_bf16 v[172:175], v[60:63], a[92:95], v[172:175]
    buffer_load_dword v77, v104, s[40:43], s26 offen offset:2048
    s_add_u32 s36, s36, 128
    s_addc_u32 s37, s37, 0
    s_sub_u32 s38, s38, 128
    v_mfma_f32_16x16x32_bf16 v[180:183], v[60:63], a[216:219], v[180:183]
    s_add_u32 s40, s40, 128
    s_addc_u32 s41, s41, 0
    s_sub_u32 s42, s42, 128
    v_mfma_f32_16x16x32_bf16 v[188:191], v[60:63], a[220:223], v[188:191]
    s_add_u32 m0, s5, 114688
    s_mul_i32 s26, s16, 3584
    s_waitcnt lgkmcnt(4)
    v_mfma_f32_16x16x32_bf16 v[128:131], v[40:43], a[96:99], v[128:131]
    ds_read_b128 a[104:107], v68 offset:49152
    v_mfma_f32_16x16x32_bf16 v[136:139], v[40:43], a[100:103], v[136:139]
    ds_read_b128 a[108:111], v68 offset:51200
    buffer_load_dwordx4 v2, s[36:39], s26 offen lds
    v_mfma_f32_16x16x32_bf16 v[144:147], v[40:43], a[224:227], v[144:147]
    ds_read_b128 a[232:235], v69 offset:49152
    v_mfma_f32_16x16x32_bf16 v[152:155], v[40:43], a[228:231], v[152:155]
    ds_read_b128 a[236:239], v69 offset:51200
    v_mfma_f32_16x16x32_bf16 v[132:135], v[44:47], a[96:99], v[132:135]
    ds_read_b64_tr_b16 v[56:57], v9 offset:8192
    v_mfma_f32_16x16x32_bf16 v[140:143], v[44:47], a[100:103], v[140:143]
    ds_read_b64_tr_b16 v[58:59], v9 offset:8704
    buffer_load_dwordx4 v3, s[36:39], s26 offen offset:1024 lds
    v_mfma_f32_16x16x32_bf16 v[148:151], v[44:47], a[224:227], v[148:151]
    ds_read_b64_tr_b16 v[60:61], v12 offset:8192
    v_mfma_f32_16x16x32_bf16 v[156:159], v[44:47], a[228:231], v[156:159]
    ds_read_b64_tr_b16 v[62:63], v12 offset:8704
    s_waitcnt lgkmcnt(8)
    v_mfma_f32_16x16x32_bf16 v[160:163], v[48:51], a[96:99], v[160:163]
    ds_read_b64_tr_b16 v[40:41], v9 offset:10240
    v_mfma_f32_16x16x32_bf16 v[168:171], v[48:51], a[100:103], v[168:171]
    ds_read_b64_tr_b16 v[42:43], v9 offset:10752
    buffer_load_dwordx4 v2, s[40:43], s26 offen offset:2048 lds
    v_mfma_f32_16x16x32_bf16 v[176:179], v[48:51], a[224:227], v[176:179]
    ds_read_b64_tr_b16 v[44:45], v12 offset:10240
    v_mfma_f32_16x16x32_bf16 v[184:187], v[48:51], a[228:231], v[184:187]
    ds_read_b64_tr_b16 v[46:47], v12 offset:10752
    v_mfma_f32_16x16x32_bf16 v[164:167], v[52:55], a[96:99], v[164:167]
    v_mfma_f32_16x16x32_bf16 v[172:175], v[52:55], a[100:103], v[172:175]
    buffer_load_dwordx4 v3, s[40:43], s26 offen offset:3072 lds
    s_add_u32 m0, s5, 131072
    s_mul_i32 s26, s17, 3584
    v_mfma_f32_16x16x32_bf16 v[180:183], v[52:55], a[224:227], v[180:183]
    v_mfma_f32_16x16x32_bf16 v[188:191], v[52:55], a[228:231], v[188:191]
    s_waitcnt lgkmcnt(4)
    v_mfma_f32_16x16x32_bf16 v[128:131], v[56:59], a[104:107], v[128:131]
    s_waitcnt vmcnt(8) lgkmcnt(0)
    s_barrier
    v_add_u32 v66, 0x10000, v66
    v_add_u32 v67, 0x10000, v67
    v_mfma_f32_16x16x32_bf16 v[136:139], v[56:59], a[108:111], v[136:139]
    v_add_u32 v68, 0x10000, v68
    v_add_u32 v69, 0x10000, v69
    buffer_load_dwordx4 v2, s[36:39], s26 offen lds
    v_mfma_f32_16x16x32_bf16 v[144:147], v[56:59], a[232:235], v[144:147]
    ds_read_b128 a[112:115], v66 offset:16384
    ds_read_b128 a[116:119], v66 offset:18432
    v_mfma_f32_16x16x32_bf16 v[152:155], v[56:59], a[236:239], v[152:155]
    ds_read_b128 a[240:243], v67 offset:16384
    ds_read_b128 a[244:247], v67 offset:18432
    v_mfma_f32_16x16x32_bf16 v[132:135], v[60:63], a[104:107], v[132:135]
    ds_read_b64_tr_b16 v[48:49], v9 offset:32768
    v_mfma_f32_16x16x32_bf16 v[140:143], v[60:63], a[108:111], v[140:143]
    ds_read_b64_tr_b16 v[50:51], v9 offset:33280
    buffer_load_dwordx4 v3, s[36:39], s26 offen offset:1024 lds
    v_mfma_f32_16x16x32_bf16 v[148:151], v[60:63], a[232:235], v[148:151]
    ds_read_b64_tr_b16 v[52:53], v12 offset:32768
    v_mfma_f32_16x16x32_bf16 v[156:159], v[60:63], a[236:239], v[156:159]
    ds_read_b64_tr_b16 v[54:55], v12 offset:33280
    v_mfma_f32_16x16x32_bf16 v[160:163], v[40:43], a[104:107], v[160:163]
    ds_read_b64_tr_b16 v[56:57], v9 offset:34816
    v_mfma_f32_16x16x32_bf16 v[168:171], v[40:43], a[108:111], v[168:171]
    ds_read_b64_tr_b16 v[58:59], v9 offset:35328
    buffer_load_dwordx4 v2, s[40:43], s26 offen offset:2048 lds
    v_mfma_f32_16x16x32_bf16 v[176:179], v[40:43], a[232:235], v[176:179]
    ds_read_b64_tr_b16 v[60:61], v12 offset:34816
    v_mfma_f32_16x16x32_bf16 v[184:187], v[40:43], a[236:239], v[184:187]
    ds_read_b64_tr_b16 v[62:63], v12 offset:35328
    v_mfma_f32_16x16x32_bf16 v[164:167], v[44:47], a[104:107], v[164:167]
    v_mfma_f32_16x16x32_bf16 v[172:175], v[44:47], a[108:111], v[172:175]
    buffer_load_dwordx4 v3, s[40:43], s26 offen offset:3072 lds
    s_add_u32 m0, s5, 0
    s_mul_i32 s26, s18, 3584
    v_mfma_f32_16x16x32_bf16 v[180:183], v[44:47], a[232:235], v[180:183]
    v_mfma_f32_16x16x32_bf16 v[188:191], v[44:47], a[236:239], v[188:191]
    s_waitcnt lgkmcnt(4)
    v_mfma_f32_16x16x32_bf16 v[128:131], v[48:51], a[112:115], v[128:131]
    ds_read_b128 a[120:123], v68 offset:16384
    v_mfma_f32_16x16x32_bf16 v[136:139], v[48:51], a[116:119], v[136:139]
    ds_read_b128 a[124:127], v68 offset:18432
    buffer_load_dwordx4 v2, s[36:39], s26 offen lds
    v_mfma_f32_16x16x32_bf16 v[144:147], v[48:51], a[240:243], v[144:147]
    ds_read_b128 a[248:251], v69 offset:16384
    v_mfma_f32_16x16x32_bf16 v[152:155], v[48:51], a[244:247], v[152:155]
    ds_read_b128 a[252:255], v69 offset:18432
    v_mfma_f32_16x16x32_bf16 v[132:135], v[52:55], a[112:115], v[132:135]
    ds_read_b64_tr_b16 v[40:41], v9 offset:40960
    v_mfma_f32_16x16x32_bf16 v[140:143], v[52:55], a[116:119], v[140:143]
    ds_read_b64_tr_b16 v[42:43], v9 offset:41472
    buffer_load_dwordx4 v3, s[36:39], s26 offen offset:1024 lds
    v_mfma_f32_16x16x32_bf16 v[148:151], v[52:55], a[240:243], v[148:151]
    ds_read_b64_tr_b16 v[44:45], v12 offset:40960
    v_mfma_f32_16x16x32_bf16 v[156:159], v[52:55], a[244:247], v[156:159]
    ds_read_b64_tr_b16 v[46:47], v12 offset:41472
    s_waitcnt lgkmcnt(8)
    v_mfma_f32_16x16x32_bf16 v[160:163], v[56:59], a[112:115], v[160:163]
    ds_read_b64_tr_b16 v[48:49], v9 offset:43008
    v_mfma_f32_16x16x32_bf16 v[168:171], v[56:59], a[116:119], v[168:171]
    ds_read_b64_tr_b16 v[50:51], v9 offset:43520
    buffer_load_dwordx4 v2, s[40:43], s26 offen offset:2048 lds
    v_mfma_f32_16x16x32_bf16 v[176:179], v[56:59], a[240:243], v[176:179]
    ds_read_b64_tr_b16 v[52:53], v12 offset:43008
    v_mfma_f32_16x16x32_bf16 v[184:187], v[56:59], a[244:247], v[184:187]
    ds_read_b64_tr_b16 v[54:55], v12 offset:43520
    v_mfma_f32_16x16x32_bf16 v[164:167], v[60:63], a[112:115], v[164:167]
    v_mfma_f32_16x16x32_bf16 v[172:175], v[60:63], a[116:119], v[172:175]
    buffer_load_dwordx4 v3, s[40:43], s26 offen offset:3072 lds
    s_add_u32 m0, s5, 16384
    s_mul_i32 s26, s19, 3584
    v_mfma_f32_16x16x32_bf16 v[180:183], v[60:63], a[240:243], v[180:183]
    v_mfma_f32_16x16x32_bf16 v[188:191], v[60:63], a[244:247], v[188:191]
    s_waitcnt lgkmcnt(4)
    v_mfma_f32_16x16x32_bf16 v[128:131], v[40:43], a[120:123], v[128:131]
    s_waitcnt vmcnt(8) lgkmcnt(0)
    s_barrier
    ds_read_b64_tr_b16 v[56:57], v9 offset:49152
    v_mfma_f32_16x16x32_bf16 v[136:139], v[40:43], a[124:127], v[136:139]
    ds_read_b64_tr_b16 v[58:59], v9 offset:49664
    buffer_load_dwordx4 v2, s[36:39], s26 offen lds
    v_mfma_f32_16x16x32_bf16 v[144:147], v[40:43], a[248:251], v[144:147]
    ds_read_b64_tr_b16 v[60:61], v12 offset:49152
    v_mfma_f32_16x16x32_bf16 v[152:155], v[40:43], a[252:255], v[152:155]
    ds_read_b64_tr_b16 v[62:63], v12 offset:49664
    v_mfma_f32_16x16x32_bf16 v[132:135], v[44:47], a[120:123], v[132:135]
    v_mfma_f32_16x16x32_bf16 v[140:143], v[44:47], a[124:127], v[140:143]
    buffer_load_dwordx4 v3, s[36:39], s26 offen offset:1024 lds
    v_mfma_f32_16x16x32_bf16 v[148:151], v[44:47], a[248:251], v[148:151]
    v_mfma_f32_16x16x32_bf16 v[156:159], v[44:47], a[252:255], v[156:159]
    v_mfma_f32_16x16x32_bf16 v[160:163], v[48:51], a[120:123], v[160:163]
    ds_read_b64_tr_b16 v[40:41], v9 offset:51200
    v_mfma_f32_16x16x32_bf16 v[168:171], v[48:51], a[124:127], v[168:171]
    ds_read_b64_tr_b16 v[42:43], v9 offset:51712
    buffer_load_dword v35, v37, s[76:79], 0 offen offset:128 sc1
    v_mfma_f32_16x16x32_bf16 v[176:179], v[48:51], a[248:251], v[176:179]
    ds_read_b64_tr_b16 v[44:45], v12 offset:51200
    v_mfma_f32_16x16x32_bf16 v[184:187], v[48:51], a[252:255], v[184:187]
    ds_read_b64_tr_b16 v[46:47], v12 offset:51712
    v_mfma_f32_16x16x32_bf16 v[164:167], v[52:55], a[120:123], v[164:167]
    v_mfma_f32_16x16x32_bf16 v[172:175], v[52:55], a[124:127], v[172:175]
    buffer_load_dwordx4 v2, s[40:43], s26 offen offset:2048 lds
    v_mfma_f32_16x16x32_bf16 v[180:183], v[52:55], a[248:251], v[180:183]
    v_mfma_f32_16x16x32_bf16 v[188:191], v[52:55], a[252:255], v[188:191]
    s_waitcnt lgkmcnt(4)
    v_mfma_f32_16x16x32_bf16 v[192:195], v[56:59], a[0:3], 0
    ds_read_b64_tr_b16 v[48:49], v9 offset:57344
    s_lshl_b32 s97, s8, 6
    s_add_u32 s96, s97, s11
    s_add_u32 s97, s97, s12
    v_mfma_f32_16x16x32_bf16 v[200:203], v[56:59], a[4:7], 0
    ds_read_b64_tr_b16 v[50:51], v9 offset:57856
    buffer_load_dwordx4 v3, s[40:43], s26 offen offset:3072 lds
    s_add_u32 m0, s5, 32768
    s_mul_i32 s26, s20, 3584
    v_mfma_f32_16x16x32_bf16 v[208:211], v[56:59], a[128:131], 0
    ds_read_b64_tr_b16 v[52:53], v12 offset:57344
    v_mul_f32 v120, v128, v128
    v_mul_f32 v121, v129, v129
    v_mul_f32 v122, v130, v130
    v_mfma_f32_16x16x32_bf16 v[216:219], v[56:59], a[132:135], 0
    ds_read_b64_tr_b16 v[54:55], v12 offset:57856
    v_mul_f32 v123, v131, v131
    v_fmaak_f32 v120, v32, v120, 0xc0135761
    v_fmaak_f32 v121, v32, v121, 0xc0135761
    v_mfma_f32_16x16x32_bf16 v[196:199], v[60:63], a[0:3], 0
    v_fmaak_f32 v122, v32, v122, 0xc0135761
    v_fmaak_f32 v123, v32, v123, 0xc0135761
    v_mul_f32 v120, v120, v128
    v_mul_f32 v121, v121, v129
    v_mfma_f32_16x16x32_bf16 v[204:207], v[60:63], a[4:7], 0
    buffer_load_dwordx4 v2, s[36:39], s26 offen lds
    v_mul_f32 v122, v122, v130
    v_mul_f32 v123, v123, v131
    v_mfma_f32_16x16x32_bf16 v[212:215], v[60:63], a[128:131], 0
    v_exp_f32 v120, v120
    v_exp_f32 v121, v121
    v_mfma_f32_16x16x32_bf16 v[220:223], v[60:63], a[132:135], 0
    v_exp_f32 v122, v122
    s_waitcnt lgkmcnt(4)
    v_mfma_f32_16x16x32_bf16 v[224:227], v[40:43], a[0:3], 0
    ds_read_b64_tr_b16 v[56:57], v9 offset:59392
    v_exp_f32 v123, v123
    v_mul_f32 v160, v128, v160
    v_mfma_f32_16x16x32_bf16 v[232:235], v[40:43], a[4:7], 0
    ds_read_b64_tr_b16 v[58:59], v9 offset:59904
    buffer_load_dwordx4 v3, s[36:39], s26 offen offset:1024 lds
    v_mul_f32 v161, v129, v161
    v_mul_f32 v162, v130, v162
    v_mfma_f32_16x16x32_bf16 v[240:243], v[40:43], a[128:131], 0
    ds_read_b64_tr_b16 v[60:61], v12 offset:59392
    v_mul_f32 v163, v131, v163
    v_add_f32 v120, 1.0, v120
    v_add_f32 v121, 1.0, v121
    v_mfma_f32_16x16x32_bf16 v[248:251], v[40:43], a[132:135], 0
    ds_read_b64_tr_b16 v[62:63], v12 offset:59904
    v_add_f32 v122, 1.0, v122
    v_add_f32 v123, 1.0, v123
    v_mfma_f32_16x16x32_bf16 v[228:231], v[44:47], a[0:3], 0
    v_rcp_f32 v120, v120
    v_rcp_f32 v121, v121
    v_mfma_f32_16x16x32_bf16 v[236:239], v[44:47], a[4:7], 0
    buffer_load_dwordx4 v2, s[40:43], s26 offen offset:2048 lds
    v_rcp_f32 v122, v122
    v_mfma_f32_16x16x32_bf16 v[244:247], v[44:47], a[128:131], 0
    v_rcp_f32 v123, v123
    v_mul_f32 v160, v160, v120
    v_mul_f32 v161, v161, v121
    v_mfma_f32_16x16x32_bf16 v[252:255], v[44:47], a[132:135], 0
    v_mul_f32 v162, v162, v122
    v_mul_f32 v163, v163, v123
    v_cvt_pk_bf16_f32 v128, v160, v161
    s_waitcnt lgkmcnt(4)
    v_mfma_f32_16x16x32_bf16 v[192:195], v[48:51], a[8:11], v[192:195]
    s_waitcnt vmcnt(12) lgkmcnt(0)
    s_barrier
    ds_read_b64_tr_b16 v[40:41], v10 offset:0
    v_cvt_pk_bf16_f32 v129, v162, v163
    v_mfma_f32_16x16x32_bf16 v[200:203], v[48:51], a[12:15], v[200:203]
    ds_read_b64_tr_b16 v[42:43], v10 offset:512
    buffer_load_dwordx4 v3, s[40:43], s26 offen offset:3072 lds
    s_add_u32 m0, s5, 49152
    s_mul_i32 s26, s21, 3584
    v_mfma_f32_16x16x32_bf16 v[208:211], v[48:51], a[136:139], v[208:211]
    ds_read_b64_tr_b16 v[44:45], v13 offset:0
    v_mul_f32 v124, v132, v132
    v_mul_f32 v125, v133, v133
    v_mul_f32 v126, v134, v134
    v_mfma_f32_16x16x32_bf16 v[216:219], v[48:51], a[140:143], v[216:219]
    ds_read_b64_tr_b16 v[46:47], v13 offset:512
    v_mul_f32 v127, v135, v135
    v_fmaak_f32 v124, v32, v124, 0xc0135761
    v_fmaak_f32 v125, v32, v125, 0xc0135761
    v_mfma_f32_16x16x32_bf16 v[196:199], v[52:55], a[8:11], v[196:199]
    v_fmaak_f32 v126, v32, v126, 0xc0135761
    v_fmaak_f32 v127, v32, v127, 0xc0135761
    v_mul_f32 v124, v124, v132
    v_mul_f32 v125, v125, v133
    v_mfma_f32_16x16x32_bf16 v[204:207], v[52:55], a[12:15], v[204:207]
    buffer_load_dwordx4 v2, s[36:39], s26 offen lds
    v_mul_f32 v126, v126, v134
    v_mul_f32 v127, v127, v135
    v_mfma_f32_16x16x32_bf16 v[212:215], v[52:55], a[136:139], v[212:215]
    v_exp_f32 v124, v124
    v_exp_f32 v125, v125
    v_mfma_f32_16x16x32_bf16 v[220:223], v[52:55], a[140:143], v[220:223]
    v_exp_f32 v126, v126
    v_mfma_f32_16x16x32_bf16 v[224:227], v[56:59], a[8:11], v[224:227]
    ds_read_b64_tr_b16 v[48:49], v10 offset:2048
    v_exp_f32 v127, v127
    v_mul_f32 v164, v132, v164
    v_mfma_f32_16x16x32_bf16 v[232:235], v[56:59], a[12:15], v[232:235]
    ds_read_b64_tr_b16 v[50:51], v10 offset:2560
    buffer_load_dwordx4 v3, s[36:39], s26 offen offset:1024 lds
    v_mul_f32 v165, v133, v165
    v_mul_f32 v166, v134, v166
    v_mfma_f32_16x16x32_bf16 v[240:243], v[56:59], a[136:139], v[240:243]
    ds_read_b64_tr_b16 v[52:53], v13 offset:2048
    v_mul_f32 v167, v135, v167
    v_add_f32 v124, 1.0, v124
    v_add_f32 v125, 1.0, v125
    v_mfma_f32_16x16x32_bf16 v[248:251], v[56:59], a[140:143], v[248:251]
    ds_read_b64_tr_b16 v[54:55], v13 offset:2560
    v_add_f32 v126, 1.0, v126
    v_add_f32 v127, 1.0, v127
    v_mfma_f32_16x16x32_bf16 v[228:231], v[60:63], a[8:11], v[228:231]
    v_rcp_f32 v124, v124
    v_rcp_f32 v125, v125
    v_mfma_f32_16x16x32_bf16 v[236:239], v[60:63], a[12:15], v[236:239]
    buffer_load_dwordx4 v2, s[40:43], s26 offen offset:2048 lds
    v_rcp_f32 v126, v126
    v_mfma_f32_16x16x32_bf16 v[244:247], v[60:63], a[136:139], v[244:247]
    v_rcp_f32 v127, v127
    v_mul_f32 v164, v164, v124
    v_mul_f32 v165, v165, v125
    v_mfma_f32_16x16x32_bf16 v[252:255], v[60:63], a[140:143], v[252:255]
    v_mul_f32 v166, v166, v126
    v_mul_f32 v167, v167, v127
    v_cvt_pk_bf16_f32 v130, v164, v165
    s_waitcnt lgkmcnt(4)
    v_mfma_f32_16x16x32_bf16 v[192:195], v[40:43], a[16:19], v[192:195]
    ds_read_b64_tr_b16 v[56:57], v10 offset:8192
    s_waitcnt vmcnt(9)
    v_cmp_eq_u32 vcc, 0, v35
    s_nop 0
    s_and_b32 s91, vcc_lo, -1
    s_cbranch_scc1 LB_poll0_retry
LB_poll0_ok:
    v_mfma_f32_16x16x32_bf16 v[200:203], v[40:43], a[20:23], v[200:203]
    ds_read_b64_tr_b16 v[58:59], v10 offset:8704
    s_and_b32 s93, s13, 0x7ff
    s_lshl_b32 s93, s93, 5
    s_lshr_b32 s95, s4, 1
    s_lshl_b32 s95, s95, 16
    s_add_u32 s93, s93, s95
    v_mfma_f32_16x16x32_bf16 v[208:211], v[40:43], a[144:147], v[208:211]
    ds_read_b64_tr_b16 v[60:61], v13 offset:8192
    buffer_load_dwordx4 v[84:87], v1, s[28:31], s93 offen offset:0
    v_cvt_pk_bf16_f32 v131, v166, v167
    v_mfma_f32_16x16x32_bf16 v[216:219], v[40:43], a[148:151], v[216:219]
    ds_read_b64_tr_b16 v[62:63], v13 offset:8704
    v_mfma_f32_16x16x32_bf16 v[196:199], v[44:47], a[16:19], v[196:199]
    v_mfma_f32_16x16x32_bf16 v[204:207], v[44:47], a[20:23], v[204:207]
    v_mfma_f32_16x16x32_bf16 v[212:215], v[44:47], a[144:147], v[212:215]
    buffer_store_dwordx4 v[128:131], v1, s[52:55], s96 offen sc1
    v_mul_f32 v120, v136, v136
    v_mul_f32 v121, v137, v137
    v_mul_f32 v122, v138, v138
    v_mfma_f32_16x16x32_bf16 v[220:223], v[44:47], a[148:151], v[220:223]
    v_mul_f32 v123, v139, v139
    v_fmaak_f32 v120, v32, v120, 0xc0135761
    v_fmaak_f32 v121, v32, v121, 0xc0135761
    s_waitcnt lgkmcnt(4)
    v_mfma_f32_16x16x32_bf16 v[224:227], v[48:51], a[16:19], v[224:227]
    ds_read_b64_tr_b16 v[40:41], v10 offset:10240
    v_fmaak_f32 v122, v32, v122, 0xc0135761
    v_fmaak_f32 v123, v32, v123, 0xc0135761
    v_mul_f32 v120, v120, v136
    v_mfma_f32_16x16x32_bf16 v[232:235], v[48:51], a[20:23], v[232:235]
    ds_read_b64_tr_b16 v[42:43], v10 offset:10752
    v_mul_f32 v121, v121, v137
    v_mul_f32 v122, v122, v138
    v_mul_f32 v123, v123, v139
    v_mfma_f32_16x16x32_bf16 v[240:243], v[48:51], a[144:147], v[240:243]
    ds_read_b64_tr_b16 v[44:45], v13 offset:10240
    buffer_load_dwordx4 v[88:91], v1, s[28:31], s93 offen offset:1024
    v_exp_f32 v120, v120
    v_mfma_f32_16x16x32_bf16 v[248:251], v[48:51], a[148:151], v[248:251]
    ds_read_b64_tr_b16 v[46:47], v13 offset:10752
    v_exp_f32 v121, v121
    v_mfma_f32_16x16x32_bf16 v[228:231], v[52:55], a[16:19], v[228:231]
    v_exp_f32 v122, v122
    v_exp_f32 v123, v123
    v_mfma_f32_16x16x32_bf16 v[236:239], v[52:55], a[20:23], v[236:239]
    v_mul_f32 v168, v136, v168
    v_mul_f32 v169, v137, v169
    v_mul_f32 v170, v138, v170
    v_mul_f32 v171, v139, v171
    v_mfma_f32_16x16x32_bf16 v[244:247], v[52:55], a[144:147], v[244:247]
    buffer_load_dwordx4 v[92:95], v1, s[28:31], s93 offen offset:2048
    v_add_f32 v120, 1.0, v120
    v_add_f32 v121, 1.0, v121
    v_add_f32 v122, 1.0, v122
    v_mfma_f32_16x16x32_bf16 v[252:255], v[52:55], a[148:151], v[252:255]
    v_add_f32 v123, 1.0, v123
    v_rcp_f32 v120, v120
    s_waitcnt lgkmcnt(4)
    v_mfma_f32_16x16x32_bf16 v[192:195], v[56:59], a[24:27], v[192:195]
    s_waitcnt lgkmcnt(0)
    s_barrier
    ds_read_b64_tr_b16 v[48:49], v8 offset:0
    v_mfma_f32_16x16x32_bf16 v[200:203], v[56:59], a[28:31], v[200:203]
    ds_read_b64_tr_b16 v[50:51], v8 offset:512
    v_rcp_f32 v121, v121
    v_mfma_f32_16x16x32_bf16 v[208:211], v[56:59], a[152:155], v[208:211]
    ds_read_b64_tr_b16 v[52:53], v11 offset:0
    buffer_load_dwordx4 v[96:99], v1, s[28:31], s93 offen offset:3072
    v_rcp_f32 v122, v122
    v_mfma_f32_16x16x32_bf16 v[216:219], v[56:59], a[156:159], v[216:219]
    ds_read_b64_tr_b16 v[54:55], v11 offset:512
    v_rcp_f32 v123, v123
    v_mul_f32 v168, v168, v120
    v_mfma_f32_16x16x32_bf16 v[196:199], v[60:63], a[24:27], v[196:199]
    v_mul_f32 v169, v169, v121
    v_mul_f32 v170, v170, v122
    v_mul_f32 v171, v171, v123
    v_cvt_pk_bf16_f32 v132, v168, v169
    v_mfma_f32_16x16x32_bf16 v[204:207], v[60:63], a[28:31], v[204:207]
    v_cvt_pk_bf16_f32 v133, v170, v171
    v_mul_f32 v124, v140, v140
    v_mul_f32 v125, v141, v141
    v_mul_f32 v126, v142, v142
    v_mfma_f32_16x16x32_bf16 v[212:215], v[60:63], a[152:155], v[212:215]
    global_load_dwordx4 v[100:103], v1, s[98:99]
    s_add_u32 s32, s52, s15
    s_addc_u32 s33, s53, 0
    s_mov_b32 s34, 294912
    v_mfma_f32_16x16x32_bf16 v[220:223], v[60:63], a[156:159], v[220:223]
    v_mul_f32 v127, v143, v143
    v_fmaak_f32 v124, v32, v124, 0xc0135761
    v_fmaak_f32 v125, v32, v125, 0xc0135761
    v_mfma_f32_16x16x32_bf16 v[224:227], v[40:43], a[24:27], v[224:227]
    ds_read_b64_tr_b16 v[56:57], v8 offset:2048
    v_fmaak_f32 v126, v32, v126, 0xc0135761
    v_fmaak_f32 v127, v32, v127, 0xc0135761
    v_mul_f32 v124, v124, v140
    v_mfma_f32_16x16x32_bf16 v[232:235], v[40:43], a[28:31], v[232:235]
    ds_read_b64_tr_b16 v[58:59], v8 offset:2560
    v_mul_f32 v125, v125, v141
    v_mul_f32 v126, v126, v142
    v_mul_f32 v127, v127, v143
    v_mfma_f32_16x16x32_bf16 v[240:243], v[40:43], a[152:155], v[240:243]
    ds_read_b64_tr_b16 v[60:61], v11 offset:2048
    buffer_load_dwordx4 v3, s[40:43], s26 offen offset:3072 lds
    s_add_u32 m0, s5, 65536
    s_mul_i32 s26, s22, 3584
    v_mfma_f32_16x16x32_bf16 v[248:251], v[40:43], a[156:159], v[248:251]
    ds_read_b64_tr_b16 v[62:63], v11 offset:2560
    v_exp_f32 v124, v124
    v_mfma_f32_16x16x32_bf16 v[228:231], v[44:47], a[24:27], v[228:231]
    v_exp_f32 v125, v125
    v_exp_f32 v126, v126
    v_mfma_f32_16x16x32_bf16 v[236:239], v[44:47], a[28:31], v[236:239]
    v_exp_f32 v127, v127
    v_mul_f32 v172, v140, v172
    v_mul_f32 v173, v141, v173
    v_mfma_f32_16x16x32_bf16 v[244:247], v[44:47], a[152:155], v[244:247]
    buffer_load_dwordx4 v2, s[36:39], s26 offen lds
    v_mul_f32 v174, v142, v174
    v_mul_f32 v175, v143, v175
    v_add_f32 v124, 1.0, v124
    v_mfma_f32_16x16x32_bf16 v[252:255], v[44:47], a[156:159], v[252:255]
    v_add_f32 v125, 1.0, v125
    v_add_f32 v126, 1.0, v126
    v_add_f32 v127, 1.0, v127
    s_waitcnt lgkmcnt(4)
    v_mfma_f32_16x16x32_bf16 v[192:195], v[48:51], a[32:35], v[192:195]
    ds_read_b64_tr_b16 v[40:41], v8 offset:8192
    v_rcp_f32 v124, v124
    v_mfma_f32_16x16x32_bf16 v[200:203], v[48:51], a[36:39], v[200:203]
    ds_read_b64_tr_b16 v[42:43], v8 offset:8704
    v_rcp_f32 v125, v125
    v_mfma_f32_16x16x32_bf16 v[208:211], v[48:51], a[160:163], v[208:211]
    ds_read_b64_tr_b16 v[44:45], v11 offset:8192
    buffer_load_dwordx4 v3, s[36:39], s26 offen offset:1024 lds
    v_rcp_f32 v126, v126
    v_mfma_f32_16x16x32_bf16 v[216:219], v[48:51], a[164:167], v[216:219]
    ds_read_b64_tr_b16 v[46:47], v11 offset:8704
    v_rcp_f32 v127, v127
    v_mul_f32 v172, v172, v124
    v_mfma_f32_16x16x32_bf16 v[196:199], v[52:55], a[32:35], v[196:199]
    v_mul_f32 v173, v173, v125
    v_mul_f32 v174, v174, v126
    v_mul_f32 v175, v175, v127
    v_cvt_pk_bf16_f32 v134, v172, v173
    v_mfma_f32_16x16x32_bf16 v[204:207], v[52:55], a[36:39], v[204:207]
    v_cvt_pk_bf16_f32 v135, v174, v175
    v_mfma_f32_16x16x32_bf16 v[212:215], v[52:55], a[160:163], v[212:215]
    buffer_store_dwordx4 v[132:135], v1, s[52:55], s96 offen offset:1024 sc1
    v_mul_f32 v120, v144, v144
    v_mul_f32 v121, v145, v145
    v_mul_f32 v122, v146, v146
    v_mfma_f32_16x16x32_bf16 v[220:223], v[52:55], a[164:167], v[220:223]
    v_mul_f32 v123, v147, v147
    v_fmaak_f32 v120, v32, v120, 0xc0135761
    v_fmaak_f32 v121, v32, v121, 0xc0135761
    s_waitcnt lgkmcnt(4)
    v_mfma_f32_16x16x32_bf16 v[224:227], v[56:59], a[32:35], v[224:227]
    ds_read_b64_tr_b16 v[48:49], v8 offset:10240
    v_fmaak_f32 v122, v32, v122, 0xc0135761
    v_fmaak_f32 v123, v32, v123, 0xc0135761
    v_mul_f32 v120, v120, v144
    v_mfma_f32_16x16x32_bf16 v[232:235], v[56:59], a[36:39], v[232:235]
    ds_read_b64_tr_b16 v[50:51], v8 offset:10752
    v_mul_f32 v121, v121, v145
    v_mul_f32 v122, v122, v146
    v_mul_f32 v123, v123, v147
    v_mfma_f32_16x16x32_bf16 v[240:243], v[56:59], a[160:163], v[240:243]
    ds_read_b64_tr_b16 v[52:53], v11 offset:10240
    buffer_load_dwordx4 v2, s[40:43], s26 offen offset:2048 lds
    v_exp_f32 v120, v120
    v_mfma_f32_16x16x32_bf16 v[248:251], v[56:59], a[164:167], v[248:251]
    ds_read_b64_tr_b16 v[54:55], v11 offset:10752
    v_exp_f32 v121, v121
    v_mfma_f32_16x16x32_bf16 v[228:231], v[60:63], a[32:35], v[228:231]
    v_exp_f32 v122, v122
    v_exp_f32 v123, v123
    v_mfma_f32_16x16x32_bf16 v[236:239], v[60:63], a[36:39], v[236:239]
    v_mul_f32 v176, v144, v176
    v_mul_f32 v177, v145, v177
    v_mul_f32 v178, v146, v178
    v_mul_f32 v179, v147, v179
    v_mfma_f32_16x16x32_bf16 v[244:247], v[60:63], a[160:163], v[244:247]
    buffer_load_dwordx4 v3, s[40:43], s26 offen offset:3072 lds
    s_add_u32 m0, s5, 81920
    s_mul_i32 s26, s23, 3584
    v_add_f32 v120, 1.0, v120
    v_mfma_f32_16x16x32_bf16 v[252:255], v[60:63], a[164:167], v[252:255]
    v_add_f32 v121, 1.0, v121
    v_add_f32 v122, 1.0, v122
    v_add_f32 v123, 1.0, v123
    s_waitcnt lgkmcnt(4)
    v_mfma_f32_16x16x32_bf16 v[192:195], v[40:43], a[40:43], v[192:195]
    s_waitcnt vmcnt(19) lgkmcnt(0)
    s_barrier
    ds_read_b64_tr_b16 v[56:57], v8 offset:16384
    v_mfma_f32_16x16x32_bf16 v[200:203], v[40:43], a[44:47], v[200:203]
    ds_read_b64_tr_b16 v[58:59], v8 offset:16896
    v_rcp_f32 v120, v120
    v_mfma_f32_16x16x32_bf16 v[208:211], v[40:43], a[168:171], v[208:211]
    ds_read_b64_tr_b16 v[60:61], v11 offset:16384
    buffer_load_dwordx4 v2, s[36:39], s26 offen lds
    v_rcp_f32 v121, v121
    v_mfma_f32_16x16x32_bf16 v[216:219], v[40:43], a[172:175], v[216:219]
    ds_read_b64_tr_b16 v[62:63], v11 offset:16896
    v_rcp_f32 v122, v122
    v_mfma_f32_16x16x32_bf16 v[196:199], v[44:47], a[40:43], v[196:199]
    v_rcp_f32 v123, v123
    v_mul_f32 v176, v176, v120
    v_mul_f32 v177, v177, v121
    v_mfma_f32_16x16x32_bf16 v[204:207], v[44:47], a[44:47], v[204:207]
    v_mul_f32 v178, v178, v122
    v_mul_f32 v179, v179, v123
    v_cvt_pk_bf16_f32 v144, v176, v177
    v_cvt_pk_bf16_f32 v145, v178, v179
    v_mfma_f32_16x16x32_bf16 v[212:215], v[44:47], a[168:171], v[212:215]
    buffer_load_dwordx4 v3, s[36:39], s26 offen offset:1024 lds
    v_mul_f32 v124, v148, v148
    v_mul_f32 v125, v149, v149
    v_mul_f32 v126, v150, v150
    v_mfma_f32_16x16x32_bf16 v[220:223], v[44:47], a[172:175], v[220:223]
    v_mul_f32 v127, v151, v151
    v_fmaak_f32 v124, v32, v124, 0xc0135761
    v_fmaak_f32 v125, v32, v125, 0xc0135761
    v_mfma_f32_16x16x32_bf16 v[224:227], v[48:51], a[40:43], v[224:227]
    ds_read_b64_tr_b16 v[40:41], v8 offset:18432
    v_fmaak_f32 v126, v32, v126, 0xc0135761
    v_fmaak_f32 v127, v32, v127, 0xc0135761
    v_mul_f32 v124, v124, v148
    v_mfma_f32_16x16x32_bf16 v[232:235], v[48:51], a[44:47], v[232:235]
    ds_read_b64_tr_b16 v[42:43], v8 offset:18944
    v_mul_f32 v125, v125, v149
    v_mul_f32 v126, v126, v150
    v_mul_f32 v127, v127, v151
    v_mfma_f32_16x16x32_bf16 v[240:243], v[48:51], a[168:171], v[240:243]
    ds_read_b64_tr_b16 v[44:45], v11 offset:18432
    buffer_load_dwordx4 v2, s[40:43], s26 offen offset:2048 lds
    v_exp_f32 v124, v124
    v_mfma_f32_16x16x32_bf16 v[248:251], v[48:51], a[172:175], v[248:251]
    ds_read_b64_tr_b16 v[46:47], v11 offset:18944
    v_exp_f32 v125, v125
    v_mfma_f32_16x16x32_bf16 v[228:231], v[52:55], a[40:43], v[228:231]
    v_exp_f32 v126, v126
    v_exp_f32 v127, v127
    v_mfma_f32_16x16x32_bf16 v[236:239], v[52:55], a[44:47], v[236:239]
    v_mul_f32 v180, v148, v180
    v_mul_f32 v181, v149, v181
    v_mul_f32 v182, v150, v182
    v_mul_f32 v183, v151, v183
    v_mfma_f32_16x16x32_bf16 v[244:247], v[52:55], a[168:171], v[244:247]
    buffer_load_dwordx4 v3, s[40:43], s26 offen offset:3072 lds
    s_sub_u32 s26, s10, s9
    s_add_u32 s26, s26, s89
    s_ashr_i32 s27, s26, 31
    v_mfma_f32_16x16x32_bf16 v[252:255], v[52:55], a[172:175], v[252:255]
    s_add_u32 s36, s36, s26
    s_addc_u32 s37, s37, s27
    s_sub_u32 s38, s38, s26
    s_waitcnt lgkmcnt(4)
    v_mfma_f32_16x16x32_bf16 v[192:195], v[56:59], a[48:51], v[192:195]
    ds_read_b64_tr_b16 v[48:49], v8 offset:24576
    s_add_u32 s40, s40, s26
    s_addc_u32 s41, s41, s27
    s_sub_u32 s42, s42, s26
    v_mfma_f32_16x16x32_bf16 v[200:203], v[56:59], a[52:55], v[200:203]
    ds_read_b64_tr_b16 v[50:51], v8 offset:25088
    s_sub_u32 s36, s36, 2048
    s_subb_u32 s37, s37, 0
    s_add_u32 s38, s38, 2048
    v_mfma_f32_16x16x32_bf16 v[208:211], v[56:59], a[176:179], v[208:211]
    ds_read_b64_tr_b16 v[52:53], v11 offset:24576
    s_add_u32 m0, s5, 98304
    s_mul_i32 s26, s16, 3584
    s_mul_i32 s27, s17, 3584
    s_add_u32 s26, s26, 2048
    v_mfma_f32_16x16x32_bf16 v[216:219], v[56:59], a[180:183], v[216:219]
    ds_read_b64_tr_b16 v[54:55], v11 offset:25088
    buffer_load_dwordx4 v4, s[36:39], s26 offen lds
    v_add_f32 v124, 1.0, v124
    v_add_f32 v125, 1.0, v125
    v_mfma_f32_16x16x32_bf16 v[196:199], v[60:63], a[48:51], v[196:199]
    v_add_f32 v126, 1.0, v126
    v_add_f32 v127, 1.0, v127
    v_rcp_f32 v124, v124
    v_mfma_f32_16x16x32_bf16 v[204:207], v[60:63], a[52:55], v[204:207]
    v_rcp_f32 v125, v125
    v_rcp_f32 v126, v126
    v_mfma_f32_16x16x32_bf16 v[212:215], v[60:63], a[176:179], v[212:215]
    v_rcp_f32 v127, v127
    v_mul_f32 v180, v180, v124
    v_mul_f32 v181, v181, v125
    v_mfma_f32_16x16x32_bf16 v[220:223], v[60:63], a[180:183], v[220:223]
    buffer_load_dwordx4 v5, s[40:43], s26 offen offset:1024 lds
    v_mul_f32 v182, v182, v126
    v_mul_f32 v183, v183, v127
    s_waitcnt lgkmcnt(4)
    v_mfma_f32_16x16x32_bf16 v[224:227], v[40:43], a[48:51], v[224:227]
    ds_read_b64_tr_b16 v[56:57], v8 offset:26624
    v_cvt_pk_bf16_f32 v146, v180, v181
    v_cvt_pk_bf16_f32 v147, v182, v183
    v_mfma_f32_16x16x32_bf16 v[232:235], v[40:43], a[52:55], v[232:235]
    ds_read_b64_tr_b16 v[58:59], v8 offset:27136
    v_mfma_f32_16x16x32_bf16 v[240:243], v[40:43], a[176:179], v[240:243]
    ds_read_b64_tr_b16 v[60:61], v11 offset:26624
    v_mfma_f32_16x16x32_bf16 v[248:251], v[40:43], a[180:183], v[248:251]
    ds_read_b64_tr_b16 v[62:63], v11 offset:27136
    buffer_store_dwordx4 v[144:147], v1, s[52:55], s97 offen sc1
    v_mul_f32 v120, v152, v152
    v_mul_f32 v121, v153, v153
    v_mfma_f32_16x16x32_bf16 v[228:231], v[44:47], a[48:51], v[228:231]
    v_mul_f32 v122, v154, v154
    v_mul_f32 v123, v155, v155
    v_fmaak_f32 v120, v32, v120, 0xc0135761
    v_fmaak_f32 v121, v32, v121, 0xc0135761
    v_mfma_f32_16x16x32_bf16 v[236:239], v[44:47], a[52:55], v[236:239]
    v_fmaak_f32 v122, v32, v122, 0xc0135761
    v_fmaak_f32 v123, v32, v123, 0xc0135761
    v_mul_f32 v120, v120, v152
    v_mul_f32 v121, v121, v153
    v_mfma_f32_16x16x32_bf16 v[244:247], v[44:47], a[176:179], v[244:247]
    v_mul_f32 v122, v122, v154
    v_mul_f32 v123, v123, v155
    v_exp_f32 v120, v120
    v_mfma_f32_16x16x32_bf16 v[252:255], v[44:47], a[180:183], v[252:255]
    buffer_load_dwordx4 v4, s[36:39], s27 offen offset:2048 lds
    v_exp_f32 v121, v121
    s_waitcnt lgkmcnt(4)
    v_mfma_f32_16x16x32_bf16 v[192:195], v[48:51], a[56:59], v[192:195]
    s_waitcnt vmcnt(23) lgkmcnt(0)
    s_barrier
    ds_read_b64_tr_b16 v[40:41], v8 offset:32768
    v_mfma_f32_16x16x32_bf16 v[200:203], v[48:51], a[60:63], v[200:203]
    ds_read_b64_tr_b16 v[42:43], v8 offset:33280
    v_exp_f32 v122, v122
    v_mfma_f32_16x16x32_bf16 v[208:211], v[48:51], a[184:187], v[208:211]
    ds_read_b64_tr_b16 v[44:45], v11 offset:32768
    v_exp_f32 v123, v123
    v_mul_f32 v184, v152, v184
    v_mfma_f32_16x16x32_bf16 v[216:219], v[48:51], a[188:191], v[216:219]
    ds_read_b64_tr_b16 v[46:47], v11 offset:33280
    buffer_load_dwordx4 v5, s[40:43], s27 offen offset:3072 lds
    v_mul_f32 v185, v153, v185
    v_mul_f32 v186, v154, v186
    v_mfma_f32_16x16x32_bf16 v[196:199], v[52:55], a[56:59], v[196:199]
    s_add_u32 m0, s5, 114688
    s_mul_i32 s26, s18, 3584
    s_mul_i32 s27, s19, 3584
    s_add_u32 s26, s26, 2048
    v_mfma_f32_16x16x32_bf16 v[204:207], v[52:55], a[60:63], v[204:207]
    v_mul_f32 v187, v155, v187
    v_add_f32 v120, 1.0, v120
    v_add_f32 v121, 1.0, v121
    v_add_f32 v122, 1.0, v122
    v_mfma_f32_16x16x32_bf16 v[212:215], v[52:55], a[184:187], v[212:215]
    v_add_f32 v123, 1.0, v123
    v_rcp_f32 v120, v120
    v_mfma_f32_16x16x32_bf16 v[220:223], v[52:55], a[188:191], v[220:223]
    buffer_load_dwordx4 v4, s[36:39], s26 offen lds
    v_rcp_f32 v121, v121
    v_mfma_f32_16x16x32_bf16 v[224:227], v[56:59], a[56:59], v[224:227]
    ds_read_b64_tr_b16 v[48:49], v8 offset:34816
    v_rcp_f32 v122, v122
    v_mfma_f32_16x16x32_bf16 v[232:235], v[56:59], a[60:63], v[232:235]
    ds_read_b64_tr_b16 v[50:51], v8 offset:35328
    v_rcp_f32 v123, v123
    v_mul_f32 v184, v184, v120
    v_mfma_f32_16x16x32_bf16 v[240:243], v[56:59], a[184:187], v[240:243]
    ds_read_b64_tr_b16 v[52:53], v11 offset:34816
    v_mul_f32 v185, v185, v121
    v_mul_f32 v186, v186, v122
    v_mul_f32 v187, v187, v123
    v_mfma_f32_16x16x32_bf16 v[248:251], v[56:59], a[188:191], v[248:251]
    ds_read_b64_tr_b16 v[54:55], v11 offset:35328
    buffer_load_dwordx4 v5, s[40:43], s26 offen offset:1024 lds
    v_cvt_pk_bf16_f32 v148, v184, v185
    v_cvt_pk_bf16_f32 v149, v186, v187
    v_mfma_f32_16x16x32_bf16 v[228:231], v[60:63], a[56:59], v[228:231]
    v_mul_f32 v124, v156, v156
    v_mul_f32 v125, v157, v157
    v_mul_f32 v126, v158, v158
    v_mul_f32 v127, v159, v159
    v_mfma_f32_16x16x32_bf16 v[236:239], v[60:63], a[60:63], v[236:239]
    v_fmaak_f32 v124, v32, v124, 0xc0135761
    v_fmaak_f32 v125, v32, v125, 0xc0135761
    v_fmaak_f32 v126, v32, v126, 0xc0135761
    v_fmaak_f32 v127, v32, v127, 0xc0135761
    v_mfma_f32_16x16x32_bf16 v[244:247], v[60:63], a[184:187], v[244:247]
    v_mul_f32 v124, v124, v156
    v_mul_f32 v125, v125, v157
    v_mul_f32 v126, v126, v158
    v_mul_f32 v127, v127, v159
    v_mfma_f32_16x16x32_bf16 v[252:255], v[60:63], a[188:191], v[252:255]
    buffer_load_dwordx4 v4, s[36:39], s27 offen offset:2048 lds
    v_exp_f32 v124, v124
    s_waitcnt lgkmcnt(4)
    v_mfma_f32_16x16x32_bf16 v[192:195], v[40:43], a[64:67], v[192:195]
    ds_read_b64_tr_b16 v[56:57], v8 offset:40960
    v_exp_f32 v125, v125
    v_mfma_f32_16x16x32_bf16 v[200:203], v[40:43], a[68:71], v[200:203]
    ds_read_b64_tr_b16 v[58:59], v8 offset:41472
    v_exp_f32 v126, v126
    v_mfma_f32_16x16x32_bf16 v[208:211], v[40:43], a[192:195], v[208:211]
    ds_read_b64_tr_b16 v[60:61], v11 offset:40960
    v_exp_f32 v127, v127
    v_mul_f32 v188, v156, v188
    v_mfma_f32_16x16x32_bf16 v[216:219], v[40:43], a[196:199], v[216:219]
    ds_read_b64_tr_b16 v[62:63], v11 offset:41472
    buffer_load_dwordx4 v5, s[40:43], s27 offen offset:3072 lds
    v_mul_f32 v189, v157, v189
    v_mul_f32 v190, v158, v190
    v_mfma_f32_16x16x32_bf16 v[196:199], v[44:47], a[64:67], v[196:199]
    s_add_u32 m0, s5, 131072
    s_mul_i32 s26, s20, 3584
    s_mul_i32 s27, s21, 3584
    s_add_u32 s26, s26, 2048
    v_mfma_f32_16x16x32_bf16 v[204:207], v[44:47], a[68:71], v[204:207]
    v_mul_f32 v191, v159, v191
    v_add_f32 v124, 1.0, v124
    v_add_f32 v125, 1.0, v125
    v_add_f32 v126, 1.0, v126
    v_mfma_f32_16x16x32_bf16 v[212:215], v[44:47], a[192:195], v[212:215]
    v_add_f32 v127, 1.0, v127
    v_rcp_f32 v124, v124
    v_mfma_f32_16x16x32_bf16 v[220:223], v[44:47], a[196:199], v[220:223]
    buffer_load_dwordx4 v4, s[36:39], s26 offen lds
    v_rcp_f32 v125, v125
    s_waitcnt lgkmcnt(4)
    v_mfma_f32_16x16x32_bf16 v[224:227], v[48:51], a[64:67], v[224:227]
    ds_read_b64_tr_b16 v[40:41], v8 offset:43008
    v_rcp_f32 v126, v126
    v_mfma_f32_16x16x32_bf16 v[232:235], v[48:51], a[68:71], v[232:235]
    ds_read_b64_tr_b16 v[42:43], v8 offset:43520
    v_rcp_f32 v127, v127
    v_mul_f32 v188, v188, v124
    v_mfma_f32_16x16x32_bf16 v[240:243], v[48:51], a[192:195], v[240:243]
    ds_read_b64_tr_b16 v[44:45], v11 offset:43008
    v_mul_f32 v189, v189, v125
    v_mul_f32 v190, v190, v126
    v_mul_f32 v191, v191, v127
    v_mfma_f32_16x16x32_bf16 v[248:251], v[48:51], a[196:199], v[248:251]
    ds_read_b64_tr_b16 v[46:47], v11 offset:43520
    buffer_load_dwordx4 v5, s[40:43], s26 offen offset:1024 lds
    v_cvt_pk_bf16_f32 v150, v188, v189
    v_cvt_pk_bf16_f32 v151, v190, v191
    v_mfma_f32_16x16x32_bf16 v[228:231], v[52:55], a[64:67], v[228:231]
    v_mfma_f32_16x16x32_bf16 v[236:239], v[52:55], a[68:71], v[236:239]
    v_mfma_f32_16x16x32_bf16 v[244:247], v[52:55], a[192:195], v[244:247]
    v_mfma_f32_16x16x32_bf16 v[252:255], v[52:55], a[196:199], v[252:255]
    buffer_store_dwordx4 v[148:151], v1, s[52:55], s97 offen offset:1024 sc1
    s_waitcnt lgkmcnt(4)
    v_mfma_f32_16x16x32_bf16 v[192:195], v[56:59], a[72:75], v[192:195]
    s_waitcnt vmcnt(21) lgkmcnt(0)
    s_barrier
    ds_read_b64_tr_b16 v[48:49], v8 offset:49152
    v_mfma_f32_16x16x32_bf16 v[200:203], v[56:59], a[76:79], v[200:203]
    ds_read_b64_tr_b16 v[50:51], v8 offset:49664
    v_mfma_f32_16x16x32_bf16 v[208:211], v[56:59], a[200:203], v[208:211]
    ds_read_b64_tr_b16 v[52:53], v11 offset:49152
    v_mfma_f32_16x16x32_bf16 v[216:219], v[56:59], a[204:207], v[216:219]
    ds_read_b64_tr_b16 v[54:55], v11 offset:49664
    buffer_load_dwordx4 v4, s[36:39], s27 offen offset:2048 lds
    v_mfma_f32_16x16x32_bf16 v[196:199], v[60:63], a[72:75], v[196:199]
    v_mfma_f32_16x16x32_bf16 v[204:207], v[60:63], a[76:79], v[204:207]
    v_mfma_f32_16x16x32_bf16 v[212:215], v[60:63], a[200:203], v[212:215]
    v_mfma_f32_16x16x32_bf16 v[220:223], v[60:63], a[204:207], v[220:223]
    buffer_load_dwordx4 v5, s[40:43], s27 offen offset:3072 lds
    v_mfma_f32_16x16x32_bf16 v[224:227], v[40:43], a[72:75], v[224:227]
    ds_read_b64_tr_b16 v[56:57], v8 offset:51200
    s_add_u32 m0, s5, 0
    s_mul_i32 s26, s22, 3584
    s_mul_i32 s27, s23, 3584
    s_add_u32 s26, s26, 2048
    v_mfma_f32_16x16x32_bf16 v[232:235], v[40:43], a[76:79], v[232:235]
    ds_read_b64_tr_b16 v[58:59], v8 offset:51712
    v_mfma_f32_16x16x32_bf16 v[240:243], v[40:43], a[200:203], v[240:243]
    ds_read_b64_tr_b16 v[60:61], v11 offset:51200
    v_mfma_f32_16x16x32_bf16 v[248:251], v[40:43], a[204:207], v[248:251]
    ds_read_b64_tr_b16 v[62:63], v11 offset:51712
    buffer_load_dwordx4 v4, s[36:39], s26 offen lds
    v_mfma_f32_16x16x32_bf16 v[228:231], v[44:47], a[72:75], v[228:231]
    v_mfma_f32_16x16x32_bf16 v[236:239], v[44:47], a[76:79], v[236:239]
    v_mfma_f32_16x16x32_bf16 v[244:247], v[44:47], a[200:203], v[244:247]
    v_mfma_f32_16x16x32_bf16 v[252:255], v[44:47], a[204:207], v[252:255]
    buffer_load_dwordx4 v5, s[40:43], s26 offen offset:1024 lds
    s_waitcnt lgkmcnt(4)
    v_mfma_f32_16x16x32_bf16 v[192:195], v[48:51], a[80:83], v[192:195]
    ds_read_b64_tr_b16 v[40:41], v8 offset:57344
    v_mfma_f32_16x16x32_bf16 v[200:203], v[48:51], a[84:87], v[200:203]
    ds_read_b64_tr_b16 v[42:43], v8 offset:57856
    v_mfma_f32_16x16x32_bf16 v[208:211], v[48:51], a[208:211], v[208:211]
    ds_read_b64_tr_b16 v[44:45], v11 offset:57344
    v_mfma_f32_16x16x32_bf16 v[216:219], v[48:51], a[212:215], v[216:219]
    ds_read_b64_tr_b16 v[46:47], v11 offset:57856
    buffer_load_dwordx4 v4, s[36:39], s27 offen offset:2048 lds
    v_mfma_f32_16x16x32_bf16 v[196:199], v[52:55], a[80:83], v[196:199]
    v_mfma_f32_16x16x32_bf16 v[204:207], v[52:55], a[84:87], v[204:207]
    v_mfma_f32_16x16x32_bf16 v[212:215], v[52:55], a[208:211], v[212:215]
    v_mfma_f32_16x16x32_bf16 v[220:223], v[52:55], a[212:215], v[220:223]
    buffer_load_dwordx4 v5, s[40:43], s27 offen offset:3072 lds
    s_waitcnt lgkmcnt(4)
    v_mfma_f32_16x16x32_bf16 v[224:227], v[56:59], a[80:83], v[224:227]
    ds_read_b64_tr_b16 v[48:49], v8 offset:59392
    v_readlane_b32 s16, v38, 0
    v_mfma_f32_16x16x32_bf16 v[232:235], v[56:59], a[84:87], v[232:235]
    ds_read_b64_tr_b16 v[50:51], v8 offset:59904
    v_readlane_b32 s17, v38, 1
    v_mfma_f32_16x16x32_bf16 v[240:243], v[56:59], a[208:211], v[240:243]
    ds_read_b64_tr_b16 v[52:53], v11 offset:59392
    v_readlane_b32 s18, v38, 2
    v_mfma_f32_16x16x32_bf16 v[248:251], v[56:59], a[212:215], v[248:251]
    ds_read_b64_tr_b16 v[54:55], v11 offset:59904
    v_readlane_b32 s19, v38, 3
    v_mfma_f32_16x16x32_bf16 v[228:231], v[60:63], a[80:83], v[228:231]
    v_readlane_b32 s20, v38, 4
    v_readlane_b32 s21, v38, 5
    v_mfma_f32_16x16x32_bf16 v[236:239], v[60:63], a[84:87], v[236:239]
    v_readlane_b32 s22, v38, 6
    v_readlane_b32 s23, v38, 7
    v_mfma_f32_16x16x32_bf16 v[244:247], v[60:63], a[208:211], v[244:247]
    s_add_u32 s26, s4, 1
    s_and_b32 s26, s26, 3
    s_lshl_b32 s26, s26, 10
    v_add_u32 v2, s26, v1
    v_mfma_f32_16x16x32_bf16 v[252:255], v[60:63], a[212:215], v[252:255]
    s_add_u32 s26, s4, 2
    s_and_b32 s26, s26, 3
    s_lshl_b32 s26, s26, 10
    v_add_u32 v3, s26, v1
    s_waitcnt lgkmcnt(4)
    v_mfma_f32_16x16x32_bf16 v[192:195], v[40:43], a[88:91], v[192:195]
    s_waitcnt vmcnt(22) lgkmcnt(0)
    s_barrier
    ds_read_b64_tr_b16 v[56:57], v9 offset:0
    v_mfma_f32_16x16x32_bf16 v[200:203], v[40:43], a[92:95], v[200:203]
    ds_read_b64_tr_b16 v[58:59], v9 offset:512
    s_add_u32 s26, s4, 3
    s_and_b32 s26, s26, 3
    s_lshl_b32 s26, s26, 10
    v_add_u32 v4, s26, v1
    v_mfma_f32_16x16x32_bf16 v[208:211], v[40:43], a[216:219], v[208:211]
    ds_read_b64_tr_b16 v[60:61], v12 offset:0
    s_add_u32 s26, s4, 4
    s_and_b32 s26, s26, 3
    s_lshl_b32 s26, s26, 10
    v_add_u32 v5, s26, v1
    v_mfma_f32_16x16x32_bf16 v[216:219], v[40:43], a[220:223], v[216:219]
    ds_read_b64_tr_b16 v[62:63], v12 offset:512
    s_add_u32 m0, s5, 16384
    v_mfma_f32_16x16x32_bf16 v[196:199], v[44:47], a[88:91], v[196:199]
    buffer_load_dwordx4 v6, s[56:59], s80 offen lds
    v_mov_b32 v104, 0
    v_mfma_f32_16x16x32_bf16 v[204:207], v[44:47], a[92:95], v[204:207]
    v_mov_b32 v105, 0
    v_mov_b32 v106, 0
    v_mfma_f32_16x16x32_bf16 v[212:215], v[44:47], a[216:219], v[212:215]
    v_mov_b32 v107, 0
    v_dot2c_f32_bf16 v104, v84, v100
    v_mfma_f32_16x16x32_bf16 v[220:223], v[44:47], a[220:223], v[220:223]
    v_dot2c_f32_bf16 v105, v88, v100
    v_mfma_f32_16x16x32_bf16 v[224:227], v[48:51], a[88:91], v[224:227]
    ds_read_b64_tr_b16 v[40:41], v9 offset:2048
    buffer_load_dwordx4 v7, s[56:59], s80 offen offset:1024 lds
    v_mfma_f32_16x16x32_bf16 v[232:235], v[48:51], a[92:95], v[232:235]
    ds_read_b64_tr_b16 v[42:43], v9 offset:2560
    v_dot2c_f32_bf16 v106, v92, v100
    v_mfma_f32_16x16x32_bf16 v[240:243], v[48:51], a[216:219], v[240:243]
    ds_read_b64_tr_b16 v[44:45], v12 offset:2048
    v_dot2c_f32_bf16 v107, v96, v100
    v_mfma_f32_16x16x32_bf16 v[248:251], v[48:51], a[220:223], v[248:251]
    ds_read_b64_tr_b16 v[46:47], v12 offset:2560
    v_dot2c_f32_bf16 v104, v85, v101
    v_mfma_f32_16x16x32_bf16 v[228:231], v[52:55], a[88:91], v[228:231]
    buffer_load_dwordx4 v6, s[60:63], s80 offen offset:2048 lds
    v_dot2c_f32_bf16 v105, v89, v101
    v_mfma_f32_16x16x32_bf16 v[236:239], v[52:55], a[92:95], v[236:239]
    v_dot2c_f32_bf16 v106, v93, v101
    v_dot2c_f32_bf16 v107, v97, v101
    v_mfma_f32_16x16x32_bf16 v[244:247], v[52:55], a[216:219], v[244:247]
    v_dot2c_f32_bf16 v104, v86, v102
    v_dot2c_f32_bf16 v105, v90, v102
    v_mfma_f32_16x16x32_bf16 v[252:255], v[52:55], a[220:223], v[252:255]
    v_dot2c_f32_bf16 v106, v94, v102
    s_waitcnt lgkmcnt(4)
    v_mfma_f32_16x16x32_bf16 v[192:195], v[56:59], a[96:99], v[192:195]
    ds_read_b64_tr_b16 v[48:49], v9 offset:8192
    buffer_load_dwordx4 v7, s[60:63], s80 offen offset:3072 lds
    v_mfma_f32_16x16x32_bf16 v[200:203], v[56:59], a[100:103], v[200:203]
    ds_read_b64_tr_b16 v[50:51], v9 offset:8704
    s_add_u32 m0, s5, 32768
    v_mfma_f32_16x16x32_bf16 v[208:211], v[56:59], a[224:227], v[208:211]
    ds_read_b64_tr_b16 v[52:53], v12 offset:8192
    v_dot2c_f32_bf16 v107, v98, v102
    v_mfma_f32_16x16x32_bf16 v[216:219], v[56:59], a[228:231], v[216:219]
    ds_read_b64_tr_b16 v[54:55], v12 offset:8704
    v_dot2c_f32_bf16 v104, v87, v103
    v_mfma_f32_16x16x32_bf16 v[196:199], v[60:63], a[96:99], v[196:199]
    buffer_load_dwordx4 v6, s[56:59], s81 offen lds
    v_dot2c_f32_bf16 v105, v91, v103
    v_mfma_f32_16x16x32_bf16 v[204:207], v[60:63], a[100:103], v[204:207]
    v_dot2c_f32_bf16 v106, v95, v103
    v_dot2c_f32_bf16 v107, v99, v103
    v_mfma_f32_16x16x32_bf16 v[212:215], v[60:63], a[224:227], v[212:215]
    v_permlane32_swap_b32 v104, v105
    s_nop 0
    v_permlane32_swap_b32 v106, v107
    v_mfma_f32_16x16x32_bf16 v[220:223], v[60:63], a[228:231], v[220:223]
    v_add_f32 v104, v104, v105
    s_waitcnt lgkmcnt(4)
    v_mfma_f32_16x16x32_bf16 v[224:227], v[40:43], a[96:99], v[224:227]
    ds_read_b64_tr_b16 v[56:57], v9 offset:10240
    buffer_load_dwordx4 v7, s[56:59], s81 offen offset:1024 lds
    v_mfma_f32_16x16x32_bf16 v[232:235], v[40:43], a[100:103], v[232:235]
    ds_read_b64_tr_b16 v[58:59], v9 offset:10752
    v_add_f32 v106, v106, v107
    v_mfma_f32_16x16x32_bf16 v[240:243], v[40:43], a[224:227], v[240:243]
    ds_read_b64_tr_b16 v[60:61], v12 offset:10240
    v_permlane16_swap_b32 v104, v106
    v_mfma_f32_16x16x32_bf16 v[248:251], v[40:43], a[228:231], v[248:251]
    ds_read_b64_tr_b16 v[62:63], v12 offset:10752
    v_add_f32 v104, v104, v106
    v_mfma_f32_16x16x32_bf16 v[228:231], v[44:47], a[96:99], v[228:231]
    s_waitcnt vmcnt(12)
    buffer_store_dword v0, v37, s[52:55], s13 offen sc1
    s_add_u32 s13, s13, 4096
    v_mfma_f32_16x16x32_bf16 v[236:239], v[44:47], a[100:103], v[236:239]
    v_add_f32_dpp v104, v104, v104 quad_perm:[1,0,3,2] row_mask:0xf bank_mask:0xf
    s_nop 1
    v_add_f32_dpp v104, v104, v104 quad_perm:[2,3,0,1] row_mask:0xf bank_mask:0xf
    v_mfma_f32_16x16x32_bf16 v[244:247], v[44:47], a[224:227], v[244:247]
    s_nop 0
    v_add_f32_dpp v104, v104, v104 row_half_mirror row_mask:0xf bank_mask:0xf
    v_mfma_f32_16x16x32_bf16 v[252:255], v[44:47], a[228:231], v[252:255]
    s_nop 0
    v_add_f32_dpp v104, v104, v104 row_mirror row_mask:0xf bank_mask:0xf
    s_waitcnt lgkmcnt(4)
    v_mfma_f32_16x16x32_bf16 v[192:195], v[48:51], a[104:107], v[192:195]
    s_waitcnt lgkmcnt(0)
    s_barrier
    ds_read_b64_tr_b16 v[40:41], v9 offset:16384
    v_mfma_f32_16x16x32_bf16 v[200:203], v[48:51], a[108:111], v[200:203]
    ds_read_b64_tr_b16 v[42:43], v9 offset:16896
    buffer_load_dwordx4 v6, s[60:63], s81 offen offset:2048 lds
    v_mfma_f32_16x16x32_bf16 v[208:211], v[48:51], a[232:235], v[208:211]
    ds_read_b64_tr_b16 v[44:45], v12 offset:16384
    v_mul_f32 v104, 0xbfb8aa3b, v104
    v_mfma_f32_16x16x32_bf16 v[216:219], v[48:51], a[236:239], v[216:219]
    ds_read_b64_tr_b16 v[46:47], v12 offset:16896
    v_exp_f32 v104, v104
    v_mfma_f32_16x16x32_bf16 v[196:199], v[52:55], a[104:107], v[196:199]
    v_add_f32 v104, 1.0, v104
    v_rcp_f32 v104, v104
    v_mfma_f32_16x16x32_bf16 v[204:207], v[52:55], a[108:111], v[204:207]
    buffer_load_dwordx4 v7, s[60:63], s81 offen offset:3072 lds
    s_add_u32 m0, s5, 49152
    v_mfma_f32_16x16x32_bf16 v[212:215], v[52:55], a[232:235], v[212:215]
    v_add_f32 v104, 1.0, v104
    s_nop 0
    v_readlane_b32 s96, v104, 0
    v_readlane_b32 s97, v104, 32
    s_nop 0
    v_writelane_b32 v0, s96, 0
    v_writelane_b32 v0, s97, 1
    v_mfma_f32_16x16x32_bf16 v[220:223], v[52:55], a[236:239], v[220:223]
    v_readlane_b32 s96, v104, 16
    v_readlane_b32 s97, v104, 48
    s_nop 0
    v_writelane_b32 v0, s96, 2
    v_writelane_b32 v0, s97, 3
    v_mfma_f32_16x16x32_bf16 v[224:227], v[56:59], a[104:107], v[224:227]
    ds_read_b64_tr_b16 v[48:49], v9 offset:18432
    v_mfma_f32_16x16x32_bf16 v[232:235], v[56:59], a[108:111], v[232:235]
    ds_read_b64_tr_b16 v[50:51], v9 offset:18944
    buffer_load_dwordx4 v6, s[56:59], s82 offen lds
    v_mfma_f32_16x16x32_bf16 v[240:243], v[56:59], a[232:235], v[240:243]
    ds_read_b64_tr_b16 v[52:53], v12 offset:18432
    v_mfma_f32_16x16x32_bf16 v[248:251], v[56:59], a[236:239], v[248:251]
    ds_read_b64_tr_b16 v[54:55], v12 offset:18944
    v_mfma_f32_16x16x32_bf16 v[228:231], v[60:63], a[104:107], v[228:231]
    v_mfma_f32_16x16x32_bf16 v[236:239], v[60:63], a[108:111], v[236:239]
    buffer_load_dwordx4 v7, s[56:59], s82 offen offset:1024 lds
    v_mfma_f32_16x16x32_bf16 v[244:247], v[60:63], a[232:235], v[244:247]
    v_mfma_f32_16x16x32_bf16 v[252:255], v[60:63], a[236:239], v[252:255]
    s_waitcnt lgkmcnt(4)
    v_mfma_f32_16x16x32_bf16 v[192:195], v[40:43], a[112:115], v[192:195]
    ds_read_b64_tr_b16 v[56:57], v9 offset:24576
    v_mfma_f32_16x16x32_bf16 v[200:203], v[40:43], a[116:119], v[200:203]
    ds_read_b64_tr_b16 v[58:59], v9 offset:25088
    buffer_load_dwordx4 v6, s[60:63], s82 offen offset:2048 lds
    v_mfma_f32_16x16x32_bf16 v[208:211], v[40:43], a[240:243], v[208:211]
    ds_read_b64_tr_b16 v[60:61], v12 offset:24576
    v_mfma_f32_16x16x32_bf16 v[216:219], v[40:43], a[244:247], v[216:219]
    ds_read_b64_tr_b16 v[62:63], v12 offset:25088
    v_mfma_f32_16x16x32_bf16 v[196:199], v[44:47], a[112:115], v[196:199]
    v_mfma_f32_16x16x32_bf16 v[204:207], v[44:47], a[116:119], v[204:207]
    buffer_load_dwordx4 v7, s[60:63], s82 offen offset:3072 lds
    s_add_u32 m0, s5, 65536
    v_mfma_f32_16x16x32_bf16 v[212:215], v[44:47], a[240:243], v[212:215]
    v_mfma_f32_16x16x32_bf16 v[220:223], v[44:47], a[244:247], v[220:223]
    s_waitcnt lgkmcnt(4)
    v_mfma_f32_16x16x32_bf16 v[224:227], v[48:51], a[112:115], v[224:227]
    ds_read_b64_tr_b16 v[40:41], v9 offset:26624
    v_mfma_f32_16x16x32_bf16 v[232:235], v[48:51], a[116:119], v[232:235]
    ds_read_b64_tr_b16 v[42:43], v9 offset:27136
    buffer_load_dwordx4 v6, s[56:59], s83 offen lds
    v_mfma_f32_16x16x32_bf16 v[240:243], v[48:51], a[240:243], v[240:243]
    ds_read_b64_tr_b16 v[44:45], v12 offset:26624
    v_mfma_f32_16x16x32_bf16 v[248:251], v[48:51], a[244:247], v[248:251]
    ds_read_b64_tr_b16 v[46:47], v12 offset:27136
    v_mfma_f32_16x16x32_bf16 v[228:231], v[52:55], a[112:115], v[228:231]
    v_mfma_f32_16x16x32_bf16 v[236:239], v[52:55], a[116:119], v[236:239]
    buffer_load_dwordx4 v7, s[56:59], s83 offen offset:1024 lds
    v_mfma_f32_16x16x32_bf16 v[244:247], v[52:55], a[240:243], v[244:247]
    v_mfma_f32_16x16x32_bf16 v[252:255], v[52:55], a[244:247], v[252:255]
    s_waitcnt lgkmcnt(4)
    v_mfma_f32_16x16x32_bf16 v[192:195], v[56:59], a[120:123], v[192:195]
    s_waitcnt lgkmcnt(0)
    s_barrier
    ds_read_b64_tr_b16 v[48:49], v15 offset:32768
    v_mfma_f32_16x16x32_bf16 v[200:203], v[56:59], a[124:127], v[200:203]
    ds_read_b64_tr_b16 v[50:51], v15 offset:33024
    buffer_load_dwordx4 v6, s[60:63], s83 offen offset:2048 lds
    v_mfma_f32_16x16x32_bf16 v[208:211], v[56:59], a[248:251], v[208:211]
    ds_read_b64_tr_b16 v[52:53], v18 offset:32768
    v_mfma_f32_16x16x32_bf16 v[216:219], v[56:59], a[252:255], v[216:219]
    ds_read_b64_tr_b16 v[54:55], v18 offset:33024
    v_mfma_f32_16x16x32_bf16 v[196:199], v[60:63], a[120:123], v[196:199]
    v_mfma_f32_16x16x32_bf16 v[204:207], v[60:63], a[124:127], v[204:207]
    buffer_load_dwordx4 v7, s[60:63], s83 offen offset:3072 lds
    s_add_u32 m0, s5, 81920
    v_mfma_f32_16x16x32_bf16 v[212:215], v[60:63], a[248:251], v[212:215]
    v_mfma_f32_16x16x32_bf16 v[220:223], v[60:63], a[252:255], v[220:223]
    v_mfma_f32_16x16x32_bf16 v[224:227], v[40:43], a[120:123], v[224:227]
    ds_read_b64_tr_b16 v[56:57], v15 offset:33792
    v_mfma_f32_16x16x32_bf16 v[232:235], v[40:43], a[124:127], v[232:235]
    ds_read_b64_tr_b16 v[58:59], v15 offset:34048
    buffer_load_dwordx4 v6, s[56:59], s16 offen lds
    v_mfma_f32_16x16x32_bf16 v[240:243], v[40:43], a[248:251], v[240:243]
    ds_read_b64_tr_b16 v[60:61], v18 offset:33792
    v_mfma_f32_16x16x32_bf16 v[248:251], v[40:43], a[252:255], v[248:251]
    ds_read_b64_tr_b16 v[62:63], v18 offset:34048
    v_mfma_f32_16x16x32_bf16 v[228:231], v[44:47], a[120:123], v[228:231]
    v_mfma_f32_16x16x32_bf16 v[236:239], v[44:47], a[124:127], v[236:239]
    buffer_load_dwordx4 v7, s[56:59], s16 offen offset:1024 lds
    v_mfma_f32_16x16x32_bf16 v[244:247], v[44:47], a[248:251], v[244:247]
    v_mfma_f32_16x16x32_bf16 v[252:255], v[44:47], a[252:255], v[252:255]
    s_waitcnt lgkmcnt(4)
    v_mfma_f32_16x16x32_bf16 v[128:131], v[48:51], a[0:3], 0
    ds_read_b64_tr_b16 v[40:41], v15 offset:40960
    s_waitcnt vmcnt(15)
    ds_read_b64_tr_b16 a[192:193], v20 offset:16384
    ds_read_b64_tr_b16 a[194:195], v20 offset:18432
    ds_read_b64_tr_b16 a[196:197], v23 offset:16384
    ds_read_b64_tr_b16 a[198:199], v23 offset:18432
    v_mfma_f32_16x16x32_bf16 v[136:139], v[48:51], a[4:7], 0
    ds_read_b64_tr_b16 v[42:43], v15 offset:41216
    buffer_load_dwordx4 v6, s[60:63], s16 offen offset:2048 lds
    ds_read_b64_tr_b16 a[200:201], v26 offset:16384
    ds_read_b64_tr_b16 a[202:203], v26 offset:18432
    ds_read_b64_tr_b16 a[204:205], v29 offset:16384
    ds_read_b64_tr_b16 a[206:207], v29 offset:18432
    v_mfma_f32_16x16x32_bf16 v[132:135], v[52:55], a[0:3], 0
    ds_read_b64_tr_b16 v[44:45], v18 offset:40960
    s_waitcnt vmcnt(11) lgkmcnt(14)
    ds_read_b64_tr_b16 a[208:209], v20 offset:32768
    s_waitcnt lgkmcnt(14)
    ds_read_b64_tr_b16 a[210:211], v20 offset:34816
    s_waitcnt lgkmcnt(14)
    ds_read_b64_tr_b16 a[212:213], v23 offset:32768
    v_mfma_f32_16x16x32_bf16 v[140:143], v[52:55], a[4:7], 0
    s_waitcnt lgkmcnt(14)
    ds_read_b64_tr_b16 v[46:47], v18 offset:41216
    buffer_load_dwordx4 v7, s[60:63], s16 offen offset:3072 lds
    s_waitcnt lgkmcnt(14)
    ds_read_b64_tr_b16 a[214:215], v23 offset:34816
    v_mfma_f32_16x16x32_bf16 v[160:163], v[56:59], a[0:3], 0
    s_waitcnt lgkmcnt(14)
    ds_read_b64_tr_b16 v[48:49], v15 offset:41984
    s_waitcnt lgkmcnt(14)
    ds_read_b64_tr_b16 a[216:217], v26 offset:32768
    s_waitcnt lgkmcnt(14)
    ds_read_b64_tr_b16 a[218:219], v26 offset:34816
    v_mfma_f32_16x16x32_bf16 v[168:171], v[56:59], a[4:7], 0
    s_waitcnt lgkmcnt(14)
    ds_read_b64_tr_b16 v[50:51], v15 offset:42240
    s_waitcnt lgkmcnt(14)
    ds_read_b64_tr_b16 a[220:221], v29 offset:32768
    s_waitcnt lgkmcnt(14)
    ds_read_b64_tr_b16 a[222:223], v29 offset:34816
    v_mfma_f32_16x16x32_bf16 v[164:167], v[60:63], a[0:3], 0
    s_waitcnt lgkmcnt(14)
    ds_read_b64_tr_b16 v[52:53], v18 offset:41984
    s_waitcnt lgkmcnt(13) vmcnt(8)
    ds_read_b64_tr_b16 a[224:225], v20 offset:49152
    ds_read_b64_tr_b16 a[226:227], v20 offset:51200
    s_waitcnt lgkmcnt(14)
    ds_read_b64_tr_b16 a[228:229], v23 offset:49152
    v_mfma_f32_16x16x32_bf16 v[172:175], v[60:63], a[4:7], 0
    s_waitcnt lgkmcnt(14)
    ds_read_b64_tr_b16 v[54:55], v18 offset:42240
    s_add_u32 m0, s5, 16384
    s_nop 0
    buffer_load_dwordx4 v6, s[56:59], s17 offen lds
    s_waitcnt lgkmcnt(12)
    v_mfma_f32_16x16x32_bf16 v[128:131], v[40:43], a[8:11], v[128:131]
    ds_read_b64_tr_b16 v[56:57], v15 offset:34816
    ds_read_b64_tr_b16 a[230:231], v23 offset:51200
    ds_read_b64_tr_b16 a[232:233], v26 offset:49152
    s_waitcnt lgkmcnt(14)
    ds_read_b64_tr_b16 a[234:235], v26 offset:51200
    s_waitcnt lgkmcnt(14)
    ds_read_b64_tr_b16 a[236:237], v29 offset:49152
    v_mfma_f32_16x16x32_bf16 v[136:139], v[40:43], a[12:15], v[136:139]
    s_waitcnt lgkmcnt(14)
    ds_read_b64_tr_b16 v[58:59], v15 offset:35072
    s_waitcnt lgkmcnt(14)
    ds_read_b64_tr_b16 a[238:239], v29 offset:51200
    s_waitcnt lgkmcnt(12)
    v_mfma_f32_16x16x32_bf16 v[132:135], v[44:47], a[8:11], v[132:135]
    ds_read_b64_tr_b16 v[60:61], v18 offset:34816
    buffer_load_dwordx4 v7, s[56:59], s17 offen offset:1024 lds
    s_lshl_b32 s97, s9, 6
    s_add_u32 s96, s97, s11
    s_add_u32 s97, s97, s12
    v_mul_f32 v120, v192, v192
    v_mfma_f32_16x16x32_bf16 v[140:143], v[44:47], a[12:15], v[140:143]
    ds_read_b64_tr_b16 v[62:63], v18 offset:35072
    v_mul_f32 v121, v193, v193
    v_mul_f32 v122, v194, v194
    v_mul_f32 v123, v195, v195
    v_fmaak_f32 v120, v32, v120, 0xc0135761
    s_waitcnt lgkmcnt(9)
    v_mfma_f32_16x16x32_bf16 v[160:163], v[48:51], a[8:11], v[160:163]
    ds_read_b64_tr_b16 v[40:41], v15 offset:35840
    buffer_load_dwordx4 v6, s[60:63], s17 offen offset:2048 lds
    v_fmaak_f32 v121, v32, v121, 0xc0135761
    v_fmaak_f32 v122, v32, v122, 0xc0135761
    v_fmaak_f32 v123, v32, v123, 0xc0135761
    v_mul_f32 v120, v120, v192
    v_mfma_f32_16x16x32_bf16 v[168:171], v[48:51], a[12:15], v[168:171]
    ds_read_b64_tr_b16 v[42:43], v15 offset:36096
    v_mul_f32 v121, v121, v193
    v_mul_f32 v122, v122, v194
    v_mul_f32 v123, v123, v195
    v_exp_f32 v120, v120
    v_mfma_f32_16x16x32_bf16 v[164:167], v[52:55], a[8:11], v[164:167]
    ds_read_b64_tr_b16 v[44:45], v18 offset:35840
    buffer_load_dwordx4 v7, s[60:63], s17 offen offset:3072 lds
    s_add_u32 m0, s5, 32768
    v_exp_f32 v121, v121
    v_mfma_f32_16x16x32_bf16 v[172:175], v[52:55], a[12:15], v[172:175]
    ds_read_b64_tr_b16 v[46:47], v18 offset:36096
    v_exp_f32 v122, v122
    v_exp_f32 v123, v123
    s_waitcnt lgkmcnt(4)
    v_mfma_f32_16x16x32_bf16 v[128:131], v[56:59], a[16:19], v[128:131]
    ds_read_b64_tr_b16 v[48:49], v15 offset:43008
    s_waitcnt vmcnt(8)
    ds_read_b64_tr_b16 a[240:241], v21 offset:0
    ds_read_b64_tr_b16 a[242:243], v21 offset:2048
    ds_read_b64_tr_b16 a[244:245], v24 offset:0
    ds_read_b64_tr_b16 a[246:247], v24 offset:2048
    v_mfma_f32_16x16x32_bf16 v[136:139], v[56:59], a[20:23], v[136:139]
    ds_read_b64_tr_b16 v[50:51], v15 offset:43264
    buffer_load_dwordx4 v6, s[56:59], s18 offen lds
    ds_read_b64_tr_b16 a[248:249], v27 offset:0
    ds_read_b64_tr_b16 a[250:251], v27 offset:2048
    ds_read_b64_tr_b16 a[252:253], v30 offset:0
    ds_read_b64_tr_b16 a[254:255], v30 offset:2048
    v_mfma_f32_16x16x32_bf16 v[132:135], v[60:63], a[16:19], v[132:135]
    ds_read_b64_tr_b16 v[52:53], v18 offset:43008
    v_mul_f32 v224, v192, v224
    v_mul_f32 v225, v193, v225
    v_mul_f32 v226, v194, v226
    v_mul_f32 v227, v195, v227
    v_add_f32 v120, 1.0, v120
    v_mfma_f32_16x16x32_bf16 v[140:143], v[60:63], a[20:23], v[140:143]
    s_waitcnt lgkmcnt(14)
    ds_read_b64_tr_b16 v[54:55], v18 offset:43264
    buffer_load_dwordx4 v7, s[56:59], s18 offen offset:1024 lds
    v_add_f32 v121, 1.0, v121
    v_add_f32 v122, 1.0, v122
    s_waitcnt lgkmcnt(12)
    v_mfma_f32_16x16x32_bf16 v[160:163], v[40:43], a[16:19], v[160:163]
    ds_read_b64_tr_b16 v[56:57], v15 offset:44032
    v_add_f32 v123, 1.0, v123
    v_rcp_f32 v120, v120
    v_rcp_f32 v121, v121
    v_mfma_f32_16x16x32_bf16 v[168:171], v[40:43], a[20:23], v[168:171]
    ds_read_b64_tr_b16 v[58:59], v15 offset:44288
    s_waitcnt lgkmcnt(4)
    v_rcp_f32 v122, v122
    v_rcp_f32 v123, v123
    v_mfma_f32_16x16x32_bf16 v[164:167], v[44:47], a[16:19], v[164:167]
    ds_read_b64_tr_b16 v[60:61], v18 offset:44032
    buffer_load_dwordx4 v6, s[60:63], s18 offen offset:2048 lds
    v_mul_f32 v224, v224, v120
    v_mul_f32 v225, v225, v121
    v_mul_f32 v226, v226, v122
    v_mul_f32 v227, v227, v123
    v_mfma_f32_16x16x32_bf16 v[172:175], v[44:47], a[20:23], v[172:175]
    ds_read_b64_tr_b16 v[62:63], v18 offset:44288
    v_cvt_pk_bf16_f32 v192, v224, v225
    v_cvt_pk_bf16_f32 v193, v226, v227
    v_mul_f32 v124, v196, v196
    v_mul_f32 v125, v197, v197
    s_waitcnt lgkmcnt(4)
    v_mfma_f32_16x16x32_bf16 v[128:131], v[48:51], a[24:27], v[128:131]
    s_waitcnt lgkmcnt(0)
    s_barrier
    ds_read_b64_tr_b16 v[40:41], v15 offset:49152
    buffer_load_dword v35, v33, s[52:55], s14 offen sc1
    v_mul_f32 v126, v198, v198
    v_mul_f32 v127, v199, v199
    v_mfma_f32_16x16x32_bf16 v[136:139], v[48:51], a[28:31], v[136:139]
    ds_read_b64_tr_b16 v[42:43], v15 offset:49408
    v_fmaak_f32 v124, v32, v124, 0xc0135761
    v_fmaak_f32 v125, v32, v125, 0xc0135761
    v_fmaak_f32 v126, v32, v126, 0xc0135761
    v_fmaak_f32 v127, v32, v127, 0xc0135761
    v_mul_f32 v124, v124, v196
    v_mfma_f32_16x16x32_bf16 v[132:135], v[52:55], a[24:27], v[132:135]
    ds_read_b64_tr_b16 v[44:45], v18 offset:49152
    v_mul_f32 v125, v125, v197
    v_mul_f32 v126, v126, v198
    v_mul_f32 v127, v127, v199
    v_exp_f32 v124, v124
    v_mfma_f32_16x16x32_bf16 v[140:143], v[52:55], a[28:31], v[140:143]
    ds_read_b64_tr_b16 v[46:47], v18 offset:49408
    buffer_load_dwordx4 v7, s[60:63], s18 offen offset:3072 lds
    s_add_u32 m0, s5, 49152
    v_exp_f32 v125, v125
    v_mfma_f32_16x16x32_bf16 v[160:163], v[56:59], a[24:27], v[160:163]
    ds_read_b64_tr_b16 v[48:49], v15 offset:50176
    v_exp_f32 v126, v126
    v_exp_f32 v127, v127
    v_mul_f32 v228, v196, v228
    v_mfma_f32_16x16x32_bf16 v[168:171], v[56:59], a[28:31], v[168:171]
    ds_read_b64_tr_b16 v[50:51], v15 offset:50432
    v_mul_f32 v229, v197, v229
    v_mul_f32 v230, v198, v230
    v_mul_f32 v231, v199, v231
    v_add_f32 v124, 1.0, v124
    v_add_f32 v125, 1.0, v125
    v_mfma_f32_16x16x32_bf16 v[164:167], v[60:63], a[24:27], v[164:167]
    ds_read_b64_tr_b16 v[52:53], v18 offset:50176
    buffer_load_dwordx4 v6, s[56:59], s19 offen lds
    v_add_f32 v126, 1.0, v126
    v_add_f32 v127, 1.0, v127
    v_rcp_f32 v124, v124
    v_mfma_f32_16x16x32_bf16 v[172:175], v[60:63], a[28:31], v[172:175]
    ds_read_b64_tr_b16 v[54:55], v18 offset:50432
    v_rcp_f32 v125, v125
    v_rcp_f32 v126, v126
    s_waitcnt lgkmcnt(4)
    v_mfma_f32_16x16x32_bf16 v[128:131], v[40:43], a[32:35], v[128:131]
    ds_read_b64_tr_b16 v[56:57], v15 offset:57344
    buffer_load_dwordx4 v7, s[56:59], s19 offen offset:1024 lds
    v_rcp_f32 v127, v127
    v_mul_f32 v228, v228, v124
    v_mul_f32 v229, v229, v125
    v_mfma_f32_16x16x32_bf16 v[136:139], v[40:43], a[36:39], v[136:139]
    ds_read_b64_tr_b16 v[58:59], v15 offset:57600
    v_mul_f32 v230, v230, v126
    v_mul_f32 v231, v231, v127
    v_cvt_pk_bf16_f32 v194, v228, v229
    v_cvt_pk_bf16_f32 v195, v230, v231
    v_mfma_f32_16x16x32_bf16 v[132:135], v[44:47], a[32:35], v[132:135]
    ds_read_b64_tr_b16 v[60:61], v18 offset:57344
    v_mfma_f32_16x16x32_bf16 v[140:143], v[44:47], a[36:39], v[140:143]
    ds_read_b64_tr_b16 v[62:63], v18 offset:57600
    buffer_store_dwordx4 v[192:195], v1, s[52:55], s96 offen sc1
    v_mul_f32 v120, v200, v200
    v_mul_f32 v121, v201, v201
    v_mul_f32 v122, v202, v202
    s_waitcnt lgkmcnt(4)
    v_mfma_f32_16x16x32_bf16 v[160:163], v[48:51], a[32:35], v[160:163]
    ds_read_b64_tr_b16 v[40:41], v15 offset:58368
    v_mul_f32 v123, v203, v203
    v_fmaak_f32 v120, v32, v120, 0xc0135761
    v_fmaak_f32 v121, v32, v121, 0xc0135761
    v_fmaak_f32 v122, v32, v122, 0xc0135761
    v_fmaak_f32 v123, v32, v123, 0xc0135761
    v_mfma_f32_16x16x32_bf16 v[168:171], v[48:51], a[36:39], v[168:171]
    ds_read_b64_tr_b16 v[42:43], v15 offset:58624
    buffer_load_dwordx4 v6, s[60:63], s19 offen offset:2048 lds
    v_mul_f32 v120, v120, v200
    v_mul_f32 v121, v121, v201
    v_mul_f32 v122, v122, v202
    v_mul_f32 v123, v123, v203
    v_mfma_f32_16x16x32_bf16 v[164:167], v[52:55], a[32:35], v[164:167]
    ds_read_b64_tr_b16 v[44:45], v18 offset:58368
    v_exp_f32 v120, v120
    v_exp_f32 v121, v121
    v_mfma_f32_16x16x32_bf16 v[172:175], v[52:55], a[36:39], v[172:175]
    ds_read_b64_tr_b16 v[46:47], v18 offset:58624
    v_exp_f32 v122, v122
    v_exp_f32 v123, v123
    s_waitcnt lgkmcnt(4)
    v_mfma_f32_16x16x32_bf16 v[128:131], v[56:59], a[40:43], v[128:131]
    ds_read_b64_tr_b16 v[48:49], v15 offset:51200
    buffer_load_dwordx4 v7, s[60:63], s19 offen offset:3072 lds
    s_add_u32 m0, s5, 65536
    v_mul_f32 v232, v200, v232
    v_mul_f32 v233, v201, v233
    v_mul_f32 v234, v202, v234
    v_mfma_f32_16x16x32_bf16 v[136:139], v[56:59], a[44:47], v[136:139]
    ds_read_b64_tr_b16 v[50:51], v15 offset:51456
    v_mul_f32 v235, v203, v235
    v_add_f32 v120, 1.0, v120
    v_add_f32 v121, 1.0, v121
    v_add_f32 v122, 1.0, v122
    v_add_f32 v123, 1.0, v123
    v_mfma_f32_16x16x32_bf16 v[132:135], v[60:63], a[40:43], v[132:135]
    ds_read_b64_tr_b16 v[52:53], v18 offset:51200
    buffer_load_dwordx4 v6, s[56:59], s20 offen lds
    v_rcp_f32 v120, v120
    v_rcp_f32 v121, v121
    v_mfma_f32_16x16x32_bf16 v[140:143], v[60:63], a[44:47], v[140:143]
    ds_read_b64_tr_b16 v[54:55], v18 offset:51456
    v_rcp_f32 v122, v122
    v_rcp_f32 v123, v123
    s_waitcnt lgkmcnt(4)
    v_mfma_f32_16x16x32_bf16 v[160:163], v[40:43], a[40:43], v[160:163]
    ds_read_b64_tr_b16 v[56:57], v15 offset:52224
    s_waitcnt vmcnt(7)
    v_cmp_eq_u32 vcc, 0, v35
    s_nop 0
    s_and_b32 s91, vcc_lo, 255
    s_cbranch_scc1 LB_poll1_retry
LB_poll1_ok:
    v_mfma_f32_16x16x32_bf16 v[168:171], v[40:43], a[44:47], v[168:171]
    ds_read_b64_tr_b16 v[58:59], v15 offset:52480
    s_add_u32 s14, s14, 4096
    s_lshr_b32 s93, s80, 3
    buffer_load_dwordx4 a[128:131], v2, s[32:35], s93 offen sc1
    v_mul_f32 v232, v232, v120
    v_mul_f32 v233, v233, v121
    v_mfma_f32_16x16x32_bf16 v[164:167], v[44:47], a[40:43], v[164:167]
    ds_read_b64_tr_b16 v[60:61], v18 offset:52224
    v_mul_f32 v234, v234, v122
    v_mul_f32 v235, v235, v123
    v_cvt_pk_bf16_f32 v196, v232, v233
    v_cvt_pk_bf16_f32 v197, v234, v235
    v_mul_f32 v124, v204, v204
    v_mfma_f32_16x16x32_bf16 v[172:175], v[44:47], a[44:47], v[172:175]
    ds_read_b64_tr_b16 v[62:63], v18 offset:52480
    v_mul_f32 v125, v205, v205
    v_mul_f32 v126, v206, v206
    v_mul_f32 v127, v207, v207
    v_fmaak_f32 v124, v32, v124, 0xc0135761
    s_waitcnt lgkmcnt(4)
    v_mfma_f32_16x16x32_bf16 v[128:131], v[48:51], a[48:51], v[128:131]
    ds_read_b64_tr_b16 v[40:41], v15 offset:59392
    buffer_load_dwordx4 a[132:135], v3, s[32:35], s93 offen sc1
    v_fmaak_f32 v125, v32, v125, 0xc0135761
    v_fmaak_f32 v126, v32, v126, 0xc0135761
    v_fmaak_f32 v127, v32, v127, 0xc0135761
    v_mul_f32 v124, v124, v204
    v_mfma_f32_16x16x32_bf16 v[136:139], v[48:51], a[52:55], v[136:139]
    ds_read_b64_tr_b16 v[42:43], v15 offset:59648
    v_mul_f32 v125, v125, v205
    v_mul_f32 v126, v126, v206
    v_mul_f32 v127, v127, v207
    v_exp_f32 v124, v124
    v_mfma_f32_16x16x32_bf16 v[132:135], v[52:55], a[48:51], v[132:135]
    ds_read_b64_tr_b16 v[44:45], v18 offset:59392
    buffer_load_dwordx4 a[136:139], v4, s[32:35], s93 offen sc1
    v_exp_f32 v125, v125
    v_exp_f32 v126, v126
    v_mfma_f32_16x16x32_bf16 v[140:143], v[52:55], a[52:55], v[140:143]
    ds_read_b64_tr_b16 v[46:47], v18 offset:59648
    v_exp_f32 v127, v127
    v_mul_f32 v236, v204, v236
    v_mul_f32 v237, v205, v237
    s_waitcnt lgkmcnt(4)
    v_mfma_f32_16x16x32_bf16 v[160:163], v[56:59], a[48:51], v[160:163]
    ds_read_b64_tr_b16 v[48:49], v15 offset:60416
    buffer_load_dwordx4 a[140:143], v5, s[32:35], s93 offen sc1
    v_mul_f32 v238, v206, v238
    v_mul_f32 v239, v207, v239
    v_add_f32 v124, 1.0, v124
    v_add_f32 v125, 1.0, v125
    v_mfma_f32_16x16x32_bf16 v[168:171], v[56:59], a[52:55], v[168:171]
    ds_read_b64_tr_b16 v[50:51], v15 offset:60672
    v_add_f32 v126, 1.0, v126
    v_add_f32 v127, 1.0, v127
    v_rcp_f32 v124, v124
    v_mfma_f32_16x16x32_bf16 v[164:167], v[60:63], a[48:51], v[164:167]
    ds_read_b64_tr_b16 v[52:53], v18 offset:60416
    v_rcp_f32 v125, v125
    v_rcp_f32 v126, v126
    v_mfma_f32_16x16x32_bf16 v[172:175], v[60:63], a[52:55], v[172:175]
    ds_read_b64_tr_b16 v[54:55], v18 offset:60672
    s_lshr_b32 s93, s81, 3
    buffer_load_dwordx4 a[144:147], v2, s[32:35], s93 offen sc1
    v_rcp_f32 v127, v127
    s_waitcnt lgkmcnt(4)
    v_mfma_f32_16x16x32_bf16 v[128:131], v[40:43], a[56:59], v[128:131]
    s_waitcnt lgkmcnt(0)
    s_barrier
    ds_read_b64_tr_b16 v[56:57], v16 offset:0
    buffer_load_dwordx4 a[148:151], v3, s[32:35], s93 offen sc1
    v_mul_f32 v236, v236, v124
    v_mul_f32 v237, v237, v125
    v_mfma_f32_16x16x32_bf16 v[136:139], v[40:43], a[60:63], v[136:139]
    ds_read_b64_tr_b16 v[58:59], v16 offset:256
    v_mul_f32 v238, v238, v126
    v_mul_f32 v239, v239, v127
    v_cvt_pk_bf16_f32 v198, v236, v237
    v_cvt_pk_bf16_f32 v199, v238, v239
    v_mfma_f32_16x16x32_bf16 v[132:135], v[44:47], a[56:59], v[132:135]
    ds_read_b64_tr_b16 v[60:61], v19 offset:0
    v_mfma_f32_16x16x32_bf16 v[140:143], v[44:47], a[60:63], v[140:143]
    ds_read_b64_tr_b16 v[62:63], v19 offset:256
    buffer_store_dwordx4 v[196:199], v1, s[52:55], s96 offen offset:1024 sc1
    v_mul_f32 v120, v208, v208
    v_mul_f32 v121, v209, v209
    v_mul_f32 v122, v210, v210
    v_mfma_f32_16x16x32_bf16 v[160:163], v[48:51], a[56:59], v[160:163]
    ds_read_b64_tr_b16 v[40:41], v16 offset:1024
    v_mul_f32 v123, v211, v211
    v_fmaak_f32 v120, v32, v120, 0xc0135761
    v_fmaak_f32 v121, v32, v121, 0xc0135761
    v_fmaak_f32 v122, v32, v122, 0xc0135761
    v_fmaak_f32 v123, v32, v123, 0xc0135761
    v_mfma_f32_16x16x32_bf16 v[168:171], v[48:51], a[60:63], v[168:171]
    ds_read_b64_tr_b16 v[42:43], v16 offset:1280
    v_mul_f32 v120, v120, v208
    v_mul_f32 v121, v121, v209
    v_mul_f32 v122, v122, v210
    v_mul_f32 v123, v123, v211
    v_mfma_f32_16x16x32_bf16 v[164:167], v[52:55], a[56:59], v[164:167]
    ds_read_b64_tr_b16 v[44:45], v19 offset:1024
    buffer_load_dwordx4 a[152:155], v4, s[32:35], s93 offen sc1
    v_exp_f32 v120, v120
    v_exp_f32 v121, v121
    v_mfma_f32_16x16x32_bf16 v[172:175], v[52:55], a[60:63], v[172:175]
    ds_read_b64_tr_b16 v[46:47], v19 offset:1280
    v_exp_f32 v122, v122
    v_exp_f32 v123, v123
    s_waitcnt lgkmcnt(4)
    v_mfma_f32_16x16x32_bf16 v[128:131], v[56:59], a[64:67], v[128:131]
    ds_read_b64_tr_b16 v[48:49], v16 offset:8192
    buffer_load_dwordx4 a[156:159], v5, s[32:35], s93 offen sc1
    v_mul_f32 v240, v208, v240
    v_mul_f32 v241, v209, v241
    v_mul_f32 v242, v210, v242
    v_mul_f32 v243, v211, v243
    v_mfma_f32_16x16x32_bf16 v[136:139], v[56:59], a[68:71], v[136:139]
    ds_read_b64_tr_b16 v[50:51], v16 offset:8448
    v_add_f32 v120, 1.0, v120
    v_add_f32 v121, 1.0, v121
    v_add_f32 v122, 1.0, v122
    v_add_f32 v123, 1.0, v123
    v_mfma_f32_16x16x32_bf16 v[132:135], v[60:63], a[64:67], v[132:135]
    ds_read_b64_tr_b16 v[52:53], v19 offset:8192
    v_rcp_f32 v120, v120
    v_rcp_f32 v121, v121
    v_mfma_f32_16x16x32_bf16 v[140:143], v[60:63], a[68:71], v[140:143]
    ds_read_b64_tr_b16 v[54:55], v19 offset:8448
    s_lshr_b32 s93, s82, 3
    buffer_load_dwordx4 a[160:163], v2, s[32:35], s93 offen sc1
    v_rcp_f32 v122, v122
    s_waitcnt lgkmcnt(4)
    v_mfma_f32_16x16x32_bf16 v[160:163], v[40:43], a[64:67], v[160:163]
    ds_read_b64_tr_b16 v[56:57], v16 offset:9216
    v_rcp_f32 v123, v123
    v_mul_f32 v240, v240, v120
    v_mul_f32 v241, v241, v121
    v_mul_f32 v242, v242, v122
    v_mfma_f32_16x16x32_bf16 v[168:171], v[40:43], a[68:71], v[168:171]
    ds_read_b64_tr_b16 v[58:59], v16 offset:9472
    v_mul_f32 v243, v243, v123
    v_cvt_pk_bf16_f32 v208, v240, v241
    v_cvt_pk_bf16_f32 v209, v242, v243
    v_mul_f32 v124, v212, v212
    v_mul_f32 v125, v213, v213
    v_mfma_f32_16x16x32_bf16 v[164:167], v[44:47], a[64:67], v[164:167]
    ds_read_b64_tr_b16 v[60:61], v19 offset:9216
    buffer_load_dwordx4 a[164:167], v3, s[32:35], s93 offen sc1
    v_mul_f32 v126, v214, v214
    v_mul_f32 v127, v215, v215
    v_fmaak_f32 v124, v32, v124, 0xc0135761
    v_fmaak_f32 v125, v32, v125, 0xc0135761
    v_mfma_f32_16x16x32_bf16 v[172:175], v[44:47], a[68:71], v[172:175]
    ds_read_b64_tr_b16 v[62:63], v19 offset:9472
    v_fmaak_f32 v126, v32, v126, 0xc0135761
    v_fmaak_f32 v127, v32, v127, 0xc0135761
    v_mul_f32 v124, v124, v212
    v_mul_f32 v125, v125, v213
    s_waitcnt lgkmcnt(4)
    v_mfma_f32_16x16x32_bf16 v[128:131], v[48:51], a[72:75], v[128:131]
    ds_read_b64_tr_b16 v[40:41], v16 offset:2048
    buffer_load_dwordx4 a[168:171], v4, s[32:35], s93 offen sc1
    v_mul_f32 v126, v126, v214
    v_mul_f32 v127, v127, v215
    v_exp_f32 v124, v124
    v_mfma_f32_16x16x32_bf16 v[136:139], v[48:51], a[76:79], v[136:139]
    ds_read_b64_tr_b16 v[42:43], v16 offset:2304
    v_exp_f32 v125, v125
    v_exp_f32 v126, v126
    v_mfma_f32_16x16x32_bf16 v[132:135], v[52:55], a[72:75], v[132:135]
    ds_read_b64_tr_b16 v[44:45], v19 offset:2048
    v_exp_f32 v127, v127
    v_mul_f32 v244, v212, v244
    v_mul_f32 v245, v213, v245
    v_mul_f32 v246, v214, v246
    v_mfma_f32_16x16x32_bf16 v[140:143], v[52:55], a[76:79], v[140:143]
    ds_read_b64_tr_b16 v[46:47], v19 offset:2304
    buffer_load_dwordx4 a[172:175], v5, s[32:35], s93 offen sc1
    v_mul_f32 v247, v215, v247
    v_add_f32 v124, 1.0, v124
    v_add_f32 v125, 1.0, v125
    s_waitcnt lgkmcnt(4)
    v_mfma_f32_16x16x32_bf16 v[160:163], v[56:59], a[72:75], v[160:163]
    ds_read_b64_tr_b16 v[48:49], v16 offset:3072
    v_add_f32 v126, 1.0, v126
    v_add_f32 v127, 1.0, v127
    v_rcp_f32 v124, v124
    v_mfma_f32_16x16x32_bf16 v[168:171], v[56:59], a[76:79], v[168:171]
    ds_read_b64_tr_b16 v[50:51], v16 offset:3328
    v_rcp_f32 v125, v125
    v_rcp_f32 v126, v126
    v_mfma_f32_16x16x32_bf16 v[164:167], v[60:63], a[72:75], v[164:167]
    ds_read_b64_tr_b16 v[52:53], v19 offset:3072
    s_lshr_b32 s93, s83, 3
    buffer_load_dwordx4 a[176:179], v2, s[32:35], s93 offen sc1
    v_rcp_f32 v127, v127
    v_mul_f32 v244, v244, v124
    v_mfma_f32_16x16x32_bf16 v[172:175], v[60:63], a[76:79], v[172:175]
    ds_read_b64_tr_b16 v[54:55], v19 offset:3328
    v_mul_f32 v245, v245, v125
    v_mul_f32 v246, v246, v126
    v_mul_f32 v247, v247, v127
    v_cvt_pk_bf16_f32 v210, v244, v245
    s_waitcnt lgkmcnt(4)
    v_mfma_f32_16x16x32_bf16 v[128:131], v[40:43], a[80:83], v[128:131]
    ds_read_b64_tr_b16 v[56:57], v16 offset:10240
    v_cvt_pk_bf16_f32 v211, v246, v247
    buffer_store_dwordx4 v[208:211], v1, s[52:55], s97 offen sc1
    v_mul_f32 v120, v216, v216
    v_mul_f32 v121, v217, v217
    v_mul_f32 v122, v218, v218
    v_mfma_f32_16x16x32_bf16 v[136:139], v[40:43], a[84:87], v[136:139]
    ds_read_b64_tr_b16 v[58:59], v16 offset:10496
    v_mul_f32 v123, v219, v219
    v_fmaak_f32 v120, v32, v120, 0xc0135761
    v_fmaak_f32 v121, v32, v121, 0xc0135761
    v_fmaak_f32 v122, v32, v122, 0xc0135761
    v_fmaak_f32 v123, v32, v123, 0xc0135761
    v_mfma_f32_16x16x32_bf16 v[132:135], v[44:47], a[80:83], v[132:135]
    ds_read_b64_tr_b16 v[60:61], v19 offset:10240
    v_mul_f32 v120, v120, v216
    v_mul_f32 v121, v121, v217
    v_mul_f32 v122, v122, v218
    v_mul_f32 v123, v123, v219
    v_mfma_f32_16x16x32_bf16 v[140:143], v[44:47], a[84:87], v[140:143]
    ds_read_b64_tr_b16 v[62:63], v19 offset:10496
    buffer_load_dwordx4 a[180:183], v3, s[32:35], s93 offen sc1
    v_exp_f32 v120, v120
    s_waitcnt lgkmcnt(4)
    v_mfma_f32_16x16x32_bf16 v[160:163], v[48:51], a[80:83], v[160:163]
    ds_read_b64_tr_b16 v[40:41], v16 offset:11264
    v_exp_f32 v121, v121
    v_exp_f32 v122, v122
    v_mfma_f32_16x16x32_bf16 v[168:171], v[48:51], a[84:87], v[168:171]
    ds_read_b64_tr_b16 v[42:43], v16 offset:11520
    v_exp_f32 v123, v123
    v_mul_f32 v248, v216, v248
    v_mul_f32 v249, v217, v249
    v_mul_f32 v250, v218, v250
    v_mfma_f32_16x16x32_bf16 v[164:167], v[52:55], a[80:83], v[164:167]
    ds_read_b64_tr_b16 v[44:45], v19 offset:11264
    buffer_load_dwordx4 a[184:187], v4, s[32:35], s93 offen sc1
    v_mul_f32 v251, v219, v251
    v_add_f32 v120, 1.0, v120
    v_add_f32 v121, 1.0, v121
    v_add_f32 v122, 1.0, v122
    v_mfma_f32_16x16x32_bf16 v[172:175], v[52:55], a[84:87], v[172:175]
    ds_read_b64_tr_b16 v[46:47], v19 offset:11520
    v_add_f32 v123, 1.0, v123
    v_rcp_f32 v120, v120
    s_waitcnt lgkmcnt(4)
    v_mfma_f32_16x16x32_bf16 v[128:131], v[56:59], a[88:91], v[128:131]
    s_waitcnt lgkmcnt(0)
    s_barrier
    ds_read_b64_tr_b16 v[48:49], v14 offset:0
    buffer_load_dwordx4 a[188:191], v5, s[32:35], s93 offen sc1
    v_rcp_f32 v121, v121
    v_mfma_f32_16x16x32_bf16 v[136:139], v[56:59], a[92:95], v[136:139]
    ds_read_b64_tr_b16 v[50:51], v14 offset:256
    v_rcp_f32 v122, v122
    v_rcp_f32 v123, v123
    v_mul_f32 v248, v248, v120
    v_mfma_f32_16x16x32_bf16 v[132:135], v[60:63], a[88:91], v[132:135]
    ds_read_b64_tr_b16 v[52:53], v17 offset:0
    v_mul_f32 v249, v249, v121
    v_mul_f32 v250, v250, v122
    v_mul_f32 v251, v251, v123
    v_cvt_pk_bf16_f32 v212, v248, v249
    v_cvt_pk_bf16_f32 v213, v250, v251
    v_mfma_f32_16x16x32_bf16 v[140:143], v[60:63], a[92:95], v[140:143]
    ds_read_b64_tr_b16 v[54:55], v17 offset:256
    buffer_load_dwordx4 v7, s[56:59], s20 offen offset:1024 lds
    v_mul_f32 v124, v220, v220
    v_mul_f32 v125, v221, v221
    v_mul_f32 v126, v222, v222
    v_mfma_f32_16x16x32_bf16 v[160:163], v[40:43], a[88:91], v[160:163]
    ds_read_b64_tr_b16 v[56:57], v14 offset:1024
    v_mul_f32 v127, v223, v223
    v_fmaak_f32 v124, v32, v124, 0xc0135761
    v_fmaak_f32 v125, v32, v125, 0xc0135761
    v_fmaak_f32 v126, v32, v126, 0xc0135761
    v_fmaak_f32 v127, v32, v127, 0xc0135761
    v_mfma_f32_16x16x32_bf16 v[168:171], v[40:43], a[92:95], v[168:171]
    ds_read_b64_tr_b16 v[58:59], v14 offset:1280
    v_mul_f32 v124, v124, v220
    v_mul_f32 v125, v125, v221
    v_mul_f32 v126, v126, v222
    v_mul_f32 v127, v127, v223
    v_mfma_f32_16x16x32_bf16 v[164:167], v[44:47], a[88:91], v[164:167]
    ds_read_b64_tr_b16 v[60:61], v17 offset:1024
    buffer_load_dwordx4 v6, s[60:63], s20 offen offset:2048 lds
    v_exp_f32 v124, v124
    v_exp_f32 v125, v125
    v_mfma_f32_16x16x32_bf16 v[172:175], v[44:47], a[92:95], v[172:175]
    ds_read_b64_tr_b16 v[62:63], v17 offset:1280
    v_exp_f32 v126, v126
    v_exp_f32 v127, v127
    s_waitcnt lgkmcnt(4)
    v_mfma_f32_16x16x32_bf16 v[128:131], v[48:51], a[96:99], v[128:131]
    ds_read_b64_tr_b16 v[40:41], v14 offset:8192
    buffer_load_dwordx4 v7, s[60:63], s20 offen offset:3072 lds
    s_add_u32 m0, s5, 98304
    v_mul_f32 v252, v220, v252
    v_mul_f32 v253, v221, v253
    v_mul_f32 v254, v222, v254
    v_mfma_f32_16x16x32_bf16 v[136:139], v[48:51], a[100:103], v[136:139]
    ds_read_b64_tr_b16 v[42:43], v14 offset:8448
    v_mul_f32 v255, v223, v255
    v_add_f32 v124, 1.0, v124
    v_add_f32 v125, 1.0, v125
    v_add_f32 v126, 1.0, v126
    v_add_f32 v127, 1.0, v127
    v_mfma_f32_16x16x32_bf16 v[132:135], v[52:55], a[96:99], v[132:135]
    ds_read_b64_tr_b16 v[44:45], v17 offset:8192
    buffer_load_dwordx4 v6, s[56:59], s21 offen lds
    v_rcp_f32 v124, v124
    v_rcp_f32 v125, v125
    v_mfma_f32_16x16x32_bf16 v[140:143], v[52:55], a[100:103], v[140:143]
    ds_read_b64_tr_b16 v[46:47], v17 offset:8448
    v_rcp_f32 v126, v126
    v_rcp_f32 v127, v127
    s_waitcnt lgkmcnt(4)
    v_mfma_f32_16x16x32_bf16 v[160:163], v[56:59], a[96:99], v[160:163]
    ds_read_b64_tr_b16 v[48:49], v14 offset:9216
    buffer_load_dwordx4 v7, s[56:59], s21 offen offset:1024 lds
    v_mul_f32 v252, v252, v124
    v_mul_f32 v253, v253, v125
    v_mul_f32 v254, v254, v126
    v_mul_f32 v255, v255, v127
    v_mfma_f32_16x16x32_bf16 v[168:171], v[56:59], a[100:103], v[168:171]
    ds_read_b64_tr_b16 v[50:51], v14 offset:9472
    v_cvt_pk_bf16_f32 v214, v252, v253
    v_cvt_pk_bf16_f32 v215, v254, v255
    v_mfma_f32_16x16x32_bf16 v[164:167], v[60:63], a[96:99], v[164:167]
    ds_read_b64_tr_b16 v[52:53], v17 offset:9216
    v_mfma_f32_16x16x32_bf16 v[172:175], v[60:63], a[100:103], v[172:175]
    ds_read_b64_tr_b16 v[54:55], v17 offset:9472
    buffer_store_dwordx4 v[212:215], v1, s[52:55], s97 offen offset:1024 sc1
    s_waitcnt lgkmcnt(4)
    v_mfma_f32_16x16x32_bf16 v[128:131], v[40:43], a[104:107], v[128:131]
    ds_read_b64_tr_b16 v[56:57], v14 offset:2048
    v_mfma_f32_16x16x32_bf16 v[136:139], v[40:43], a[108:111], v[136:139]
    ds_read_b64_tr_b16 v[58:59], v14 offset:2304
    v_mfma_f32_16x16x32_bf16 v[132:135], v[44:47], a[104:107], v[132:135]
    ds_read_b64_tr_b16 v[60:61], v17 offset:2048
    v_mfma_f32_16x16x32_bf16 v[140:143], v[44:47], a[108:111], v[140:143]
    ds_read_b64_tr_b16 v[62:63], v17 offset:2304
    buffer_load_dwordx4 v6, s[60:63], s21 offen offset:2048 lds
    s_waitcnt lgkmcnt(4)
    v_mfma_f32_16x16x32_bf16 v[160:163], v[48:51], a[104:107], v[160:163]
    ds_read_b64_tr_b16 v[40:41], v14 offset:3072
    v_mfma_f32_16x16x32_bf16 v[168:171], v[48:51], a[108:111], v[168:171]
    ds_read_b64_tr_b16 v[42:43], v14 offset:3328
    v_mfma_f32_16x16x32_bf16 v[164:167], v[52:55], a[104:107], v[164:167]
    ds_read_b64_tr_b16 v[44:45], v17 offset:3072
    v_mfma_f32_16x16x32_bf16 v[172:175], v[52:55], a[108:111], v[172:175]
    ds_read_b64_tr_b16 v[46:47], v17 offset:3328
    buffer_load_dwordx4 v7, s[60:63], s21 offen offset:3072 lds
    s_add_u32 m0, s5, 114688
    s_waitcnt lgkmcnt(4)
    v_mfma_f32_16x16x32_bf16 v[128:131], v[56:59], a[112:115], v[128:131]
    ds_read_b64_tr_b16 v[48:49], v14 offset:10240
    v_mfma_f32_16x16x32_bf16 v[136:139], v[56:59], a[116:119], v[136:139]
    ds_read_b64_tr_b16 v[50:51], v14 offset:10496
    v_mfma_f32_16x16x32_bf16 v[132:135], v[60:63], a[112:115], v[132:135]
    ds_read_b64_tr_b16 v[52:53], v17 offset:10240
    v_mfma_f32_16x16x32_bf16 v[140:143], v[60:63], a[116:119], v[140:143]
    ds_read_b64_tr_b16 v[54:55], v17 offset:10496
    buffer_load_dwordx4 v6, s[56:59], s22 offen lds
    s_waitcnt lgkmcnt(4)
    v_mfma_f32_16x16x32_bf16 v[160:163], v[40:43], a[112:115], v[160:163]
    ds_read_b64_tr_b16 v[56:57], v14 offset:11264
    v_mfma_f32_16x16x32_bf16 v[168:171], v[40:43], a[116:119], v[168:171]
    ds_read_b64_tr_b16 v[58:59], v14 offset:11520
    v_mfma_f32_16x16x32_bf16 v[164:167], v[44:47], a[112:115], v[164:167]
    ds_read_b64_tr_b16 v[60:61], v17 offset:11264
    v_mfma_f32_16x16x32_bf16 v[172:175], v[44:47], a[116:119], v[172:175]
    ds_read_b64_tr_b16 v[62:63], v17 offset:11520
    buffer_load_dwordx4 v7, s[56:59], s22 offen offset:1024 lds
    s_waitcnt lgkmcnt(4)
    v_mfma_f32_16x16x32_bf16 v[128:131], v[48:51], a[120:123], v[128:131]
    s_waitcnt lgkmcnt(0)
    s_barrier
    v_mfma_f32_16x16x32_bf16 v[136:139], v[48:51], a[124:127], v[136:139]
    v_mfma_f32_16x16x32_bf16 v[132:135], v[52:55], a[120:123], v[132:135]
    buffer_load_dwordx4 v6, s[60:63], s22 offen offset:2048 lds
    v_mfma_f32_16x16x32_bf16 v[140:143], v[52:55], a[124:127], v[140:143]
    v_mfma_f32_16x16x32_bf16 v[160:163], v[56:59], a[120:123], v[160:163]
    v_mfma_f32_16x16x32_bf16 v[168:171], v[56:59], a[124:127], v[168:171]
    v_mfma_f32_16x16x32_bf16 v[164:167], v[60:63], a[120:123], v[164:167]
    v_mfma_f32_16x16x32_bf16 v[172:175], v[60:63], a[124:127], v[172:175]
    buffer_load_dwordx4 v7, s[60:63], s22 offen offset:3072 lds
    s_add_u32 m0, s5, 131072
    s_lshl_b32 s97, s10, 6
    s_add_u32 s96, s97, s11
    s_add_u32 s97, s97, s12
    s_add_u32 s96, s96, s94
    v_mov_b32 v116, 0xbdd2d3e8
    v_mov_b32 v117, 0xc0135761
    v_mov_b32 v118, 1.0
    v_pk_mul_f32 v[120:121], v[128:129], v[128:129]
    v_pk_mul_f32 v[122:123], v[130:131], v[130:131]
    v_pk_mul_f32 v[124:125], v[132:133], v[132:133]
    v_pk_mul_f32 v[126:127], v[134:135], v[134:135]
    v_pk_fma_f32 v[120:121], v[120:121], v[116:117], v[116:117] op_sel:[0,0,1] op_sel_hi:[1,0,1]
    v_pk_fma_f32 v[122:123], v[122:123], v[116:117], v[116:117] op_sel:[0,0,1] op_sel_hi:[1,0,1]
    v_pk_fma_f32 v[124:125], v[124:125], v[116:117], v[116:117] op_sel:[0,0,1] op_sel_hi:[1,0,1]
    v_pk_fma_f32 v[126:127], v[126:127], v[116:117], v[116:117] op_sel:[0,0,1] op_sel_hi:[1,0,1]
    v_pk_mul_f32 v[120:121], v[120:121], v[128:129]
    v_pk_mul_f32 v[122:123], v[122:123], v[130:131]
    v_pk_mul_f32 v[124:125], v[124:125], v[132:133]
    buffer_load_dwordx4 v6, s[56:59], s23 offen lds
    v_pk_mul_f32 v[126:127], v[126:127], v[134:135]
    v_exp_f32 v120, v120
    v_exp_f32 v121, v121
    v_exp_f32 v122, v122
    v_exp_f32 v123, v123
    v_exp_f32 v124, v124
    v_exp_f32 v125, v125
    v_exp_f32 v126, v126
    v_exp_f32 v127, v127
    buffer_load_dwordx4 v7, s[56:59], s23 offen offset:1024 lds
    v_pk_mul_f32 v[160:161], v[128:129], v[160:161]
    v_pk_mul_f32 v[162:163], v[130:131], v[162:163]
    v_pk_mul_f32 v[164:165], v[132:133], v[164:165]
    v_pk_mul_f32 v[166:167], v[134:135], v[166:167]
    v_pk_add_f32 v[120:121], v[120:121], v[118:119] op_sel_hi:[1,0]
    v_pk_add_f32 v[122:123], v[122:123], v[118:119] op_sel_hi:[1,0]
    v_pk_add_f32 v[124:125], v[124:125], v[118:119] op_sel_hi:[1,0]
    v_pk_add_f32 v[126:127], v[126:127], v[118:119] op_sel_hi:[1,0]
    v_rcp_f32 v120, v120
    v_rcp_f32 v121, v121
    v_rcp_f32 v122, v122
    v_rcp_f32 v123, v123
    buffer_load_dwordx4 v6, s[60:63], s23 offen offset:2048 lds
    v_rcp_f32 v124, v124
    v_rcp_f32 v125, v125
    v_rcp_f32 v126, v126
    v_rcp_f32 v127, v127
    v_pk_mul_f32 v[160:161], v[160:161], v[120:121]
    v_pk_mul_f32 v[162:163], v[162:163], v[122:123]
    v_pk_mul_f32 v[164:165], v[164:165], v[124:125]
    v_pk_mul_f32 v[166:167], v[166:167], v[126:127]
    v_cvt_pk_bf16_f32 v128, v160, v161
    v_cvt_pk_bf16_f32 v129, v162, v163
    v_cvt_pk_bf16_f32 v130, v164, v165
    v_cvt_pk_bf16_f32 v131, v166, v167
    buffer_store_dwordx4 v[128:131], v1, s[52:55], s96 offen sc1
    v_pk_mul_f32 v[120:121], v[136:137], v[136:137]
    v_pk_mul_f32 v[122:123], v[138:139], v[138:139]
    v_pk_mul_f32 v[124:125], v[140:141], v[140:141]
    v_pk_mul_f32 v[126:127], v[142:143], v[142:143]
    v_pk_fma_f32 v[120:121], v[120:121], v[116:117], v[116:117] op_sel:[0,0,1] op_sel_hi:[1,0,1]
    v_pk_fma_f32 v[122:123], v[122:123], v[116:117], v[116:117] op_sel:[0,0,1] op_sel_hi:[1,0,1]
    v_pk_fma_f32 v[124:125], v[124:125], v[116:117], v[116:117] op_sel:[0,0,1] op_sel_hi:[1,0,1]
    v_pk_fma_f32 v[126:127], v[126:127], v[116:117], v[116:117] op_sel:[0,0,1] op_sel_hi:[1,0,1]
    v_pk_mul_f32 v[120:121], v[120:121], v[136:137]
    v_pk_mul_f32 v[122:123], v[122:123], v[138:139]
    v_pk_mul_f32 v[124:125], v[124:125], v[140:141]
    v_pk_mul_f32 v[126:127], v[126:127], v[142:143]
    v_exp_f32 v120, v120
    v_exp_f32 v121, v121
    buffer_load_dwordx4 v7, s[60:63], s23 offen offset:3072 lds
    s_add_u32 m0, s5, 0
    v_exp_f32 v122, v122
    v_exp_f32 v123, v123
    v_exp_f32 v124, v124
    v_exp_f32 v125, v125
    v_exp_f32 v126, v126
    v_exp_f32 v127, v127
    v_pk_mul_f32 v[168:169], v[136:137], v[168:169]
    v_pk_mul_f32 v[170:171], v[138:139], v[170:171]
    v_pk_mul_f32 v[172:173], v[140:141], v[172:173]
    v_pk_mul_f32 v[174:175], v[142:143], v[174:175]
    buffer_load_dwordx4 v6, s[56:59], s6 offen lds
    v_pk_add_f32 v[120:121], v[120:121], v[118:119] op_sel_hi:[1,0]
    v_pk_add_f32 v[122:123], v[122:123], v[118:119] op_sel_hi:[1,0]
    v_pk_add_f32 v[124:125], v[124:125], v[118:119] op_sel_hi:[1,0]
    v_pk_add_f32 v[126:127], v[126:127], v[118:119] op_sel_hi:[1,0]
    v_rcp_f32 v120, v120
    v_rcp_f32 v121, v121
    v_rcp_f32 v122, v122
    v_rcp_f32 v123, v123
    v_rcp_f32 v124, v124
    v_rcp_f32 v125, v125
    s_waitcnt vmcnt(12)
    buffer_store_dword v0, v37, s[52:55], s13 offen sc1
    s_add_u32 s13, s13, 4096
    v_rcp_f32 v126, v126
    v_rcp_f32 v127, v127
    v_pk_mul_f32 v[168:169], v[168:169], v[120:121]
    v_pk_mul_f32 v[170:171], v[170:171], v[122:123]
    v_pk_mul_f32 v[172:173], v[172:173], v[124:125]
    v_pk_mul_f32 v[174:175], v[174:175], v[126:127]
    v_cvt_pk_bf16_f32 v132, v168, v169
    v_cvt_pk_bf16_f32 v133, v170, v171
    v_cvt_pk_bf16_f32 v134, v172, v173
    v_cvt_pk_bf16_f32 v135, v174, v175
    buffer_store_dwordx4 v[132:135], v1, s[52:55], s96 offen offset:1024 sc1
    ds_read_b64_tr_b16 a[0:1], v21 offset:16384
    ds_read_b64_tr_b16 a[2:3], v21 offset:18432
    ds_read_b64_tr_b16 a[4:5], v24 offset:16384
    ds_read_b64_tr_b16 a[6:7], v24 offset:18432
    ds_read_b64_tr_b16 a[8:9], v27 offset:16384
    v_mfma_f32_16x16x32_bf16 v[192:195], a[192:195], a[128:131], 0
    ds_read_b64_tr_b16 a[10:11], v27 offset:18432
    ds_read_b64_tr_b16 a[12:13], v30 offset:16384
    ds_read_b64_tr_b16 a[14:15], v30 offset:18432
    v_mfma_f32_16x16x32_bf16 v[208:211], a[192:195], a[132:135], 0
    ds_read_b64_tr_b16 a[16:17], v20 offset:16384
    ds_read_b64_tr_b16 a[18:19], v20 offset:18432
    ds_read_b64_tr_b16 a[20:21], v23 offset:16384
    v_mfma_f32_16x16x32_bf16 v[224:227], a[192:195], a[136:139], 0
    ds_read_b64_tr_b16 a[22:23], v23 offset:18432
    ds_read_b64_tr_b16 a[24:25], v26 offset:16384
    ds_read_b64_tr_b16 a[26:27], v26 offset:18432
    v_mfma_f32_16x16x32_bf16 v[240:243], a[192:195], a[140:143], 0
    buffer_load_dwordx4 v7, s[56:59], s6 offen offset:1024 lds
    ds_read_b64_tr_b16 a[28:29], v29 offset:16384
    s_waitcnt lgkmcnt(14)
    ds_read_b64_tr_b16 a[30:31], v29 offset:18432
    v_mfma_f32_16x16x32_bf16 v[196:199], a[196:199], a[128:131], 0
    s_waitcnt lgkmcnt(8)
    ds_read_b64_tr_b16 a[32:33], v20 offset:32768
    ds_read_b64_tr_b16 a[34:35], v20 offset:34816
    v_mfma_f32_16x16x32_bf16 v[212:215], a[196:199], a[132:135], 0
    ds_read_b64_tr_b16 a[36:37], v23 offset:32768
    ds_read_b64_tr_b16 a[38:39], v23 offset:34816
    ds_read_b64_tr_b16 a[40:41], v26 offset:32768
    v_mfma_f32_16x16x32_bf16 v[228:231], a[196:199], a[136:139], 0
    ds_read_b64_tr_b16 a[42:43], v26 offset:34816
    ds_read_b64_tr_b16 a[44:45], v29 offset:32768
    s_waitcnt lgkmcnt(14)
    ds_read_b64_tr_b16 a[46:47], v29 offset:34816
    v_mfma_f32_16x16x32_bf16 v[244:247], a[196:199], a[140:143], 0
    buffer_load_dwordx4 v6, s[60:63], s6 offen offset:2048 lds
    s_waitcnt lgkmcnt(8)
    v_mfma_f32_16x16x32_bf16 v[200:203], a[200:203], a[128:131], 0
    ds_read_b64_tr_b16 a[48:49], v20 offset:49152
    ds_read_b64_tr_b16 a[50:51], v20 offset:51200
    ds_read_b64_tr_b16 a[52:53], v23 offset:49152
    v_mfma_f32_16x16x32_bf16 v[216:219], a[200:203], a[132:135], 0
    ds_read_b64_tr_b16 a[54:55], v23 offset:51200
    ds_read_b64_tr_b16 a[56:57], v26 offset:49152
    ds_read_b64_tr_b16 a[58:59], v26 offset:51200
    v_mfma_f32_16x16x32_bf16 v[232:235], a[200:203], a[136:139], 0
    ds_read_b64_tr_b16 a[60:61], v29 offset:49152
    s_waitcnt lgkmcnt(14)
    ds_read_b64_tr_b16 a[62:63], v29 offset:51200
    v_mfma_f32_16x16x32_bf16 v[248:251], a[200:203], a[140:143], 0
    buffer_load_dwordx4 v7, s[60:63], s6 offen offset:3072 lds
    s_add_u32 m0, s5, 81920
    s_xor_b32 s26, s6, 32768
    v_mfma_f32_16x16x32_bf16 v[204:207], a[204:207], a[128:131], 0
    s_waitcnt lgkmcnt(8)
    ds_read_b64_tr_b16 a[64:65], v21 offset:0
    ds_read_b64_tr_b16 a[66:67], v21 offset:2048
    v_mfma_f32_16x16x32_bf16 v[220:223], a[204:207], a[132:135], 0
    ds_read_b64_tr_b16 a[68:69], v24 offset:0
    ds_read_b64_tr_b16 a[70:71], v24 offset:2048
    ds_read_b64_tr_b16 a[72:73], v27 offset:0
    v_mfma_f32_16x16x32_bf16 v[236:239], a[204:207], a[136:139], 0
    ds_read_b64_tr_b16 a[74:75], v27 offset:2048
    ds_read_b64_tr_b16 a[76:77], v30 offset:0
    s_waitcnt lgkmcnt(14)
    ds_read_b64_tr_b16 a[78:79], v30 offset:2048
    v_mfma_f32_16x16x32_bf16 v[252:255], a[204:207], a[140:143], 0
    buffer_load_dwordx4 v6, s[56:59], s26 offen lds
    s_waitcnt lgkmcnt(8)
    v_mfma_f32_16x16x32_bf16 v[192:195], a[208:211], a[144:147], v[192:195]
    v_mfma_f32_16x16x32_bf16 v[208:211], a[208:211], a[148:151], v[208:211]
    v_mfma_f32_16x16x32_bf16 v[224:227], a[208:211], a[152:155], v[224:227]
    v_mfma_f32_16x16x32_bf16 v[240:243], a[208:211], a[156:159], v[240:243]
    buffer_load_dwordx4 v7, s[56:59], s26 offen offset:1024 lds
    v_mfma_f32_16x16x32_bf16 v[196:199], a[212:215], a[144:147], v[196:199]
    v_mfma_f32_16x16x32_bf16 v[212:215], a[212:215], a[148:151], v[212:215]
    v_mfma_f32_16x16x32_bf16 v[228:231], a[212:215], a[152:155], v[228:231]
    s_waitcnt lgkmcnt(0)
    v_mfma_f32_16x16x32_bf16 v[244:247], a[212:215], a[156:159], v[244:247]
    buffer_load_dwordx4 v6, s[60:63], s26 offen offset:2048 lds
    v_mfma_f32_16x16x32_bf16 v[200:203], a[216:219], a[144:147], v[200:203]
    v_mfma_f32_16x16x32_bf16 v[216:219], a[216:219], a[148:151], v[216:219]
    v_mfma_f32_16x16x32_bf16 v[232:235], a[216:219], a[152:155], v[232:235]
    v_mfma_f32_16x16x32_bf16 v[248:251], a[216:219], a[156:159], v[248:251]
    buffer_load_dwordx4 v7, s[60:63], s26 offen offset:3072 lds
    s_add_u32 m0, s5, 16384
    v_mfma_f32_16x16x32_bf16 v[204:207], a[220:223], a[144:147], v[204:207]
    v_mfma_f32_16x16x32_bf16 v[220:223], a[220:223], a[148:151], v[220:223]
    v_mfma_f32_16x16x32_bf16 v[236:239], a[220:223], a[152:155], v[236:239]
    v_mfma_f32_16x16x32_bf16 v[252:255], a[220:223], a[156:159], v[252:255]
    buffer_load_dwordx4 v6, s[64:67], s84 offen lds
    v_mfma_f32_16x16x32_bf16 v[192:195], a[224:227], a[160:163], v[192:195]
    v_mfma_f32_16x16x32_bf16 v[208:211], a[224:227], a[164:167], v[208:211]
    v_mfma_f32_16x16x32_bf16 v[224:227], a[224:227], a[168:171], v[224:227]
    v_mfma_f32_16x16x32_bf16 v[240:243], a[224:227], a[172:175], v[240:243]
    buffer_load_dwordx4 v7, s[64:67], s84 offen offset:1024 lds
    v_mfma_f32_16x16x32_bf16 v[196:199], a[228:231], a[160:163], v[196:199]
    v_mfma_f32_16x16x32_bf16 v[212:215], a[228:231], a[164:167], v[212:215]
    v_mfma_f32_16x16x32_bf16 v[228:231], a[228:231], a[168:171], v[228:231]
    v_mfma_f32_16x16x32_bf16 v[244:247], a[228:231], a[172:175], v[244:247]
    buffer_load_dwordx4 v6, s[68:71], s84 offen offset:2048 lds
    v_mfma_f32_16x16x32_bf16 v[200:203], a[232:235], a[160:163], v[200:203]
    v_mfma_f32_16x16x32_bf16 v[216:219], a[232:235], a[164:167], v[216:219]
    v_mfma_f32_16x16x32_bf16 v[232:235], a[232:235], a[168:171], v[232:235]
    v_mfma_f32_16x16x32_bf16 v[248:251], a[232:235], a[172:175], v[248:251]
    buffer_load_dwordx4 v7, s[68:71], s84 offen offset:3072 lds
    s_add_u32 m0, s5, 32768
    v_mfma_f32_16x16x32_bf16 v[204:207], a[236:239], a[160:163], v[204:207]
    v_mfma_f32_16x16x32_bf16 v[220:223], a[236:239], a[164:167], v[220:223]
    v_mfma_f32_16x16x32_bf16 v[236:239], a[236:239], a[168:171], v[236:239]
    v_mfma_f32_16x16x32_bf16 v[252:255], a[236:239], a[172:175], v[252:255]
    buffer_load_dwordx4 v6, s[64:67], s85 offen lds
    v_mfma_f32_16x16x32_bf16 v[192:195], a[240:243], a[176:179], v[192:195]
    v_mfma_f32_16x16x32_bf16 v[208:211], a[240:243], a[180:183], v[208:211]
    v_mfma_f32_16x16x32_bf16 v[224:227], a[240:243], a[184:187], v[224:227]
    v_mfma_f32_16x16x32_bf16 v[240:243], a[240:243], a[188:191], v[240:243]
    s_waitcnt vmcnt(12)
    buffer_store_dword v0, v37, s[52:55], s13 offen sc1
    s_add_u32 s13, s13, 4096
    v_mfma_f32_16x16x32_bf16 v[196:199], a[244:247], a[176:179], v[196:199]
    v_mfma_f32_16x16x32_bf16 v[212:215], a[244:247], a[180:183], v[212:215]
    v_mfma_f32_16x16x32_bf16 v[228:231], a[244:247], a[184:187], v[228:231]
    v_mfma_f32_16x16x32_bf16 v[244:247], a[244:247], a[188:191], v[244:247]
    buffer_load_dwordx4 v7, s[64:67], s85 offen offset:1024 lds
    v_mfma_f32_16x16x32_bf16 v[200:203], a[248:251], a[176:179], v[200:203]
    v_mfma_f32_16x16x32_bf16 v[216:219], a[248:251], a[180:183], v[216:219]
    v_mfma_f32_16x16x32_bf16 v[232:235], a[248:251], a[184:187], v[232:235]
    v_mfma_f32_16x16x32_bf16 v[248:251], a[248:251], a[188:191], v[248:251]
    buffer_load_dwordx4 v6, s[68:71], s85 offen offset:2048 lds
    v_mfma_f32_16x16x32_bf16 v[204:207], a[252:255], a[176:179], v[204:207]
    v_mfma_f32_16x16x32_bf16 v[220:223], a[252:255], a[180:183], v[220:223]
    v_mfma_f32_16x16x32_bf16 v[236:239], a[252:255], a[184:187], v[236:239]
    v_mfma_f32_16x16x32_bf16 v[252:255], a[252:255], a[188:191], v[252:255]
    buffer_load_dwordx4 v7, s[68:71], s85 offen offset:3072 lds
    s_add_u32 m0, s5, 49152
    buffer_load_dwordx4 v[80:83], v33, s[52:55], s14 offen sc1
    buffer_load_dwordx4 v6, s[64:67], s86 offen lds
    buffer_load_dwordx4 v7, s[64:67], s86 offen offset:1024 lds
    buffer_load_dwordx4 v6, s[68:71], s86 offen offset:2048 lds
    buffer_load_dwordx4 v7, s[68:71], s86 offen offset:3072 lds
    s_add_u32 m0, s5, 65536
    s_nop 0
    buffer_load_dwordx4 v6, s[64:67], s87 offen lds
    buffer_load_dwordx4 v7, s[64:67], s87 offen offset:1024 lds
    buffer_load_dwordx4 v6, s[68:71], s87 offen offset:2048 lds
    buffer_load_dwordx4 v7, s[68:71], s87 offen offset:3072 lds
    s_waitcnt vmcnt(8)
    v_cmp_eq_u32 vcc, 0, v80
    s_nop 0
    s_and_b32 s91, vcc_lo, 255
    s_cbranch_scc1 LB_poll2_retry
LB_poll2_ok:
    v_subrev_u32 v35, 2048, v33
    v_lshrrev_b32 v35, 3, v35
    v_add_u32 v35, 159744, v35
    ds_write_b128 v35, v[80:83]
    s_add_u32 s14, s14, 4096
    s_lshr_b32 s93, s16, 3
    buffer_load_dwordx4 a[128:131], v2, s[32:35], s93 offen sc1
    buffer_load_dwordx4 a[132:135], v3, s[32:35], s93 offen sc1
    buffer_load_dwordx4 a[136:139], v4, s[32:35], s93 offen sc1
    buffer_load_dwordx4 a[140:143], v5, s[32:35], s93 offen sc1
    s_lshr_b32 s93, s17, 3
    buffer_load_dwordx4 a[144:147], v2, s[32:35], s93 offen sc1
    buffer_load_dwordx4 a[148:151], v3, s[32:35], s93 offen sc1
    buffer_load_dwordx4 a[152:155], v4, s[32:35], s93 offen sc1
    buffer_load_dwordx4 a[156:159], v5, s[32:35], s93 offen sc1
    s_lshr_b32 s93, s18, 3
    buffer_load_dwordx4 a[160:163], v2, s[32:35], s93 offen sc1
    buffer_load_dwordx4 a[164:167], v3, s[32:35], s93 offen sc1
    buffer_load_dwordx4 a[168:171], v4, s[32:35], s93 offen sc1
    buffer_load_dwordx4 a[172:175], v5, s[32:35], s93 offen sc1
    s_waitcnt vmcnt(11)
    v_mfma_f32_16x16x32_bf16 v[192:195], a[0:3], a[128:131], v[192:195]
    s_waitcnt vmcnt(10)
    v_mfma_f32_16x16x32_bf16 v[208:211], a[0:3], a[132:135], v[208:211]
    s_waitcnt vmcnt(9)
    v_mfma_f32_16x16x32_bf16 v[224:227], a[0:3], a[136:139], v[224:227]
    s_waitcnt vmcnt(8)
    v_mfma_f32_16x16x32_bf16 v[240:243], a[0:3], a[140:143], v[240:243]
    s_lshr_b32 s93, s19, 3
    buffer_load_dwordx4 a[176:179], v2, s[32:35], s93 offen sc1
    v_mfma_f32_16x16x32_bf16 v[196:199], a[4:7], a[128:131], v[196:199]
    v_mfma_f32_16x16x32_bf16 v[212:215], a[4:7], a[132:135], v[212:215]
    v_mfma_f32_16x16x32_bf16 v[228:231], a[4:7], a[136:139], v[228:231]
    v_mfma_f32_16x16x32_bf16 v[244:247], a[4:7], a[140:143], v[244:247]
    buffer_load_dwordx4 a[180:183], v3, s[32:35], s93 offen sc1
    v_mfma_f32_16x16x32_bf16 v[200:203], a[8:11], a[128:131], v[200:203]
    v_mfma_f32_16x16x32_bf16 v[216:219], a[8:11], a[132:135], v[216:219]
    v_mfma_f32_16x16x32_bf16 v[232:235], a[8:11], a[136:139], v[232:235]
    v_mfma_f32_16x16x32_bf16 v[248:251], a[8:11], a[140:143], v[248:251]
    buffer_load_dwordx4 a[184:187], v4, s[32:35], s93 offen sc1
    v_mfma_f32_16x16x32_bf16 v[204:207], a[12:15], a[128:131], v[204:207]
    v_mfma_f32_16x16x32_bf16 v[220:223], a[12:15], a[132:135], v[220:223]
    v_mfma_f32_16x16x32_bf16 v[236:239], a[12:15], a[136:139], v[236:239]
    v_mfma_f32_16x16x32_bf16 v[252:255], a[12:15], a[140:143], v[252:255]
    buffer_load_dwordx4 a[188:191], v5, s[32:35], s93 offen sc1
    s_waitcnt vmcnt(8)
    v_mfma_f32_16x16x32_bf16 v[192:195], a[16:19], a[144:147], v[192:195]
    v_mfma_f32_16x16x32_bf16 v[208:211], a[16:19], a[148:151], v[208:211]
    v_mfma_f32_16x16x32_bf16 v[224:227], a[16:19], a[152:155], v[224:227]
    v_mfma_f32_16x16x32_bf16 v[240:243], a[16:19], a[156:159], v[240:243]
    s_lshr_b32 s93, s20, 3
    buffer_load_dwordx4 a[128:131], v2, s[32:35], s93 offen sc1
    v_mfma_f32_16x16x32_bf16 v[196:199], a[20:23], a[144:147], v[196:199]
    v_mfma_f32_16x16x32_bf16 v[212:215], a[20:23], a[148:151], v[212:215]
    v_mfma_f32_16x16x32_bf16 v[228:231], a[20:23], a[152:155], v[228:231]
    v_mfma_f32_16x16x32_bf16 v[244:247], a[20:23], a[156:159], v[244:247]
    buffer_load_dwordx4 a[132:135], v3, s[32:35], s93 offen sc1
    v_mfma_f32_16x16x32_bf16 v[200:203], a[24:27], a[144:147], v[200:203]
    v_mfma_f32_16x16x32_bf16 v[216:219], a[24:27], a[148:151], v[216:219]
    v_mfma_f32_16x16x32_bf16 v[232:235], a[24:27], a[152:155], v[232:235]
    v_mfma_f32_16x16x32_bf16 v[248:251], a[24:27], a[156:159], v[248:251]
    buffer_load_dwordx4 a[136:139], v4, s[32:35], s93 offen sc1
    v_mfma_f32_16x16x32_bf16 v[204:207], a[28:31], a[144:147], v[204:207]
    v_mfma_f32_16x16x32_bf16 v[220:223], a[28:31], a[148:151], v[220:223]
    v_mfma_f32_16x16x32_bf16 v[236:239], a[28:31], a[152:155], v[236:239]
    v_mfma_f32_16x16x32_bf16 v[252:255], a[28:31], a[156:159], v[252:255]
    buffer_load_dwordx4 a[140:143], v5, s[32:35], s93 offen sc1
    s_waitcnt vmcnt(8)
    v_mfma_f32_16x16x32_bf16 v[192:195], a[32:35], a[160:163], v[192:195]
    v_mfma_f32_16x16x32_bf16 v[208:211], a[32:35], a[164:167], v[208:211]
    v_mfma_f32_16x16x32_bf16 v[224:227], a[32:35], a[168:171], v[224:227]
    v_mfma_f32_16x16x32_bf16 v[240:243], a[32:35], a[172:175], v[240:243]
    buffer_load_dword v35, v33, s[52:55], s14 offen sc1
    v_mfma_f32_16x16x32_bf16 v[196:199], a[36:39], a[160:163], v[196:199]
    v_mfma_f32_16x16x32_bf16 v[212:215], a[36:39], a[164:167], v[212:215]
    v_mfma_f32_16x16x32_bf16 v[228:231], a[36:39], a[168:171], v[228:231]
    v_mfma_f32_16x16x32_bf16 v[244:247], a[36:39], a[172:175], v[244:247]
    s_lshr_b32 s93, s21, 3
    buffer_load_dwordx4 a[144:147], v2, s[32:35], s93 offen sc1
    v_mfma_f32_16x16x32_bf16 v[200:203], a[40:43], a[160:163], v[200:203]
    v_mfma_f32_16x16x32_bf16 v[216:219], a[40:43], a[164:167], v[216:219]
    v_mfma_f32_16x16x32_bf16 v[232:235], a[40:43], a[168:171], v[232:235]
    v_mfma_f32_16x16x32_bf16 v[248:251], a[40:43], a[172:175], v[248:251]
    buffer_load_dwordx4 a[148:151], v3, s[32:35], s93 offen sc1
    v_mfma_f32_16x16x32_bf16 v[204:207], a[44:47], a[160:163], v[204:207]
    v_mfma_f32_16x16x32_bf16 v[220:223], a[44:47], a[164:167], v[220:223]
    v_mfma_f32_16x16x32_bf16 v[236:239], a[44:47], a[168:171], v[236:239]
    v_mfma_f32_16x16x32_bf16 v[252:255], a[44:47], a[172:175], v[252:255]
    buffer_load_dwordx4 a[152:155], v4, s[32:35], s93 offen sc1
    s_waitcnt vmcnt(8)
    v_mfma_f32_16x16x32_bf16 v[192:195], a[48:51], a[176:179], v[192:195]
    v_mfma_f32_16x16x32_bf16 v[208:211], a[48:51], a[180:183], v[208:211]
    v_mfma_f32_16x16x32_bf16 v[224:227], a[48:51], a[184:187], v[224:227]
    v_mfma_f32_16x16x32_bf16 v[240:243], a[48:51], a[188:191], v[240:243]
    buffer_load_dwordx4 a[156:159], v5, s[32:35], s93 offen sc1
    v_mfma_f32_16x16x32_bf16 v[196:199], a[52:55], a[176:179], v[196:199]
    v_mfma_f32_16x16x32_bf16 v[212:215], a[52:55], a[180:183], v[212:215]
    v_mfma_f32_16x16x32_bf16 v[228:231], a[52:55], a[184:187], v[228:231]
    v_mfma_f32_16x16x32_bf16 v[244:247], a[52:55], a[188:191], v[244:247]
    s_lshr_b32 s93, s22, 3
    buffer_load_dwordx4 a[160:163], v2, s[32:35], s93 offen sc1
    v_mfma_f32_16x16x32_bf16 v[200:203], a[56:59], a[176:179], v[200:203]
    v_mfma_f32_16x16x32_bf16 v[216:219], a[56:59], a[180:183], v[216:219]
    v_mfma_f32_16x16x32_bf16 v[232:235], a[56:59], a[184:187], v[232:235]
    v_mfma_f32_16x16x32_bf16 v[248:251], a[56:59], a[188:191], v[248:251]
    buffer_load_dwordx4 a[164:167], v3, s[32:35], s93 offen sc1
    v_mfma_f32_16x16x32_bf16 v[204:207], a[60:63], a[176:179], v[204:207]
    v_mfma_f32_16x16x32_bf16 v[220:223], a[60:63], a[180:183], v[220:223]
    v_mfma_f32_16x16x32_bf16 v[236:239], a[60:63], a[184:187], v[236:239]
    v_mfma_f32_16x16x32_bf16 v[252:255], a[60:63], a[188:191], v[252:255]
    buffer_load_dwordx4 a[168:171], v4, s[32:35], s93 offen sc1
    s_waitcnt vmcnt(8)
    v_mfma_f32_16x16x32_bf16 v[192:195], a[64:67], a[128:131], v[192:195]
    ds_read_b64_tr_b16 v[40:41], v21 offset:32768
    ds_read_b64_tr_b16 a[0:1], v20 offset:16384
    ds_read_b64_tr_b16 a[2:3], v20 offset:18432
    v_mfma_f32_16x16x32_bf16 v[208:211], a[64:67], a[132:135], v[208:211]
    ds_read_b64_tr_b16 v[42:43], v21 offset:34816
    ds_read_b64_tr_b16 a[4:5], v23 offset:16384
    ds_read_b64_tr_b16 a[6:7], v23 offset:18432
    v_mfma_f32_16x16x32_bf16 v[224:227], a[64:67], a[136:139], v[224:227]
    ds_read_b64_tr_b16 v[44:45], v24 offset:32768
    ds_read_b64_tr_b16 a[8:9], v26 offset:16384
    ds_read_b64_tr_b16 a[10:11], v26 offset:18432
    v_mfma_f32_16x16x32_bf16 v[240:243], a[64:67], a[140:143], v[240:243]
    ds_read_b64_tr_b16 v[46:47], v24 offset:34816
    buffer_load_dwordx4 a[172:175], v5, s[32:35], s93 offen sc1
    ds_read_b64_tr_b16 a[12:13], v29 offset:16384
    v_mfma_f32_16x16x32_bf16 v[196:199], a[68:71], a[128:131], v[196:199]
    ds_read_b64_tr_b16 a[14:15], v29 offset:18432
    ds_read_b64_tr_b16 a[16:17], v20 offset:32768
    ds_read_b64_tr_b16 a[18:19], v20 offset:34816
    v_mfma_f32_16x16x32_bf16 v[212:215], a[68:71], a[132:135], v[212:215]
    s_waitcnt lgkmcnt(14)
    ds_read_b64_tr_b16 a[20:21], v23 offset:32768
    s_waitcnt lgkmcnt(14)
    ds_read_b64_tr_b16 a[22:23], v23 offset:34816
    v_mfma_f32_16x16x32_bf16 v[228:231], a[68:71], a[136:139], v[228:231]
    s_waitcnt lgkmcnt(14)
    ds_read_b64_tr_b16 a[24:25], v26 offset:32768
    s_waitcnt lgkmcnt(14)
    ds_read_b64_tr_b16 a[26:27], v26 offset:34816
    v_mfma_f32_16x16x32_bf16 v[244:247], a[68:71], a[140:143], v[244:247]
    s_lshr_b32 s93, s23, 3
    buffer_load_dwordx4 a[176:179], v2, s[32:35], s93 offen sc1
    v_mfma_f32_16x16x32_bf16 v[200:203], a[72:75], a[128:131], v[200:203]
    s_waitcnt lgkmcnt(14)
    ds_read_b64_tr_b16 v[48:49], v27 offset:32768
    s_waitcnt lgkmcnt(14)
    ds_read_b64_tr_b16 a[28:29], v29 offset:32768
    v_mfma_f32_16x16x32_bf16 v[216:219], a[72:75], a[132:135], v[216:219]
    s_waitcnt lgkmcnt(14)
    ds_read_b64_tr_b16 v[50:51], v27 offset:34816
    s_waitcnt lgkmcnt(14)
    ds_read_b64_tr_b16 a[30:31], v29 offset:34816
    v_mfma_f32_16x16x32_bf16 v[232:235], a[72:75], a[136:139], v[232:235]
    s_waitcnt lgkmcnt(14)
    ds_read_b64_tr_b16 v[52:53], v30 offset:32768
    s_waitcnt lgkmcnt(11)
    v_mfma_f32_16x16x32_bf16 v[248:251], a[72:75], a[140:143], v[248:251]
    ds_read_b64_tr_b16 v[54:55], v30 offset:34816
    buffer_load_dwordx4 a[180:183], v3, s[32:35], s93 offen sc1
    v_mfma_f32_16x16x32_bf16 v[204:207], a[76:79], a[128:131], v[204:207]
    ds_read_b64_tr_b16 a[32:33], v20 offset:49152
    ds_read_b64_tr_b16 a[34:35], v20 offset:51200
    ds_read_b64_tr_b16 a[36:37], v23 offset:49152
    v_mfma_f32_16x16x32_bf16 v[220:223], a[76:79], a[132:135], v[220:223]
    s_waitcnt lgkmcnt(14)
    ds_read_b64_tr_b16 a[38:39], v23 offset:51200
    s_waitcnt lgkmcnt(14)
    ds_read_b64_tr_b16 a[40:41], v26 offset:49152
    v_mfma_f32_16x16x32_bf16 v[236:239], a[76:79], a[136:139], v[236:239]
    s_waitcnt lgkmcnt(14)
    ds_read_b64_tr_b16 a[42:43], v26 offset:51200
    s_waitcnt lgkmcnt(14)
    ds_read_b64_tr_b16 a[44:45], v29 offset:49152
    v_mfma_f32_16x16x32_bf16 v[252:255], a[76:79], a[140:143], v[252:255]
    buffer_load_dwordx4 a[184:187], v4, s[32:35], s93 offen sc1
    s_waitcnt lgkmcnt(14)
    ds_read_b64_tr_b16 a[46:47], v29 offset:51200
    s_waitcnt vmcnt(7)
    v_mfma_f32_16x16x32_bf16 v[192:195], v[40:43], a[144:147], v[192:195]
    s_waitcnt lgkmcnt(14)
    ds_read_b64_tr_b16 v[56:57], v21 offset:49152
    s_waitcnt lgkmcnt(11)
    v_mfma_f32_16x16x32_bf16 v[208:211], v[40:43], a[148:151], v[208:211]
    ds_read_b64_tr_b16 v[58:59], v21 offset:51200
    ds_read_b64_tr_b16 a[48:49], v21 offset:0
    ds_read_b64_tr_b16 a[50:51], v21 offset:2048
    v_mfma_f32_16x16x32_bf16 v[224:227], v[40:43], a[152:155], v[224:227]
    ds_read_b64_tr_b16 v[60:61], v24 offset:49152
    s_waitcnt lgkmcnt(14)
    ds_read_b64_tr_b16 a[52:53], v24 offset:0
    v_mfma_f32_16x16x32_bf16 v[240:243], v[40:43], a[156:159], v[240:243]
    s_waitcnt lgkmcnt(14)
    ds_read_b64_tr_b16 v[62:63], v24 offset:51200
    buffer_load_dwordx4 a[188:191], v5, s[32:35], s93 offen sc1
    v_mfma_f32_16x16x32_bf16 v[196:199], v[44:47], a[144:147], v[196:199]
    s_barrier
    v_cmp_eq_u32 vcc, 0, v35
    s_nop 0
    s_and_b32 s91, vcc_lo, 255
    s_cbranch_scc1 LB_poll3_retry
LB_poll3_ok:
    v_mfma_f32_16x16x32_bf16 v[212:215], v[44:47], a[148:151], v[212:215]
    s_waitcnt lgkmcnt(14)
    ds_read_b64_tr_b16 a[54:55], v24 offset:2048
    s_waitcnt lgkmcnt(14)
    ds_read_b64_tr_b16 a[56:57], v27 offset:0
    v_mfma_f32_16x16x32_bf16 v[228:231], v[44:47], a[152:155], v[228:231]
    s_waitcnt lgkmcnt(14)
    ds_read_b64_tr_b16 a[58:59], v27 offset:2048
    s_waitcnt lgkmcnt(14)
    ds_read_b64_tr_b16 a[60:61], v30 offset:0
    v_mfma_f32_16x16x32_bf16 v[244:247], v[44:47], a[156:159], v[244:247]
    s_lshr_b32 s93, s6, 3
    buffer_load_dwordx4 a[128:131], v2, s[32:35], s93 offen sc1
    v_mfma_f32_16x16x32_bf16 v[200:203], v[48:51], a[144:147], v[200:203]
    s_waitcnt lgkmcnt(14)
    ds_read_b64_tr_b16 v[40:41], v27 offset:49152
    s_waitcnt lgkmcnt(14)
    ds_read_b64_tr_b16 a[62:63], v30 offset:2048
    v_mfma_f32_16x16x32_bf16 v[216:219], v[48:51], a[148:151], v[216:219]
    s_waitcnt lgkmcnt(14)
    ds_read_b64_tr_b16 v[42:43], v27 offset:51200
    s_waitcnt lgkmcnt(14)
    v_mfma_f32_16x16x32_bf16 v[232:235], v[48:51], a[152:155], v[232:235]
    ds_read_b64_tr_b16 v[44:45], v30 offset:49152
    v_lshrrev_b32 v64, 10, v2
    v_lshl_add_u32 v64, v64, 6, v34
    v_mfma_f32_16x16x32_bf16 v[248:251], v[48:51], a[156:159], v[248:251]
    s_waitcnt lgkmcnt(14)
    ds_read_b64_tr_b16 v[46:47], v30 offset:51200
    buffer_load_dwordx4 a[132:135], v3, s[32:35], s93 offen sc1
    v_mfma_f32_16x16x32_bf16 v[204:207], v[52:55], a[144:147], v[204:207]
    s_waitcnt lgkmcnt(14)
    ds_read_b32 v84, v64
    v_lshrrev_b32 v64, 10, v3
    v_mfma_f32_16x16x32_bf16 v[220:223], v[52:55], a[148:151], v[220:223]
    v_lshl_add_u32 v64, v64, 6, v34
    s_waitcnt lgkmcnt(14)
    ds_read_b32 v85, v64
    v_mfma_f32_16x16x32_bf16 v[236:239], v[52:55], a[152:155], v[236:239]
    v_lshrrev_b32 v64, 10, v4
    v_lshl_add_u32 v64, v64, 6, v34
    s_waitcnt lgkmcnt(14)
    ds_read_b32 v86, v64
    v_mfma_f32_16x16x32_bf16 v[252:255], v[52:55], a[156:159], v[252:255]
    buffer_load_dwordx4 a[136:139], v4, s[32:35], s93 offen sc1
    s_waitcnt lgkmcnt(6) vmcnt(7)
    v_mfma_f32_16x16x32_bf16 v[192:195], v[56:59], a[160:163], v[192:195]
    ds_read_b64_tr_b16 v[48:49], v22 offset:0
    v_lshrrev_b32 v64, 10, v5
    v_lshl_add_u32 v64, v64, 6, v34
    v_mfma_f32_16x16x32_bf16 v[208:211], v[56:59], a[164:167], v[208:211]
    ds_read_b64_tr_b16 v[50:51], v22 offset:2048
    ds_read_b32 v87, v64
    v_mfma_f32_16x16x32_bf16 v[224:227], v[56:59], a[168:171], v[224:227]
    ds_read_b64_tr_b16 v[52:53], v25 offset:0
    v_mfma_f32_16x16x32_bf16 v[240:243], v[56:59], a[172:175], v[240:243]
    ds_read_b64_tr_b16 v[54:55], v25 offset:2048
    buffer_load_dwordx4 a[140:143], v5, s[32:35], s93 offen sc1
    v_mfma_f32_16x16x32_bf16 v[196:199], v[60:63], a[160:163], v[196:199]
    v_mfma_f32_16x16x32_bf16 v[212:215], v[60:63], a[164:167], v[212:215]
    v_mfma_f32_16x16x32_bf16 v[228:231], v[60:63], a[168:171], v[228:231]
    v_mfma_f32_16x16x32_bf16 v[244:247], v[60:63], a[172:175], v[244:247]
    s_xor_b32 s93, s6, 32768
    s_lshr_b32 s93, s93, 3
    buffer_load_dwordx4 a[144:147], v2, s[32:35], s93 offen sc1
    s_waitcnt lgkmcnt(8)
    v_mfma_f32_16x16x32_bf16 v[200:203], v[40:43], a[160:163], v[200:203]
    ds_read_b64_tr_b16 v[56:57], v28 offset:0
    s_waitcnt lgkmcnt(8)
    v_sub_f32 v88, 2.0, v84
    v_mfma_f32_16x16x32_bf16 v[216:219], v[40:43], a[164:167], v[216:219]
    ds_read_b64_tr_b16 v[58:59], v28 offset:2048
    v_subrev_f32 v84, 1.0, v84
    v_mfma_f32_16x16x32_bf16 v[232:235], v[40:43], a[168:171], v[232:235]
    ds_read_b64_tr_b16 v[60:61], v31 offset:0
    s_waitcnt lgkmcnt(9)
    v_sub_f32 v89, 2.0, v85
    v_mfma_f32_16x16x32_bf16 v[248:251], v[40:43], a[172:175], v[248:251]
    ds_read_b64_tr_b16 v[62:63], v31 offset:2048
    buffer_load_dwordx4 a[148:151], v3, s[32:35], s93 offen sc1
    v_subrev_f32 v85, 1.0, v85
    v_mfma_f32_16x16x32_bf16 v[204:207], v[44:47], a[160:163], v[204:207]
    s_waitcnt lgkmcnt(9)
    v_sub_f32 v90, 2.0, v86
    v_subrev_f32 v86, 1.0, v86
    v_mfma_f32_16x16x32_bf16 v[220:223], v[44:47], a[164:167], v[220:223]
    s_waitcnt lgkmcnt(6)
    v_sub_f32 v91, 2.0, v87
    v_subrev_f32 v87, 1.0, v87
    v_mfma_f32_16x16x32_bf16 v[236:239], v[44:47], a[168:171], v[236:239]
    v_add_u32 v64, s5, v1
    s_add_u32 s96, s4, 3
    s_and_b32 s96, s96, 3
    s_lshl_b32 s96, s96, 12
    v_add_u32 v65, s96, v1
    v_mfma_f32_16x16x32_bf16 v[252:255], v[44:47], a[172:175], v[252:255]
    buffer_load_dwordx4 a[152:155], v4, s[32:35], s93 offen sc1
    s_add_u32 s96, s4, 2
    s_and_b32 s96, s96, 3
    s_lshl_b32 s96, s96, 12
    v_add_u32 v66, s96, v1
    s_waitcnt vmcnt(7) lgkmcnt(4)
    v_mfma_f32_16x16x32_bf16 v[192:195], v[48:51], a[176:179], v[192:195]
    ds_read_b64_tr_b16 v[40:41], v20 offset:0
    s_add_u32 s96, s4, 1
    s_and_b32 s96, s96, 3
    s_lshl_b32 s96, s96, 12
    v_add_u32 v67, s96, v1
    v_mfma_f32_16x16x32_bf16 v[208:211], v[48:51], a[180:183], v[208:211]
    ds_read_b64_tr_b16 v[42:43], v20 offset:2048
    v_bfe_u32 v68, v1, 4, 4
    v_lshlrev_b32 v68, 10, v68
    v_mfma_f32_16x16x32_bf16 v[224:227], v[48:51], a[184:187], v[224:227]
    ds_read_b64_tr_b16 v[44:45], v23 offset:0
    v_bfe_u32 v69, v1, 8, 1
    v_lshl_add_u32 v68, v69, 5, v68
    v_mfma_f32_16x16x32_bf16 v[240:243], v[48:51], a[188:191], v[240:243]
    ds_read_b64_tr_b16 v[46:47], v23 offset:2048
    buffer_load_dwordx4 a[156:159], v5, s[32:35], s93 offen sc1
    v_lshrrev_b32 v69, 9, v1
    v_mfma_f32_16x16x32_bf16 v[196:199], v[52:55], a[176:179], v[196:199]
    s_lshr_b32 s84, s84, 3
    s_add_u32 s84, s84, 229376
    v_lshl_add_u32 v68, v69, 4, v68
    v_mfma_f32_16x16x32_bf16 v[212:215], v[52:55], a[180:183], v[212:215]
    s_lshr_b32 s85, s85, 3
    s_add_u32 s85, s85, 229376
    v_bfe_u32 v69, v1, 4, 4
    v_mfma_f32_16x16x32_bf16 v[228:231], v[52:55], a[184:187], v[228:231]
    s_lshr_b32 s86, s86, 3
    s_add_u32 s86, s86, 229376
    v_mul_u32_u24 v69, 144, v69
    v_mfma_f32_16x16x32_bf16 v[244:247], v[52:55], a[188:191], v[244:247]
    s_lshr_b32 s87, s87, 3
    s_add_u32 s87, s87, 229376
    s_waitcnt lgkmcnt(4)
    v_mfma_f32_16x16x32_bf16 v[200:203], v[56:59], a[176:179], v[200:203]
    ds_read_b64_tr_b16 v[48:49], v26 offset:0
    buffer_load_dwordx4 a[192:195], v2, s[32:35], s84 offen sc1
    v_lshrrev_b32 v70, 8, v1
    v_mfma_f32_16x16x32_bf16 v[216:219], v[56:59], a[180:183], v[216:219]
    ds_read_b64_tr_b16 v[50:51], v26 offset:2048
    v_lshl_add_u32 v69, v70, 3, v69
    v_add_u32 v69, s5, v69
    v_mfma_f32_16x16x32_bf16 v[232:235], v[56:59], a[184:187], v[232:235]
    ds_read_b64_tr_b16 v[52:53], v29 offset:0
    v_lshrrev_b32 v71, 7, v1
    v_and_b32 v68, 0x70, v1
    v_mfma_f32_16x16x32_bf16 v[248:251], v[56:59], a[188:191], v[248:251]
    ds_read_b64_tr_b16 v[54:55], v29 offset:2048
    v_mul_u32_u24 v70, 144, v71
    v_add3_u32 v70, v70, v68, s5
    v_mfma_f32_16x16x32_bf16 v[204:207], v[60:63], a[176:179], v[204:207]
    buffer_load_dwordx4 a[208:211], v2, s[32:35], s85 offen sc1
    v_lshl_add_u32 v68, v71, 10, v68
    v_add_u32 v71, 0x2000, v68
    v_mfma_f32_16x16x32_bf16 v[220:223], v[60:63], a[180:183], v[220:223]
    v_mfma_f32_16x16x32_bf16 v[236:239], v[60:63], a[184:187], v[236:239]
    v_mfma_f32_16x16x32_bf16 v[252:255], v[60:63], a[188:191], v[252:255]
    s_waitcnt vmcnt(6) lgkmcnt(4)
    v_mfma_f32_16x16x32_bf16 v[192:195], v[40:43], a[128:131], v[192:195]
    ds_read_b64_tr_b16 v[56:57], v21 offset:16384
    buffer_load_dwordx4 a[224:227], v2, s[32:35], s86 offen sc1
    v_mfma_f32_16x16x32_bf16 v[208:211], v[40:43], a[132:135], v[208:211]
    ds_read_b64_tr_b16 v[58:59], v21 offset:18432
    v_mfma_f32_16x16x32_bf16 v[224:227], v[40:43], a[136:139], v[224:227]
    ds_read_b64_tr_b16 v[60:61], v24 offset:16384
    v_mfma_f32_16x16x32_bf16 v[240:243], v[40:43], a[140:143], v[240:243]
    ds_read_b64_tr_b16 v[62:63], v24 offset:18432
    v_mfma_f32_16x16x32_bf16 v[196:199], v[44:47], a[128:131], v[196:199]
    buffer_load_dwordx4 a[240:243], v2, s[32:35], s87 offen sc1
    v_mfma_f32_16x16x32_bf16 v[212:215], v[44:47], a[132:135], v[212:215]
    v_mfma_f32_16x16x32_bf16 v[228:231], v[44:47], a[136:139], v[228:231]
    v_mfma_f32_16x16x32_bf16 v[244:247], v[44:47], a[140:143], v[244:247]
    s_waitcnt lgkmcnt(4)
    v_mfma_f32_16x16x32_bf16 v[200:203], v[48:51], a[128:131], v[200:203]
    ds_read_b64_tr_b16 v[40:41], v27 offset:16384
    buffer_load_dwordx4 a[196:199], v3, s[32:35], s84 offen sc1
    v_mfma_f32_16x16x32_bf16 v[216:219], v[48:51], a[132:135], v[216:219]
    ds_read_b64_tr_b16 v[42:43], v27 offset:18432
    v_mfma_f32_16x16x32_bf16 v[232:235], v[48:51], a[136:139], v[232:235]
    ds_read_b64_tr_b16 v[44:45], v30 offset:16384
    v_mfma_f32_16x16x32_bf16 v[248:251], v[48:51], a[140:143], v[248:251]
    ds_read_b64_tr_b16 v[46:47], v30 offset:18432
    v_mfma_f32_16x16x32_bf16 v[204:207], v[52:55], a[128:131], v[204:207]
    buffer_load_dwordx4 a[212:215], v3, s[32:35], s85 offen sc1
    v_mfma_f32_16x16x32_bf16 v[220:223], v[52:55], a[132:135], v[220:223]
    v_mfma_f32_16x16x32_bf16 v[236:239], v[52:55], a[136:139], v[236:239]
    v_mfma_f32_16x16x32_bf16 v[252:255], v[52:55], a[140:143], v[252:255]
    s_waitcnt vmcnt(6) lgkmcnt(4)
    v_mfma_f32_16x16x32_bf16 v[192:195], v[56:59], a[144:147], v[192:195]
    buffer_load_dwordx4 a[228:231], v3, s[32:35], s86 offen sc1
    v_mfma_f32_16x16x32_bf16 v[208:211], v[56:59], a[148:151], v[208:211]
    v_mfma_f32_16x16x32_bf16 v[224:227], v[56:59], a[152:155], v[224:227]
    v_mfma_f32_16x16x32_bf16 v[240:243], v[56:59], a[156:159], v[240:243]
    v_mfma_f32_16x16x32_bf16 v[196:199], v[60:63], a[144:147], v[196:199]
    buffer_load_dwordx4 a[244:247], v3, s[32:35], s87 offen sc1
    v_mfma_f32_16x16x32_bf16 v[212:215], v[60:63], a[148:151], v[212:215]
    v_mfma_f32_16x16x32_bf16 v[228:231], v[60:63], a[152:155], v[228:231]
    v_mfma_f32_16x16x32_bf16 v[244:247], v[60:63], a[156:159], v[244:247]
    s_waitcnt lgkmcnt(0)
    v_mfma_f32_16x16x32_bf16 v[200:203], v[40:43], a[144:147], v[200:203]
    buffer_load_dwordx4 a[200:203], v4, s[32:35], s84 offen sc1
    v_mfma_f32_16x16x32_bf16 v[216:219], v[40:43], a[148:151], v[216:219]
    v_mfma_f32_16x16x32_bf16 v[232:235], v[40:43], a[152:155], v[232:235]
    v_mfma_f32_16x16x32_bf16 v[248:251], v[40:43], a[156:159], v[248:251]
    v_mfma_f32_16x16x32_bf16 v[204:207], v[44:47], a[144:147], v[204:207]
    buffer_load_dwordx4 a[216:219], v4, s[32:35], s85 offen sc1
    v_mfma_f32_16x16x32_bf16 v[220:223], v[44:47], a[148:151], v[220:223]
    v_mfma_f32_16x16x32_bf16 v[236:239], v[44:47], a[152:155], v[236:239]
    v_mfma_f32_16x16x32_bf16 v[252:255], v[44:47], a[156:159], v[252:255]
    s_waitcnt vmcnt(6)
    v_mfma_f32_16x16x32_bf16 v[128:131], a[0:3], a[192:195], 0
    buffer_load_dwordx4 a[232:235], v4, s[32:35], s86 offen sc1
    v_mul_f32 v192, v192, v88
    v_mul_f32 v193, v193, v88
    v_mul_f32 v194, v194, v88
    v_mfma_f32_16x16x32_bf16 v[132:135], a[4:7], a[192:195], 0
    v_mul_f32 v195, v195, v88
    v_mul_f32 v196, v196, v88
    v_mul_f32 v197, v197, v88
    v_mul_f32 v198, v198, v88
    v_mfma_f32_16x16x32_bf16 v[136:139], a[8:11], a[192:195], 0
    v_mul_f32 v199, v199, v88
    v_mul_f32 v200, v200, v88
    v_mul_f32 v201, v201, v88
    v_mul_f32 v202, v202, v88
    v_mfma_f32_16x16x32_bf16 v[140:143], a[12:15], a[192:195], 0
    v_mul_f32 v203, v203, v88
    v_mul_f32 v204, v204, v88
    v_mul_f32 v205, v205, v88
    v_mul_f32 v206, v206, v88
    v_mfma_f32_16x16x32_bf16 v[128:131], a[16:19], a[208:211], v[128:131]
    buffer_load_dwordx4 a[248:251], v4, s[32:35], s87 offen sc1
    v_mul_f32 v207, v207, v88
    v_mul_f32 v208, v208, v89
    v_mul_f32 v209, v209, v89
    v_mfma_f32_16x16x32_bf16 v[132:135], a[20:23], a[208:211], v[132:135]
    v_mul_f32 v210, v210, v89
    v_mul_f32 v211, v211, v89
    v_mul_f32 v212, v212, v89
    v_mul_f32 v213, v213, v89
    v_mfma_f32_16x16x32_bf16 v[136:139], a[24:27], a[208:211], v[136:139]
    v_mul_f32 v214, v214, v89
    v_mul_f32 v215, v215, v89
    v_mul_f32 v216, v216, v89
    v_mul_f32 v217, v217, v89
    v_mfma_f32_16x16x32_bf16 v[140:143], a[28:31], a[208:211], v[140:143]
    v_mul_f32 v218, v218, v89
    v_mul_f32 v219, v219, v89
    v_mul_f32 v220, v220, v89
    v_mfma_f32_16x16x32_bf16 v[128:131], a[32:35], a[224:227], v[128:131]
    buffer_load_dwordx4 a[204:207], v5, s[32:35], s84 offen sc1
    v_mul_f32 v221, v221, v89
    v_mul_f32 v222, v222, v89
    v_mul_f32 v223, v223, v89
    v_mfma_f32_16x16x32_bf16 v[132:135], a[36:39], a[224:227], v[132:135]
    v_mul_f32 v224, v224, v90
    v_mul_f32 v225, v225, v90
    v_mul_f32 v226, v226, v90
    v_mul_f32 v227, v227, v90
    v_mfma_f32_16x16x32_bf16 v[136:139], a[40:43], a[224:227], v[136:139]
    v_mul_f32 v228, v228, v90
    v_mul_f32 v229, v229, v90
    v_mul_f32 v230, v230, v90
    v_mul_f32 v231, v231, v90
    v_mfma_f32_16x16x32_bf16 v[140:143], a[44:47], a[224:227], v[140:143]
    v_mul_f32 v232, v232, v90
    v_mul_f32 v233, v233, v90
    v_mul_f32 v234, v234, v90
    v_mul_f32 v235, v235, v90
    v_mfma_f32_16x16x32_bf16 v[128:131], a[48:51], a[240:243], v[128:131]
    buffer_load_dwordx4 a[220:223], v5, s[32:35], s85 offen sc1
    v_mul_f32 v236, v236, v90
    v_mul_f32 v237, v237, v90
    v_mul_f32 v238, v238, v90
    v_mfma_f32_16x16x32_bf16 v[132:135], a[52:55], a[240:243], v[132:135]
    v_mul_f32 v239, v239, v90
    v_mul_f32 v240, v240, v91
    v_mul_f32 v241, v241, v91
    v_mul_f32 v242, v242, v91
    v_mfma_f32_16x16x32_bf16 v[136:139], a[56:59], a[240:243], v[136:139]
    v_mul_f32 v243, v243, v91
    v_mul_f32 v244, v244, v91
    v_mul_f32 v245, v245, v91
    v_mul_f32 v246, v246, v91
    v_mfma_f32_16x16x32_bf16 v[140:143], a[60:63], a[240:243], v[140:143]
    v_mul_f32 v247, v247, v91
    v_mul_f32 v248, v248, v91
    v_mul_f32 v249, v249, v91
    s_waitcnt vmcnt(6)
    v_mfma_f32_16x16x32_bf16 v[144:147], a[0:3], a[196:199], 0
    buffer_load_dwordx4 a[236:239], v5, s[32:35], s86 offen sc1
    v_mul_f32 v250, v250, v91
    v_mul_f32 v251, v251, v91
    v_mul_f32 v252, v252, v91
    v_mfma_f32_16x16x32_bf16 v[148:151], a[4:7], a[196:199], 0
    v_mul_f32 v253, v253, v91
    v_mul_f32 v254, v254, v91
    v_mul_f32 v255, v255, v91
    v_fmac_f32 v192, v128, v84
    v_mfma_f32_16x16x32_bf16 v[152:155], a[8:11], a[196:199], 0
    v_fmac_f32 v193, v129, v84
    v_fmac_f32 v194, v130, v84
    v_fmac_f32 v195, v131, v84
    v_fmac_f32 v196, v132, v84
    v_mfma_f32_16x16x32_bf16 v[156:159], a[12:15], a[196:199], 0
    v_fmac_f32 v197, v133, v84
    v_fmac_f32 v198, v134, v84
    v_fmac_f32 v199, v135, v84
    v_fmac_f32 v200, v136, v84
    v_mfma_f32_16x16x32_bf16 v[144:147], a[16:19], a[212:215], v[144:147]
    buffer_load_dwordx4 a[252:255], v5, s[32:35], s87 offen sc1
    v_fmac_f32 v201, v137, v84
    v_fmac_f32 v202, v138, v84
    v_fmac_f32 v203, v139, v84
    v_mfma_f32_16x16x32_bf16 v[148:151], a[20:23], a[212:215], v[148:151]
    v_fmac_f32 v204, v140, v84
    v_fmac_f32 v205, v141, v84
    v_fmac_f32 v206, v142, v84
    v_fmac_f32 v207, v143, v84
    v_mfma_f32_16x16x32_bf16 v[152:155], a[24:27], a[212:215], v[152:155]
    ds_write_b128 v64, v[192:195] offset:0
    v_mfma_f32_16x16x32_bf16 v[156:159], a[28:31], a[212:215], v[156:159]
    v_mfma_f32_16x16x32_bf16 v[144:147], a[32:35], a[228:231], v[144:147]
    ds_write_b128 v64, v[196:199] offset:1024
    v_mfma_f32_16x16x32_bf16 v[148:151], a[36:39], a[228:231], v[148:151]
    v_mfma_f32_16x16x32_bf16 v[152:155], a[40:43], a[228:231], v[152:155]
    ds_write_b128 v64, v[200:203] offset:2048
    v_mfma_f32_16x16x32_bf16 v[156:159], a[44:47], a[228:231], v[156:159]
    v_mfma_f32_16x16x32_bf16 v[144:147], a[48:51], a[244:247], v[144:147]
    ds_write_b128 v64, v[204:207] offset:3072
    v_mfma_f32_16x16x32_bf16 v[148:151], a[52:55], a[244:247], v[148:151]
    v_mfma_f32_16x16x32_bf16 v[152:155], a[56:59], a[244:247], v[152:155]
    v_mfma_f32_16x16x32_bf16 v[156:159], a[60:63], a[244:247], v[156:159]
    s_waitcnt vmcnt(4)
    v_mfma_f32_16x16x32_bf16 v[160:163], a[0:3], a[200:203], 0
    s_nop 1
    v_fmac_f32 v208, v144, v85
    v_fmac_f32 v209, v145, v85
    v_mfma_f32_16x16x32_bf16 v[164:167], a[4:7], a[200:203], 0
    v_fmac_f32 v210, v146, v85
    v_fmac_f32 v211, v147, v85
    v_fmac_f32 v212, v148, v85
    v_fmac_f32 v213, v149, v85
    v_mfma_f32_16x16x32_bf16 v[168:171], a[8:11], a[200:203], 0
    v_fmac_f32 v214, v150, v85
    v_fmac_f32 v215, v151, v85
    v_fmac_f32 v216, v152, v85
    v_fmac_f32 v217, v153, v85
    v_mfma_f32_16x16x32_bf16 v[172:175], a[12:15], a[200:203], 0
    v_fmac_f32 v218, v154, v85
    v_fmac_f32 v219, v155, v85
    v_fmac_f32 v220, v156, v85
    v_fmac_f32 v221, v157, v85
    v_mfma_f32_16x16x32_bf16 v[160:163], a[16:19], a[216:219], v[160:163]
    v_fmac_f32 v222, v158, v85
    v_fmac_f32 v223, v159, v85
    v_mfma_f32_16x16x32_bf16 v[164:167], a[20:23], a[216:219], v[164:167]
    ds_write_b128 v64, v[208:211] offset:16384
    v_mfma_f32_16x16x32_bf16 v[168:171], a[24:27], a[216:219], v[168:171]
    v_mfma_f32_16x16x32_bf16 v[172:175], a[28:31], a[216:219], v[172:175]
    ds_write_b128 v64, v[212:215] offset:17408
    v_mfma_f32_16x16x32_bf16 v[160:163], a[32:35], a[232:235], v[160:163]
    v_mfma_f32_16x16x32_bf16 v[164:167], a[36:39], a[232:235], v[164:167]
    ds_write_b128 v64, v[216:219] offset:18432
    v_mfma_f32_16x16x32_bf16 v[168:171], a[40:43], a[232:235], v[168:171]
    v_mfma_f32_16x16x32_bf16 v[172:175], a[44:47], a[232:235], v[172:175]
    ds_write_b128 v64, v[220:223] offset:19456
    v_mfma_f32_16x16x32_bf16 v[160:163], a[48:51], a[248:251], v[160:163]
    v_mfma_f32_16x16x32_bf16 v[164:167], a[52:55], a[248:251], v[164:167]
    v_mfma_f32_16x16x32_bf16 v[168:171], a[56:59], a[248:251], v[168:171]
    v_mfma_f32_16x16x32_bf16 v[172:175], a[60:63], a[248:251], v[172:175]
    s_waitcnt vmcnt(0)
    v_mfma_f32_16x16x32_bf16 v[176:179], a[0:3], a[204:207], 0
    s_nop 2
    v_fmac_f32 v224, v160, v86
    v_mfma_f32_16x16x32_bf16 v[180:183], a[4:7], a[204:207], 0
    v_fmac_f32 v225, v161, v86
    v_fmac_f32 v226, v162, v86
    v_fmac_f32 v227, v163, v86
    v_fmac_f32 v228, v164, v86
    v_mfma_f32_16x16x32_bf16 v[184:187], a[8:11], a[204:207], 0
    v_fmac_f32 v229, v165, v86
    v_fmac_f32 v230, v166, v86
    v_fmac_f32 v231, v167, v86
    v_fmac_f32 v232, v168, v86
    v_mfma_f32_16x16x32_bf16 v[188:191], a[12:15], a[204:207], 0
    v_fmac_f32 v233, v169, v86
    v_fmac_f32 v234, v170, v86
    v_fmac_f32 v235, v171, v86
    v_fmac_f32 v236, v172, v86
    v_mfma_f32_16x16x32_bf16 v[176:179], a[16:19], a[220:223], v[176:179]
    v_fmac_f32 v237, v173, v86
    v_fmac_f32 v238, v174, v86
    v_fmac_f32 v239, v175, v86
    v_mfma_f32_16x16x32_bf16 v[180:183], a[20:23], a[220:223], v[180:183]
    ds_write_b128 v64, v[224:227] offset:32768
    v_mfma_f32_16x16x32_bf16 v[184:187], a[24:27], a[220:223], v[184:187]
    v_mfma_f32_16x16x32_bf16 v[188:191], a[28:31], a[220:223], v[188:191]
    ds_write_b128 v64, v[228:231] offset:33792
    v_mfma_f32_16x16x32_bf16 v[176:179], a[32:35], a[236:239], v[176:179]
    v_mfma_f32_16x16x32_bf16 v[180:183], a[36:39], a[236:239], v[180:183]
    ds_write_b128 v64, v[232:235] offset:34816
    v_mfma_f32_16x16x32_bf16 v[184:187], a[40:43], a[236:239], v[184:187]
    v_mfma_f32_16x16x32_bf16 v[188:191], a[44:47], a[236:239], v[188:191]
    ds_write_b128 v64, v[236:239] offset:35840
    s_waitcnt lgkmcnt(0)
    s_barrier
    ds_read_b128 v[128:131], v65 offset:0
    v_mfma_f32_16x16x32_bf16 v[176:179], a[48:51], a[252:255], v[176:179]
    ds_read_b128 v[132:135], v65 offset:1024
    ds_read_b128 v[136:139], v65 offset:2048
    ds_read_b128 v[140:143], v65 offset:3072
    ds_read_b128 v[144:147], v66 offset:16384
    v_mfma_f32_16x16x32_bf16 v[180:183], a[52:55], a[252:255], v[180:183]
    ds_read_b128 v[148:151], v66 offset:17408
    ds_read_b128 v[152:155], v66 offset:18432
    ds_read_b128 v[156:159], v66 offset:19456
    ds_read_b128 v[160:163], v67 offset:32768
    v_mfma_f32_16x16x32_bf16 v[184:187], a[56:59], a[252:255], v[184:187]
    ds_read_b128 v[164:167], v67 offset:33792
    ds_read_b128 v[168:171], v67 offset:34816
    ds_read_b128 v[172:175], v67 offset:35840
    v_mfma_f32_16x16x32_bf16 v[188:191], a[60:63], a[252:255], v[188:191]
    v_pk_fma_f32 v[240:241], v[176:177], v[86:87], v[240:241] op_sel:[0,1,0] op_sel_hi:[1,1,1]
    v_pk_fma_f32 v[242:243], v[178:179], v[86:87], v[242:243] op_sel:[0,1,0] op_sel_hi:[1,1,1]
    v_pk_fma_f32 v[244:245], v[180:181], v[86:87], v[244:245] op_sel:[0,1,0] op_sel_hi:[1,1,1]
    v_pk_fma_f32 v[246:247], v[182:183], v[86:87], v[246:247] op_sel:[0,1,0] op_sel_hi:[1,1,1]
    v_pk_fma_f32 v[248:249], v[184:185], v[86:87], v[248:249] op_sel:[0,1,0] op_sel_hi:[1,1,1]
    v_pk_fma_f32 v[250:251], v[186:187], v[86:87], v[250:251] op_sel:[0,1,0] op_sel_hi:[1,1,1]
    s_nop 1
    v_pk_fma_f32 v[252:253], v[188:189], v[86:87], v[252:253] op_sel:[0,1,0] op_sel_hi:[1,1,1]
    v_pk_fma_f32 v[254:255], v[190:191], v[86:87], v[254:255] op_sel:[0,1,0] op_sel_hi:[1,1,1]
    s_waitcnt lgkmcnt(11)
    v_pk_add_f32 v[240:241], v[240:241], v[128:129]
    v_pk_add_f32 v[242:243], v[242:243], v[130:131]
    s_waitcnt lgkmcnt(10)
    v_pk_add_f32 v[244:245], v[244:245], v[132:133]
    v_pk_add_f32 v[246:247], v[246:247], v[134:135]
    s_waitcnt lgkmcnt(9)
    v_pk_add_f32 v[248:249], v[248:249], v[136:137]
    v_pk_add_f32 v[250:251], v[250:251], v[138:139]
    s_waitcnt lgkmcnt(8)
    v_pk_add_f32 v[252:253], v[252:253], v[140:141]
    v_pk_add_f32 v[254:255], v[254:255], v[142:143]
    s_waitcnt lgkmcnt(7)
    v_pk_add_f32 v[240:241], v[240:241], v[144:145]
    v_pk_add_f32 v[242:243], v[242:243], v[146:147]
    s_waitcnt lgkmcnt(6)
    v_pk_add_f32 v[244:245], v[244:245], v[148:149]
    v_pk_add_f32 v[246:247], v[246:247], v[150:151]
    s_waitcnt lgkmcnt(5)
    v_pk_add_f32 v[248:249], v[248:249], v[152:153]
    v_pk_add_f32 v[250:251], v[250:251], v[154:155]
    s_waitcnt lgkmcnt(4)
    v_pk_add_f32 v[252:253], v[252:253], v[156:157]
    v_pk_add_f32 v[254:255], v[254:255], v[158:159]
    s_waitcnt lgkmcnt(3)
    v_pk_add_f32 v[240:241], v[240:241], v[160:161]
    v_pk_add_f32 v[242:243], v[242:243], v[162:163]
    s_waitcnt lgkmcnt(2)
    v_pk_add_f32 v[244:245], v[244:245], v[164:165]
    v_pk_add_f32 v[246:247], v[246:247], v[166:167]
    s_waitcnt lgkmcnt(1)
    v_pk_add_f32 v[248:249], v[248:249], v[168:169]
    v_pk_add_f32 v[250:251], v[250:251], v[170:171]
    s_waitcnt lgkmcnt(0)
    v_pk_add_f32 v[252:253], v[252:253], v[172:173]
    v_pk_add_f32 v[254:255], v[254:255], v[174:175]
    v_cvt_pk_bf16_f32 v176, v240, v241
    v_cvt_pk_bf16_f32 v177, v242, v243
    v_cvt_pk_bf16_f32 v178, v244, v245
    v_cvt_pk_bf16_f32 v179, v246, v247
    v_cvt_pk_bf16_f32 v180, v248, v249
    v_cvt_pk_bf16_f32 v181, v250, v251
    v_cvt_pk_bf16_f32 v182, v252, v253
    v_cvt_pk_bf16_f32 v183, v254, v255
    ds_write_b64 v69, v[176:177] offset:49152
    ds_write_b64 v69, v[178:179] offset:49184
    ds_write_b64 v69, v[180:181] offset:49216
    ds_write_b64 v69, v[182:183] offset:49248
    s_waitcnt lgkmcnt(0)
    ds_read_b128 v[184:187], v70 offset:49152
    ds_read_b128 v[188:191], v70 offset:50304
    s_waitcnt lgkmcnt(1)
    buffer_store_dwordx4 v[184:187], v68, s[72:75], s92 offen sc1
    s_waitcnt lgkmcnt(0)
    buffer_store_dwordx4 v[188:191], v71, s[72:75], s92 offen sc1
    s_endpgm
LB_poll0_retry:
    s_mov_b32 s95, 0
LB_poll0_loop:
    s_sleep 4
    buffer_load_dword v35, v37, s[76:79], 0 offen offset:128 sc1

    s_add_u32 s95, s95, 1
    s_cmp_ge_u32 s95, 400000
    s_waitcnt vmcnt(0)
    s_cbranch_scc1 LB_poll0_ok
    v_cmp_eq_u32 vcc, 0, v35
    s_nop 0
    s_and_b32 s91, vcc_lo, -1
    s_cbranch_scc1 LB_poll0_loop
    s_branch LB_poll0_ok
LB_poll1_retry:
    s_mov_b32 s95, 0
LB_poll1_loop:
    s_sleep 4
    buffer_load_dword v35, v33, s[52:55], s14 offen sc1

    s_add_u32 s95, s95, 1
    s_cmp_ge_u32 s95, 400000
    s_waitcnt vmcnt(0)
    s_cbranch_scc1 LB_poll1_ok
    v_cmp_eq_u32 vcc, 0, v35
    s_nop 0
    s_and_b32 s91, vcc_lo, 255
    s_cbranch_scc1 LB_poll1_loop
    s_branch LB_poll1_ok
LB_poll2_retry:
    s_mov_b32 s95, 0
LB_poll2_loop:
    s_sleep 4
    buffer_load_dwordx4 v[80:83], v33, s[52:55], s14 offen sc1

    s_add_u32 s95, s95, 1
    s_cmp_ge_u32 s95, 400000
    s_waitcnt vmcnt(0)
    s_cbranch_scc1 LB_poll2_ok
    v_cmp_eq_u32 vcc, 0, v80
    s_nop 0
    s_and_b32 s91, vcc_lo, 255
    s_cbranch_scc1 LB_poll2_loop
    s_branch LB_poll2_ok
LB_poll3_retry:
    s_mov_b32 s95, 0
LB_poll3_loop:
    s_sleep 4
    buffer_load_dword v35, v33, s[52:55], s14 offen sc1

    s_add_u32 s95, s95, 1
    s_cmp_ge_u32 s95, 400000
    s_waitcnt vmcnt(0)
    s_cbranch_scc1 LB_poll3_ok
    v_cmp_eq_u32 vcc, 0, v35
    s_nop 0
    s_and_b32 s91, vcc_lo, 255
    s_cbranch_scc1 LB_poll3_loop
    s_branch LB_poll3_ok
L_exit:
    s_endpgm
.section .rodata,"a"
.p2align 6
.amdhsa_kernel gated_mix__linear_attn_block__geglu_ffn__prompt_kernel
  .amdhsa_next_free_vgpr 512
  .amdhsa_next_free_sgpr 102
  .amdhsa_accum_offset 256
  .amdhsa_group_segment_fixed_size 0
  .amdhsa_kernarg_size 88
  .amdhsa_user_sgpr_count 2
  .amdhsa_user_sgpr_kernarg_segment_ptr 1
  .amdhsa_system_sgpr_workgroup_id_x 1
  .amdhsa_float_denorm_mode_32 3
.end_amdhsa_kernel
```
